```python
import torch

def _softmax(x, axis=-1):
    return torch.softmax(x, dim=axis)

def _gelu(x):
    return torch.nn.functional.gelu(x, approximate='tanh')

def _silu(x):
    return torch.nn.functional.silu(x)

def _sigmoid(x):
    return torch.sigmoid(x)

def _layernorm(x, axis=-1, eps=1e-05):
    m = x.mean(dim=axis, keepdim=True)
    v = x.var(dim=axis, keepdim=True, unbiased=False)
    return (x - m) / torch.sqrt(v + eps)

def _scatter_add(tgt, idx, src, axis=0):
    return tgt.clone().index_add_(axis, idx, src)

def _segment_sum(src, seg, n):
    out = torch.zeros((n,) + src.shape[1:], dtype=src.dtype)
    return out.index_add_(0, seg, src)

def _pad(x, pw):
    flat = tuple((v for pair in reversed(pw) for v in pair))
    return torch.nn.functional.pad(x, flat)
kernel_name = 'recurrent_scan__memory_aug_recurrent_mem_tr__dense_activation_squared_relu__prompt'

def setup_inputs():

    _w = lambda a: (lambda t: t.to(torch.bfloat16) if t.is_floating_point() else t)(torch.as_tensor(a))

    def _A_setup():
        B, S, Dm = (1, 2048, 640)
        H, Dh = (32, 192)
        M, seg = (8, 32)
        seg = min(seg, S)
        S = S // seg * seg
        return {'x': _w((lambda *s: torch.randn(*s, dtype=torch.bfloat16) * 0.05)(B, S, Dm)), 'mem0': _w((lambda *s: torch.randn(*s, dtype=torch.bfloat16) * 0.05)(B, M, Dm)), 'Wq': _w((lambda *s: torch.randn(*s, dtype=torch.bfloat16) * 1.6)(Dm, H, Dh) * Dm ** (-0.5)), 'Wk': _w((lambda *s: torch.randn(*s, dtype=torch.bfloat16) * 1.6)(Dm, H, Dh) * Dm ** (-0.5)), 'Wv': _w((lambda *s: torch.randn(*s, dtype=torch.bfloat16) * 0.05)(Dm, H, Dh) * Dm ** (-0.5)), 'Wo': _w((lambda *s: torch.randn(*s, dtype=torch.bfloat16) * 0.05)(H, Dh, Dm) * (H * Dh) ** (-0.5)), 'seg_len': seg}
    _A_in = _A_setup()

    def _B_setup():
        B, S, D, F = (1, 2048, 640, 1536)
        return {'x': _w((lambda *s: torch.randn(*s, dtype=torch.bfloat16) * 0.05)(B, S, D)), 'w1': _w((lambda *s: torch.randn(*s, dtype=torch.bfloat16) * 0.05)(D, F)), 'b1': _w((lambda *s: torch.randn(*s, dtype=torch.bfloat16) * 0.4)(F)), 'w2': _w((lambda *s: torch.randn(*s, dtype=torch.bfloat16) * 0.05)(F, D)), 'b2': _w((lambda *s: torch.randn(*s, dtype=torch.bfloat16) * 1.6)(D))}
    _B_in = _B_setup()
    return {'A_x': _A_in['x'], 'A_mem0': _A_in['mem0'], 'A_Wq': _A_in['Wq'], 'A_Wk': _A_in['Wk'], 'A_Wv': _A_in['Wv'], 'A_Wo': _A_in['Wo'], 'A_seg_len': _A_in['seg_len'], 'B_x': _B_in['x'], 'B_w1': _B_in['w1'], 'B_b1': _B_in['b1'], 'B_w2': _B_in['w2'], 'B_b2': _B_in['b2']}

def reference(A_x, A_mem0, A_Wq, A_Wk, A_Wv, A_Wo, A_seg_len, B_x, B_w1, B_b1, B_w2, B_b2):

    def _A_ref(x, mem0, Wq, Wk, Wv, Wo, seg_len):
        B, S, Dm = x.shape
        H, Dh = (Wq.shape[1], Wq.shape[2])
        M = mem0.shape[1]
        scale = Dh ** (-0.5)
        n_seg = S // seg_len
        L = M + seg_len
        idx = torch.arange(L)
        mask = (idx[:, None] < M) | (idx[:, None] >= idx[None, :])
        mem = mem0
        outs = []
        for s in range(n_seg):
            xs = x[:, s * seg_len:(s + 1) * seg_len, :].clone()
            h = torch.concatenate([mem, xs], axis=1)
            q = torch.einsum('btd,dhe->bhte', h, Wq)
            k = torch.einsum('btd,dhe->bhte', h, Wk)
            v = torch.einsum('btd,dhe->bhte', h, Wv)
            scores = torch.einsum('bhqe,bhke->bhqk', q, k) * scale
            scores = torch.where(mask[None, None], scores, -1000000000.0)
            p = _softmax(scores, axis=-1)
            o = torch.einsum('bhqk,bhke->bhqe', p, v)
            o = torch.einsum('bhte,hed->btd', o, Wo)
            mem = o[:, :M, :].clone()
            outs.append(o[:, M:, :])
        return torch.concatenate(outs, axis=1)

    def _B_ref(x, w1, b1, w2, b2):
        h = torch.einsum('bsd,df->bsf', x, w1) + b1
        zero = torch.zeros_like(h)
        r = torch.where(h > zero, h, zero)
        h = r * r
        out = torch.einsum('bsf,fd->bsd', h, w2) + b2
        return out
    x = A_x
    xn = _layernorm(x, axis=-1)
    s = _A_ref(xn, A_mem0, A_Wq, A_Wk, A_Wv, A_Wo, A_seg_len)
    g = _silu(_B_ref(xn, B_w1, B_b1, B_w2, B_b2))
    return x + s * g
```

```asm
; @launch kernel=recurrent_scan__memory_aug_recurrent_mem_tr__dense_activation_squared_relu__prompt_kernel grid=(256,1,1) block=(256,1,1) lds=163840
.amdgcn_target "amdgcn-amd-amdhsa--gfx950"
.text
.globl recurrent_scan__memory_aug_recurrent_mem_tr__dense_activation_squared_relu__prompt_kernel
.p2align 8
.type recurrent_scan__memory_aug_recurrent_mem_tr__dense_activation_squared_relu__prompt_kernel,@function
recurrent_scan__memory_aug_recurrent_mem_tr__dense_activation_squared_relu__prompt_kernel:
  s_cmp_ge_u32 s2, 256
  s_cbranch_scc1 R_END
  s_load_dwordx2 s[4:5], s[0:1], 112
  s_mov_b32 s6, 268435456
  s_mov_b32 s7, 0x20000
  s_load_dwordx2 s[48:49], s[0:1], 104
  s_mov_b32 s50, 256
  s_mov_b32 s51, 0x20000
  v_lshrrev_b32 v2, 6, v0
  v_and_b32 v1, 63, v0
  s_nop 0
  v_readfirstlane_b32 s16, v2
  s_waitcnt lgkmcnt(0)
  s_cmp_eq_u32 s16, 0
  s_cbranch_scc0 RT_wait
  s_getreg_b32 s20, hwreg(HW_REG_XCC_ID)
  s_and_b32 s20, s20, 7
  v_mov_b32 v3, 0
  s_mov_b64 exec, 1
  s_cmp_ge_u32 s20, 4
  s_cbranch_scc1 RT_w
  v_mov_b32 v2, 1
  buffer_atomic_add v2, off, s[48:51], 0 offset:0 sc0 sc1
  s_waitcnt vmcnt(0)
  v_readfirstlane_b32 s21, v2
  s_add_u32 s2, s21, 0
  s_cmp_lt_u32 s21, 104
  s_cbranch_scc1 RT_pub
RT_w:
  v_mov_b32 v2, 1
  buffer_atomic_add v2, off, s[48:51], 0 offset:128 sc0 sc1
  s_waitcnt vmcnt(0)
  v_readfirstlane_b32 s21, v2
  s_add_u32 s2, s21, 104
  s_cmp_lt_u32 s21, 152
  s_cbranch_scc1 RT_pub
  v_mov_b32 v2, 1
  buffer_atomic_add v2, off, s[48:51], 0 offset:0 sc0 sc1
  s_waitcnt vmcnt(0)
  v_readfirstlane_b32 s21, v2
  s_add_u32 s2, s21, 0
  s_cmp_lt_u32 s21, 104
  s_cbranch_scc1 RT_pub
  s_mov_b32 s2, 256
RT_pub:
  v_mov_b32 v2, s2
  ds_write_b32 v3, v2
  s_mov_b64 exec, -1
  s_waitcnt lgkmcnt(0)
RT_wait:
  s_barrier
  v_mov_b32 v3, 0
  ds_read_b32 v2, v3
  s_waitcnt lgkmcnt(0)
  v_readfirstlane_b32 s2, v2
  s_barrier
  s_mov_b32 s21, s2
  s_add_u32 s20, s21, 64
  s_cmp_ge_u32 s21, 0
  s_cselect_b32 s2, s20, s2
  s_sub_u32 s20, s21, 40
  s_cmp_ge_u32 s21, 40
  s_cselect_b32 s2, s20, s2
  s_add_u32 s20, s21, 144
  s_cmp_ge_u32 s21, 104
  s_cselect_b32 s2, s20, s2
  s_add_u32 s20, s21, 56
  s_cmp_ge_u32 s21, 112
  s_cselect_b32 s2, s20, s2
  s_add_u32 s20, s21, 64
  s_cmp_ge_u32 s21, 144
  s_cselect_b32 s2, s20, s2
  s_sub_u32 s20, s21, 40
  s_cmp_ge_u32 s21, 176
  s_cselect_b32 s2, s20, s2
  s_sub_u32 s20, s21, 104
  s_cmp_ge_u32 s21, 208
  s_cselect_b32 s2, s20, s2
  s_sub_u32 s20, s21, 40
  s_cmp_ge_u32 s21, 240
  s_cselect_b32 s2, s20, s2
  s_sub_u32 s20, s21, 8
  s_cmp_ge_u32 s21, 248
  s_cselect_b32 s2, s20, s2
  s_sub_u32 s20, s21, 0
  s_cmp_ge_u32 s21, 256
  s_cselect_b32 s2, s20, s2
  s_waitcnt vmcnt(0)
  s_mov_b32 s53, -1
  s_sub_u32 s20, s2, 64
  s_add_u32 s21, s20, 0
  s_cmp_lt_u32 s20, 40
  s_cselect_b32 s53, s21, s53
  s_sub_u32 s20, s2, 248
  s_add_u32 s21, s20, 40
  s_cmp_lt_u32 s20, 8
  s_cselect_b32 s53, s21, s53
  s_sub_u32 s20, s2, 104
  s_add_u32 s21, s20, 48
  s_cmp_lt_u32 s20, 32
  s_cselect_b32 s53, s21, s53
  s_sub_u32 s20, s2, 200
  s_add_u32 s21, s20, 80
  s_cmp_lt_u32 s20, 48
  s_cselect_b32 s53, s21, s53
  s_cmp_lt_u32 s53, 128
  s_cbranch_scc1 R_INIT
R_DISP:
  s_sub_u32 s20, s2, 200
  s_cmp_lt_u32 s20, 8
  s_cbranch_scc0 DL_1
  s_sleep 127
  s_sleep 127
DL_1:
  s_sub_u32 s20, s2, 240
  s_cmp_lt_u32 s20, 8
  s_cbranch_scc0 DL_2
  s_sleep 127
  s_sleep 127
DL_2:
  s_sub_u32 s17, s2, 0
  s_cmp_lt_u32 s17, 32
  s_cbranch_scc0 D_3
  s_getpc_b64 s[20:21]
P_4:
  s_add_u32 s20, s20, R_A-P_4
  s_addc_u32 s21, s21, 0
  s_setpc_b64 s[20:21]
D_3:
  s_sub_u32 s17, s2, 32
  s_cmp_lt_u32 s17, 32
  s_cbranch_scc0 D_5
  s_getpc_b64 s[20:21]
P_6:
  s_add_u32 s20, s20, R_B-P_6
  s_addc_u32 s21, s21, 0
  s_setpc_b64 s[20:21]
D_5:
  s_sub_u32 s17, s2, 64
  s_cmp_lt_u32 s17, 40
  s_cbranch_scc0 D_7
  s_getpc_b64 s[20:21]
P_8:
  s_add_u32 s20, s20, R_C-P_8
  s_addc_u32 s21, s21, 0
  s_setpc_b64 s[20:21]
D_7:
  s_sub_u32 s17, s2, 104
  s_cmp_lt_u32 s17, 104
  s_cbranch_scc0 D_9
  s_getpc_b64 s[20:21]
P_10:
  s_add_u32 s20, s20, R_T1-P_10
  s_addc_u32 s21, s21, 0
  s_setpc_b64 s[20:21]
D_9:
  s_sub_u32 s17, s2, 208
  s_cmp_lt_u32 s17, 40
  s_cbranch_scc0 D_11
  s_getpc_b64 s[20:21]
P_12:
  s_add_u32 s20, s20, R_T2-P_12
  s_addc_u32 s21, s21, 0
  s_setpc_b64 s[20:21]
D_11:
  s_sub_u32 s17, s2, 248
  s_cmp_lt_u32 s17, 8
  s_cbranch_scc0 D_13
  s_getpc_b64 s[20:21]
P_14:
  s_add_u32 s20, s20, R_POST-P_14
  s_addc_u32 s21, s21, 0
  s_setpc_b64 s[20:21]
D_13:
R_END:
  s_endpgm
R_INIT:
  s_load_dwordx2 s[8:9], s[0:1], 0
  s_mov_b32 s10, 2621440
  s_mov_b32 s11, 0x20000
  s_load_dwordx2 s[12:13], s[0:1], 8
  s_mov_b32 s14, 10240
  s_mov_b32 s15, 0x20000
  s_mov_b32 s24, s53
  s_sub_u32 s25, s53, 40
  v_lshrrev_b32 v112, 4, v0
  s_lshl_b32 s20, s24, 4
  v_add_u32 v112, s20, v112
  v_and_b32 v113, 15, v0
  v_mul_u32_u24 v3, 1280, v112
  v_lshl_add_u32 v3, v113, 4, v3
  v_lshlrev_b32 v2, 4, v0
  s_lshl_b32 s20, s25, 8
  v_add_u32 v30, s20, v0
  v_lshlrev_b32 v31, 1, v30
  s_waitcnt lgkmcnt(0)
  buffer_load_dwordx4 v[8:11], v3, s[8:11], 0 offen offset:0
  buffer_load_dwordx4 v[12:15], v3, s[8:11], 0 offen offset:256
  buffer_load_dwordx4 v[16:19], v3, s[8:11], 0 offen offset:512
  buffer_load_dwordx4 v[20:23], v3, s[8:11], 0 offen offset:768
  buffer_load_dwordx4 v[24:27], v3, s[8:11], 0 offen offset:1024
  s_cmp_lt_u32 s25, 8
  s_cbranch_scc0 I_np
  v_min_u32 v31, 1278, v31
  s_movk_i32 s21, 0
  buffer_load_ushort v92, v31, s[12:15], s21 offen
  s_movk_i32 s21, 1280
  buffer_load_ushort v93, v31, s[12:15], s21 offen
  s_movk_i32 s21, 2560
  buffer_load_ushort v94, v31, s[12:15], s21 offen
  s_movk_i32 s21, 3840
  buffer_load_ushort v95, v31, s[12:15], s21 offen
  s_movk_i32 s21, 5120
  buffer_load_ushort v96, v31, s[12:15], s21 offen
  s_movk_i32 s21, 6400
  buffer_load_ushort v97, v31, s[12:15], s21 offen
  s_movk_i32 s21, 7680
  buffer_load_ushort v98, v31, s[12:15], s21 offen
  s_movk_i32 s21, 8960
  buffer_load_ushort v99, v31, s[12:15], s21 offen
  s_lshl_b32 s21, s25, 12
  v_mov_b32 v100, 0
  v_mov_b32 v101, 0
  v_mov_b32 v102, 0
  v_mov_b32 v103, 0
  buffer_store_dwordx4 v[100:103], v2, s[4:7], s21 offen sc1
  s_add_u32 s21, s21, 0x8000
  buffer_store_dwordx4 v[100:103], v2, s[4:7], s21 offen sc1
  v_lshlrev_b32 v31, 4, v30
  v_cmp_le_u32 vcc, 320, v30
  v_add_u32 v29, 11264, v31
  v_cndmask_b32 v31, v31, v29, vcc
  v_cmp_gt_u32 vcc, 640, v30
  s_waitcnt vmcnt(2)
  v_lshl_or_b32 v104, v93, 16, v92
  v_lshl_or_b32 v105, v95, 16, v94
  v_lshl_or_b32 v106, v97, 16, v96
  v_lshl_or_b32 v107, v99, 16, v98
  s_mov_b64 exec, vcc
  s_mov_b32 s21, 65536
  buffer_store_dwordx4 v[104:107], v31, s[4:7], s21 offen sc1
  s_mov_b32 s21, 73728
  buffer_store_dwordx4 v[104:107], v31, s[4:7], s21 offen sc1
  s_mov_b64 exec, -1
I_np:
  s_lshl_b32 s20, s53, 12
  v_add_u32 v3, s20, v2
  v_mov_b32 v108, -1
  v_mov_b32 v109, -1
  v_mov_b32 v110, -1
  v_mov_b32 v111, -1
  s_mov_b32 s21, 98304
  buffer_store_dwordx4 v[108:111], v3, s[4:7], s21 offen sc1
  s_mov_b32 s21, 622592
  buffer_store_dwordx4 v[108:111], v3, s[4:7], s21 offen sc1
  s_mov_b32 s21, 1146880
  buffer_store_dwordx4 v[108:111], v3, s[4:7], s21 offen sc1
  v_cmp_gt_u32 vcc, 98304, v3
  s_mov_b64 exec, vcc
  s_mov_b32 s21, 1671168
  buffer_store_dwordx4 v[108:111], v3, s[4:7], s21 offen sc1
  s_mov_b64 exec, -1
  v_lshrrev_b32 v4, 5, v112
  v_bfe_u32 v5, v112, 2, 1
  v_lshl_add_u32 v4, v4, 1, v5
  v_mul_u32_u24 v4, 20480, v4
  v_bfe_u32 v5, v112, 3, 2
  v_and_b32 v6, 3, v112
  v_lshl_add_u32 v5, v5, 2, v6
  v_lshl_add_u32 v4, v5, 4, v4
  v_lshrrev_b32 v5, 2, v113
  v_lshl_add_u32 v4, v5, 10, v4
  v_and_b32 v5, 3, v113
  v_lshl_add_u32 v4, v5, 8, v4
  s_mov_b32 s26, 3145728
  s_waitcnt vmcnt(3)
I_loop:
  v_lshlrev_b32 v32, 16, v8
  v_and_b32 v33, 0xffff0000, v8
  v_lshlrev_b32 v34, 16, v9
  v_and_b32 v35, 0xffff0000, v9
  v_lshlrev_b32 v36, 16, v10
  v_and_b32 v37, 0xffff0000, v10
  v_lshlrev_b32 v38, 16, v11
  v_and_b32 v39, 0xffff0000, v11
  v_lshlrev_b32 v40, 16, v12
  v_and_b32 v41, 0xffff0000, v12
  v_lshlrev_b32 v42, 16, v13
  v_and_b32 v43, 0xffff0000, v13
  v_lshlrev_b32 v44, 16, v14
  v_and_b32 v45, 0xffff0000, v14
  v_lshlrev_b32 v46, 16, v15
  v_and_b32 v47, 0xffff0000, v15
  v_lshlrev_b32 v48, 16, v16
  v_and_b32 v49, 0xffff0000, v16
  v_lshlrev_b32 v50, 16, v17
  v_and_b32 v51, 0xffff0000, v17
  v_lshlrev_b32 v52, 16, v18
  v_and_b32 v53, 0xffff0000, v18
  v_lshlrev_b32 v54, 16, v19
  v_and_b32 v55, 0xffff0000, v19
  v_lshlrev_b32 v56, 16, v20
  v_and_b32 v57, 0xffff0000, v20
  v_lshlrev_b32 v58, 16, v21
  v_and_b32 v59, 0xffff0000, v21
  v_lshlrev_b32 v60, 16, v22
  v_and_b32 v61, 0xffff0000, v22
  v_lshlrev_b32 v62, 16, v23
  v_and_b32 v63, 0xffff0000, v23
  v_lshlrev_b32 v64, 16, v24
  v_and_b32 v65, 0xffff0000, v24
  v_lshlrev_b32 v66, 16, v25
  v_and_b32 v67, 0xffff0000, v25
  v_lshlrev_b32 v68, 16, v26
  v_and_b32 v69, 0xffff0000, v26
  v_lshlrev_b32 v70, 16, v27
  v_and_b32 v71, 0xffff0000, v27
  v_add_f32 v5, v32, v33
  v_add_f32 v5, v5, v34
  v_add_f32 v5, v5, v35
  v_add_f32 v5, v5, v36
  v_add_f32 v5, v5, v37
  v_add_f32 v5, v5, v38
  v_add_f32 v5, v5, v39
  v_add_f32 v5, v5, v40
  v_add_f32 v5, v5, v41
  v_add_f32 v5, v5, v42
  v_add_f32 v5, v5, v43
  v_add_f32 v5, v5, v44
  v_add_f32 v5, v5, v45
  v_add_f32 v5, v5, v46
  v_add_f32 v5, v5, v47
  v_add_f32 v5, v5, v48
  v_add_f32 v5, v5, v49
  v_add_f32 v5, v5, v50
  v_add_f32 v5, v5, v51
  v_add_f32 v5, v5, v52
  v_add_f32 v5, v5, v53
  v_add_f32 v5, v5, v54
  v_add_f32 v5, v5, v55
  v_add_f32 v5, v5, v56
  v_add_f32 v5, v5, v57
  v_add_f32 v5, v5, v58
  v_add_f32 v5, v5, v59
  v_add_f32 v5, v5, v60
  v_add_f32 v5, v5, v61
  v_add_f32 v5, v5, v62
  v_add_f32 v5, v5, v63
  v_add_f32 v5, v5, v64
  v_add_f32 v5, v5, v65
  v_add_f32 v5, v5, v66
  v_add_f32 v5, v5, v67
  v_add_f32 v5, v5, v68
  v_add_f32 v5, v5, v69
  v_add_f32 v5, v5, v70
  v_add_f32 v5, v5, v71
  s_nop 1
  v_add_f32 v5, v5, v5 row_ror:8 row_mask:0xf bank_mask:0xf
  s_nop 1
  v_add_f32 v5, v5, v5 row_ror:4 row_mask:0xf bank_mask:0xf
  s_nop 1
  v_add_f32 v5, v5, v5 row_ror:2 row_mask:0xf bank_mask:0xf
  s_nop 1
  v_add_f32 v5, v5, v5 row_ror:1 row_mask:0xf bank_mask:0xf
  v_mul_f32 v5, 0.0015625, v5
  v_sub_f32 v6, v32, v5
  v_mul_f32 v7, v6, v6
  v_sub_f32 v6, v33, v5
  v_fmac_f32 v7, v6, v6
  v_sub_f32 v6, v34, v5
  v_fmac_f32 v7, v6, v6
  v_sub_f32 v6, v35, v5
  v_fmac_f32 v7, v6, v6
  v_sub_f32 v6, v36, v5
  v_fmac_f32 v7, v6, v6
  v_sub_f32 v6, v37, v5
  v_fmac_f32 v7, v6, v6
  v_sub_f32 v6, v38, v5
  v_fmac_f32 v7, v6, v6
  v_sub_f32 v6, v39, v5
  v_fmac_f32 v7, v6, v6
  v_sub_f32 v6, v40, v5
  v_fmac_f32 v7, v6, v6
  v_sub_f32 v6, v41, v5
  v_fmac_f32 v7, v6, v6
  v_sub_f32 v6, v42, v5
  v_fmac_f32 v7, v6, v6
  v_sub_f32 v6, v43, v5
  v_fmac_f32 v7, v6, v6
  v_sub_f32 v6, v44, v5
  v_fmac_f32 v7, v6, v6
  v_sub_f32 v6, v45, v5
  v_fmac_f32 v7, v6, v6
  v_sub_f32 v6, v46, v5
  v_fmac_f32 v7, v6, v6
  v_sub_f32 v6, v47, v5
  v_fmac_f32 v7, v6, v6
  v_sub_f32 v6, v48, v5
  v_fmac_f32 v7, v6, v6
  v_sub_f32 v6, v49, v5
  v_fmac_f32 v7, v6, v6
  v_sub_f32 v6, v50, v5
  v_fmac_f32 v7, v6, v6
  v_sub_f32 v6, v51, v5
  v_fmac_f32 v7, v6, v6
  v_sub_f32 v6, v52, v5
  v_fmac_f32 v7, v6, v6
  v_sub_f32 v6, v53, v5
  v_fmac_f32 v7, v6, v6
  v_sub_f32 v6, v54, v5
  v_fmac_f32 v7, v6, v6
  v_sub_f32 v6, v55, v5
  v_fmac_f32 v7, v6, v6
  v_sub_f32 v6, v56, v5
  v_fmac_f32 v7, v6, v6
  v_sub_f32 v6, v57, v5
  v_fmac_f32 v7, v6, v6
  v_sub_f32 v6, v58, v5
  v_fmac_f32 v7, v6, v6
  v_sub_f32 v6, v59, v5
  v_fmac_f32 v7, v6, v6
  v_sub_f32 v6, v60, v5
  v_fmac_f32 v7, v6, v6
  v_sub_f32 v6, v61, v5
  v_fmac_f32 v7, v6, v6
  v_sub_f32 v6, v62, v5
  v_fmac_f32 v7, v6, v6
  v_sub_f32 v6, v63, v5
  v_fmac_f32 v7, v6, v6
  v_sub_f32 v6, v64, v5
  v_fmac_f32 v7, v6, v6
  v_sub_f32 v6, v65, v5
  v_fmac_f32 v7, v6, v6
  v_sub_f32 v6, v66, v5
  v_fmac_f32 v7, v6, v6
  v_sub_f32 v6, v67, v5
  v_fmac_f32 v7, v6, v6
  v_sub_f32 v6, v68, v5
  v_fmac_f32 v7, v6, v6
  v_sub_f32 v6, v69, v5
  v_fmac_f32 v7, v6, v6
  v_sub_f32 v6, v70, v5
  v_fmac_f32 v7, v6, v6
  v_sub_f32 v6, v71, v5
  v_fmac_f32 v7, v6, v6
  s_nop 1
  v_add_f32 v7, v7, v7 row_ror:8 row_mask:0xf bank_mask:0xf
  s_nop 1
  v_add_f32 v7, v7, v7 row_ror:4 row_mask:0xf bank_mask:0xf
  s_nop 1
  v_add_f32 v7, v7, v7 row_ror:2 row_mask:0xf bank_mask:0xf
  s_nop 1
  v_add_f32 v7, v7, v7 row_ror:1 row_mask:0xf bank_mask:0xf
  v_mul_f32 v7, 0.0015625, v7
  v_cvt_pk_bf16_f32 v5, v5, v7
  v_and_b32 v7, 0xffff0000, v5
  v_lshlrev_b32 v5, 16, v5
  v_add_f32 v7, 0x3727c5ac, v7
  v_cvt_pk_bf16_f32 v7, v7, v7
  v_and_b32 v7, 0xffff0000, v7
  v_sqrt_f32 v7, v7
  s_nop 0
  v_cvt_pk_bf16_f32 v7, v7, v7
  v_and_b32 v7, 0xffff0000, v7
  v_rcp_f32 v6, v7
  s_nop 0
  v_fma_f32 v28, -v7, v6, 1.0
  v_fmac_f32 v6, v28, v6
  v_sub_f32 v32, v32, v5
  v_sub_f32 v33, v33, v5
  v_cvt_pk_bf16_f32 v33, v32, v33
  v_lshlrev_b32 v32, 16, v33
  v_and_b32 v33, 0xffff0000, v33
  v_mul_f32 v28, v32, v6
  v_mul_f32 v29, v33, v6
  v_fma_f32 v32, -v28, v7, v32
  v_fma_f32 v33, -v29, v7, v33
  v_fmac_f32 v28, v32, v6
  v_fmac_f32 v29, v33, v6
  v_cvt_pk_bf16_f32 v8, v28, v29
  v_sub_f32 v34, v34, v5
  v_sub_f32 v35, v35, v5
  v_cvt_pk_bf16_f32 v35, v34, v35
  v_lshlrev_b32 v34, 16, v35
  v_and_b32 v35, 0xffff0000, v35
  v_mul_f32 v28, v34, v6
  v_mul_f32 v29, v35, v6
  v_fma_f32 v34, -v28, v7, v34
  v_fma_f32 v35, -v29, v7, v35
  v_fmac_f32 v28, v34, v6
  v_fmac_f32 v29, v35, v6
  v_cvt_pk_bf16_f32 v9, v28, v29
  v_sub_f32 v36, v36, v5
  v_sub_f32 v37, v37, v5
  v_cvt_pk_bf16_f32 v37, v36, v37
  v_lshlrev_b32 v36, 16, v37
  v_and_b32 v37, 0xffff0000, v37
  v_mul_f32 v28, v36, v6
  v_mul_f32 v29, v37, v6
  v_fma_f32 v36, -v28, v7, v36
  v_fma_f32 v37, -v29, v7, v37
  v_fmac_f32 v28, v36, v6
  v_fmac_f32 v29, v37, v6
  v_cvt_pk_bf16_f32 v10, v28, v29
  v_sub_f32 v38, v38, v5
  v_sub_f32 v39, v39, v5
  v_cvt_pk_bf16_f32 v39, v38, v39
  v_lshlrev_b32 v38, 16, v39
  v_and_b32 v39, 0xffff0000, v39
  v_mul_f32 v28, v38, v6
  v_mul_f32 v29, v39, v6
  v_fma_f32 v38, -v28, v7, v38
  v_fma_f32 v39, -v29, v7, v39
  v_fmac_f32 v28, v38, v6
  v_fmac_f32 v29, v39, v6
  v_cvt_pk_bf16_f32 v11, v28, v29
  v_sub_f32 v40, v40, v5
  v_sub_f32 v41, v41, v5
  v_cvt_pk_bf16_f32 v41, v40, v41
  v_lshlrev_b32 v40, 16, v41
  v_and_b32 v41, 0xffff0000, v41
  v_mul_f32 v28, v40, v6
  v_mul_f32 v29, v41, v6
  v_fma_f32 v40, -v28, v7, v40
  v_fma_f32 v41, -v29, v7, v41
  v_fmac_f32 v28, v40, v6
  v_fmac_f32 v29, v41, v6
  v_cvt_pk_bf16_f32 v12, v28, v29
  v_sub_f32 v42, v42, v5
  v_sub_f32 v43, v43, v5
  v_cvt_pk_bf16_f32 v43, v42, v43
  v_lshlrev_b32 v42, 16, v43
  v_and_b32 v43, 0xffff0000, v43
  v_mul_f32 v28, v42, v6
  v_mul_f32 v29, v43, v6
  v_fma_f32 v42, -v28, v7, v42
  v_fma_f32 v43, -v29, v7, v43
  v_fmac_f32 v28, v42, v6
  v_fmac_f32 v29, v43, v6
  v_cvt_pk_bf16_f32 v13, v28, v29
  v_sub_f32 v44, v44, v5
  v_sub_f32 v45, v45, v5
  v_cvt_pk_bf16_f32 v45, v44, v45
  v_lshlrev_b32 v44, 16, v45
  v_and_b32 v45, 0xffff0000, v45
  v_mul_f32 v28, v44, v6
  v_mul_f32 v29, v45, v6
  v_fma_f32 v44, -v28, v7, v44
  v_fma_f32 v45, -v29, v7, v45
  v_fmac_f32 v28, v44, v6
  v_fmac_f32 v29, v45, v6
  v_cvt_pk_bf16_f32 v14, v28, v29
  v_sub_f32 v46, v46, v5
  v_sub_f32 v47, v47, v5
  v_cvt_pk_bf16_f32 v47, v46, v47
  v_lshlrev_b32 v46, 16, v47
  v_and_b32 v47, 0xffff0000, v47
  v_mul_f32 v28, v46, v6
  v_mul_f32 v29, v47, v6
  v_fma_f32 v46, -v28, v7, v46
  v_fma_f32 v47, -v29, v7, v47
  v_fmac_f32 v28, v46, v6
  v_fmac_f32 v29, v47, v6
  v_cvt_pk_bf16_f32 v15, v28, v29
  v_sub_f32 v48, v48, v5
  v_sub_f32 v49, v49, v5
  v_cvt_pk_bf16_f32 v49, v48, v49
  v_lshlrev_b32 v48, 16, v49
  v_and_b32 v49, 0xffff0000, v49
  v_mul_f32 v28, v48, v6
  v_mul_f32 v29, v49, v6
  v_fma_f32 v48, -v28, v7, v48
  v_fma_f32 v49, -v29, v7, v49
  v_fmac_f32 v28, v48, v6
  v_fmac_f32 v29, v49, v6
  v_cvt_pk_bf16_f32 v16, v28, v29
  v_sub_f32 v50, v50, v5
  v_sub_f32 v51, v51, v5
  v_cvt_pk_bf16_f32 v51, v50, v51
  v_lshlrev_b32 v50, 16, v51
  v_and_b32 v51, 0xffff0000, v51
  v_mul_f32 v28, v50, v6
  v_mul_f32 v29, v51, v6
  v_fma_f32 v50, -v28, v7, v50
  v_fma_f32 v51, -v29, v7, v51
  v_fmac_f32 v28, v50, v6
  v_fmac_f32 v29, v51, v6
  v_cvt_pk_bf16_f32 v17, v28, v29
  v_sub_f32 v52, v52, v5
  v_sub_f32 v53, v53, v5
  v_cvt_pk_bf16_f32 v53, v52, v53
  v_lshlrev_b32 v52, 16, v53
  v_and_b32 v53, 0xffff0000, v53
  v_mul_f32 v28, v52, v6
  v_mul_f32 v29, v53, v6
  v_fma_f32 v52, -v28, v7, v52
  v_fma_f32 v53, -v29, v7, v53
  v_fmac_f32 v28, v52, v6
  v_fmac_f32 v29, v53, v6
  v_cvt_pk_bf16_f32 v18, v28, v29
  v_sub_f32 v54, v54, v5
  v_sub_f32 v55, v55, v5
  v_cvt_pk_bf16_f32 v55, v54, v55
  v_lshlrev_b32 v54, 16, v55
  v_and_b32 v55, 0xffff0000, v55
  v_mul_f32 v28, v54, v6
  v_mul_f32 v29, v55, v6
  v_fma_f32 v54, -v28, v7, v54
  v_fma_f32 v55, -v29, v7, v55
  v_fmac_f32 v28, v54, v6
  v_fmac_f32 v29, v55, v6
  v_cvt_pk_bf16_f32 v19, v28, v29
  v_sub_f32 v56, v56, v5
  v_sub_f32 v57, v57, v5
  v_cvt_pk_bf16_f32 v57, v56, v57
  v_lshlrev_b32 v56, 16, v57
  v_and_b32 v57, 0xffff0000, v57
  v_mul_f32 v28, v56, v6
  v_mul_f32 v29, v57, v6
  v_fma_f32 v56, -v28, v7, v56
  v_fma_f32 v57, -v29, v7, v57
  v_fmac_f32 v28, v56, v6
  v_fmac_f32 v29, v57, v6
  v_cvt_pk_bf16_f32 v20, v28, v29
  v_sub_f32 v58, v58, v5
  v_sub_f32 v59, v59, v5
  v_cvt_pk_bf16_f32 v59, v58, v59
  v_lshlrev_b32 v58, 16, v59
  v_and_b32 v59, 0xffff0000, v59
  v_mul_f32 v28, v58, v6
  v_mul_f32 v29, v59, v6
  v_fma_f32 v58, -v28, v7, v58
  v_fma_f32 v59, -v29, v7, v59
  v_fmac_f32 v28, v58, v6
  v_fmac_f32 v29, v59, v6
  v_cvt_pk_bf16_f32 v21, v28, v29
  v_sub_f32 v60, v60, v5
  v_sub_f32 v61, v61, v5
  v_cvt_pk_bf16_f32 v61, v60, v61
  v_lshlrev_b32 v60, 16, v61
  v_and_b32 v61, 0xffff0000, v61
  v_mul_f32 v28, v60, v6
  v_mul_f32 v29, v61, v6
  v_fma_f32 v60, -v28, v7, v60
  v_fma_f32 v61, -v29, v7, v61
  v_fmac_f32 v28, v60, v6
  v_fmac_f32 v29, v61, v6
  v_cvt_pk_bf16_f32 v22, v28, v29
  v_sub_f32 v62, v62, v5
  v_sub_f32 v63, v63, v5
  v_cvt_pk_bf16_f32 v63, v62, v63
  v_lshlrev_b32 v62, 16, v63
  v_and_b32 v63, 0xffff0000, v63
  v_mul_f32 v28, v62, v6
  v_mul_f32 v29, v63, v6
  v_fma_f32 v62, -v28, v7, v62
  v_fma_f32 v63, -v29, v7, v63
  v_fmac_f32 v28, v62, v6
  v_fmac_f32 v29, v63, v6
  v_cvt_pk_bf16_f32 v23, v28, v29
  v_sub_f32 v64, v64, v5
  v_sub_f32 v65, v65, v5
  v_cvt_pk_bf16_f32 v65, v64, v65
  v_lshlrev_b32 v64, 16, v65
  v_and_b32 v65, 0xffff0000, v65
  v_mul_f32 v28, v64, v6
  v_mul_f32 v29, v65, v6
  v_fma_f32 v64, -v28, v7, v64
  v_fma_f32 v65, -v29, v7, v65
  v_fmac_f32 v28, v64, v6
  v_fmac_f32 v29, v65, v6
  v_cvt_pk_bf16_f32 v24, v28, v29
  v_sub_f32 v66, v66, v5
  v_sub_f32 v67, v67, v5
  v_cvt_pk_bf16_f32 v67, v66, v67
  v_lshlrev_b32 v66, 16, v67
  v_and_b32 v67, 0xffff0000, v67
  v_mul_f32 v28, v66, v6
  v_mul_f32 v29, v67, v6
  v_fma_f32 v66, -v28, v7, v66
  v_fma_f32 v67, -v29, v7, v67
  v_fmac_f32 v28, v66, v6
  v_fmac_f32 v29, v67, v6
  v_cvt_pk_bf16_f32 v25, v28, v29
  v_sub_f32 v68, v68, v5
  v_sub_f32 v69, v69, v5
  v_cvt_pk_bf16_f32 v69, v68, v69
  v_lshlrev_b32 v68, 16, v69
  v_and_b32 v69, 0xffff0000, v69
  v_mul_f32 v28, v68, v6
  v_mul_f32 v29, v69, v6
  v_fma_f32 v68, -v28, v7, v68
  v_fma_f32 v69, -v29, v7, v69
  v_fmac_f32 v28, v68, v6
  v_fmac_f32 v29, v69, v6
  v_cvt_pk_bf16_f32 v26, v28, v29
  v_sub_f32 v70, v70, v5
  v_sub_f32 v71, v71, v5
  v_cvt_pk_bf16_f32 v71, v70, v71
  v_lshlrev_b32 v70, 16, v71
  v_and_b32 v71, 0xffff0000, v71
  v_mul_f32 v28, v70, v6
  v_mul_f32 v29, v71, v6
  v_fma_f32 v70, -v28, v7, v70
  v_fma_f32 v71, -v29, v7, v71
  v_fmac_f32 v28, v70, v6
  v_fmac_f32 v29, v71, v6
  v_cvt_pk_bf16_f32 v27, v28, v29
  s_mov_b32 s20, s26
  buffer_store_dwordx4 v[8:11], v4, s[4:7], s20 offen sc1
  s_add_u32 s20, s20, 4096
  buffer_store_dwordx4 v[12:15], v4, s[4:7], s20 offen sc1
  s_add_u32 s20, s20, 4096
  buffer_store_dwordx4 v[16:19], v4, s[4:7], s20 offen sc1
  s_add_u32 s20, s20, 4096
  buffer_store_dwordx4 v[20:23], v4, s[4:7], s20 offen sc1
  s_add_u32 s20, s20, 4096
  buffer_store_dwordx4 v[24:27], v4, s[4:7], s20 offen sc1
  s_add_u32 s20, s20, 4096
  s_waitcnt vmcnt(0)
  s_barrier
  v_mov_b32 v3, 0
  s_mov_b64 exec, 1
  s_mov_b32 s20, 1
  s_cmp_eq_u32 s16, 0
  s_cbranch_scc0 I_nd
  v_mov_b32 v4, s20
  buffer_atomic_add v4, off, s[48:51], 0 offset:136 sc0 sc1
  s_waitcnt vmcnt(0)
  v_readfirstlane_b32 s21, v4
  s_add_u32 s21, s21, s20
  s_and_b32 s22, s21, 0xff
  s_cmp_eq_u32 s22, 128
  s_cbranch_scc0 DA_16
  s_cmp_eq_u32 s20, 1
  s_cbranch_scc0 DA_15
  v_mov_b32 v4, 1
  buffer_store_dword v4, off, s[48:51], 0 offset:8 sc1
DA_15:
  s_and_b32 s22, s21, 0xff00
  s_cmp_eq_u32 s22, 16384
  s_cbranch_scc0 DA_16
  s_cmp_gt_i32 s21, 0xffff
  s_cselect_b32 s21, 8193, 1
  v_mov_b32 v5, s21
  buffer_store_dword v5, off, s[48:51], 0 offset:12 sc1
DA_16:
I_nd:
  s_sub_u32 s33, s53, 24
  s_sub_u32 s34, s53, 32
  s_cmp_lt_u32 s25, 8
  s_cselect_b32 s33, s34, s33
  s_cselect_b32 s34, 0, s33
  s_cmp_lt_u32 s34, 8
  s_cbranch_scc0 I_npr
  s_mov_b64 exec, 1
  s_lshl_b32 s33, s33, 2
  s_add_u32 s33, s33, s16
  s_lshl_b32 s35, s33, 7
  s_add_u32 s33, s35, 1835008
  s_add_u32 s34, s33, 8192
  s_mov_b32 s30, 0xffffff
  s_mov_b32 s31, 0xffffff
  v_mov_b32 v4, 0
  v_mov_b32 v5, 0
  buffer_atomic_add v4, off, s[4:7], s33 sc0 sc1
  buffer_atomic_add v5, off, s[4:7], s34 sc0 sc1
  s_waitcnt vmcnt(0)
  v_mov_b32 v4, 0
  s_memtime s[26:27]
  s_waitcnt lgkmcnt(0)
  buffer_atomic_add v4, off, s[4:7], s33 sc0 sc1
  s_waitcnt vmcnt(0)
  s_memtime s[28:29]
  s_waitcnt lgkmcnt(0)
  s_sub_u32 s28, s28, s26
  s_min_u32 s30, s30, s28
  v_mov_b32 v4, 0
  s_memtime s[26:27]
  s_waitcnt lgkmcnt(0)
  buffer_atomic_add v4, off, s[4:7], s34 sc0 sc1
  s_waitcnt vmcnt(0)
  s_memtime s[28:29]
  s_waitcnt lgkmcnt(0)
  s_sub_u32 s28, s28, s26
  s_min_u32 s31, s31, s28
  v_mov_b32 v4, 0
  s_memtime s[26:27]
  s_waitcnt lgkmcnt(0)
  buffer_atomic_add v4, off, s[4:7], s34 sc0 sc1
  s_waitcnt vmcnt(0)
  s_memtime s[28:29]
  s_waitcnt lgkmcnt(0)
  s_sub_u32 s28, s28, s26
  s_min_u32 s31, s31, s28
  v_mov_b32 v4, 0
  s_memtime s[26:27]
  s_waitcnt lgkmcnt(0)
  buffer_atomic_add v4, off, s[4:7], s33 sc0 sc1
  s_waitcnt vmcnt(0)
  s_memtime s[28:29]
  s_waitcnt lgkmcnt(0)
  s_sub_u32 s28, s28, s26
  s_min_u32 s30, s30, s28
  v_mov_b32 v4, 0
  s_memtime s[26:27]
  s_waitcnt lgkmcnt(0)
  buffer_atomic_add v4, off, s[4:7], s33 sc0 sc1
  s_waitcnt vmcnt(0)
  s_memtime s[28:29]
  s_waitcnt lgkmcnt(0)
  s_sub_u32 s28, s28, s26
  s_min_u32 s30, s30, s28
  v_mov_b32 v4, 0
  s_memtime s[26:27]
  s_waitcnt lgkmcnt(0)
  buffer_atomic_add v4, off, s[4:7], s34 sc0 sc1
  s_waitcnt vmcnt(0)
  s_memtime s[28:29]
  s_waitcnt lgkmcnt(0)
  s_sub_u32 s28, s28, s26
  s_min_u32 s31, s31, s28
  s_getreg_b32 s20, hwreg(HW_REG_XCC_ID)
  s_sub_i32 s22, s30, s31
  s_sub_i32 s21, s31, s30
  s_bitcmp1_b32 s20, 2
  s_cselect_b32 s20, s21, s22
  s_ashr_i32 s20, s20, 1
  s_min_i32 s20, s20, 255
  s_max_i32 s20, s20, -255
  s_lshl_b32 s20, s20, 16
  s_add_u32 s20, s20, 0x100
  v_mov_b32 v4, s20
  buffer_atomic_add v4, off, s[48:51], 0 offset:136 sc0 sc1
  s_waitcnt vmcnt(0)
  v_readfirstlane_b32 s21, v4
  s_add_u32 s21, s21, s20
  s_and_b32 s22, s21, 0xff
  s_cmp_eq_u32 s22, 128
  s_cbranch_scc0 DA_18
  s_cmp_eq_u32 s20, 1
  s_cbranch_scc0 DA_17
  v_mov_b32 v4, 1
  buffer_store_dword v4, off, s[48:51], 0 offset:8 sc1
DA_17:
  s_and_b32 s22, s21, 0xff00
  s_cmp_eq_u32 s22, 16384
  s_cbranch_scc0 DA_18
  s_cmp_gt_i32 s21, 0xffff
  s_cselect_b32 s21, 8193, 1
  v_mov_b32 v5, s21
  buffer_store_dword v5, off, s[48:51], 0 offset:12 sc1
DA_18:
  s_mov_b64 exec, -1
I_npr:
  s_mov_b64 exec, -1
  s_cmp_ge_u32 s53, 48
  s_cbranch_scc1 R_DISP
  s_sleep 100
  s_cmp_eq_u32 s16, 0
  s_cbranch_scc0 DI_19
  buffer_load_dwordx2 v[2:3], off, s[48:51], 0 offset:8 sc1
DI_19:
  s_cmp_eq_u32 s16, 0
  s_cbranch_scc0 DC_22
  s_mov_b32 s22, 0
DC_20:
  s_waitcnt vmcnt(0)
  v_readfirstlane_b32 s20, v2
  v_readfirstlane_b32 s21, v3
  s_cmp_lg_u32 s21, 0
  s_cbranch_scc1 DC_21
DC_23:
  s_add_u32 s22, s22, 1
  s_cmp_gt_u32 s22, 200000
  s_cbranch_scc1 DC_21
  s_sleep 16
  buffer_load_dwordx2 v[2:3], off, s[48:51], 0 offset:8 sc1
  s_branch DC_20
DC_21:
  s_and_b32 s21, s21, 8192
  v_mov_b32 v2, s21
  v_mov_b32 v3, 163824
  ds_write_b32 v3, v2
  s_waitcnt lgkmcnt(0)
DC_22:
  s_barrier
  v_mov_b32 v3, 163824
  ds_read_b32 v2, v3
  s_waitcnt lgkmcnt(0)
  v_readfirstlane_b32 s52, v2
  s_branch R_DISP
R_C:
  v_lshlrev_b32 v2, 4, v1
  v_and_b32 v20, 15, v1
  v_lshrrev_b32 v21, 4, v1
  v_lshlrev_b32 v3, 6, v20
  v_lshl_add_u32 v3, v21, 4, v3
  v_lshlrev_b32 v5, 4, v20
  v_and_b32 v22, 1, v21
  v_lshl_add_u32 v5, v22, 3, v5
  v_lshrrev_b32 v22, 1, v21
  v_lshl_add_u32 v5, v22, 2, v5
  s_lshl_b32 s20, s17, 8
  s_cmp_ge_u32 s17, 20
  s_cselect_b32 s21, 11264, 0
  s_add_u32 s20, s20, s21
  s_add_u32 s20, s20, s52
  v_add_u32 v5, s20, v5
  v_lshlrev_b32 v6, 4, v1
  v_add_u32 v6, 98304, v6
  v_lshrrev_b32 v8, 2, v1
  v_lshlrev_b32 v8, 7, v8
  v_and_b32 v22, 3, v1
  v_lshl_add_u32 v8, v22, 2, v8
  v_mov_b32 v10, -1
  v_mov_b32 v7, 0
  v_mov_b32 v9, 0
  s_and_b32 s22, s16, 1
  s_lshl_b32 s23, s22, 14
  s_mov_b32 s30, 0
  s_mov_b32 s32, 0
  s_mov_b32 s33, 0
  v_and_b32 v20, 8, v1
  v_cmp_eq_u32 vcc, 0, v20
  v_mov_b32 v4, 0xeeee
  v_mov_b32 v20, 0x4444
  v_cndmask_b32 v4, v4, v20, vcc
  s_cmp_ge_u32 s16, 2
  s_cbranch_scc1 C_pf
  s_lshl_b32 s35, s22, 11
  s_add_u32 s35, s35, 32768
  s_lshl_b32 s36, s17, 14
  s_lshl_b32 s20, s22, 12
  s_add_u32 s36, s36, s20
  s_add_u32 s36, s36, s52
  s_add_u32 s35, s35, s52
  s_add_u32 s34, s23, s52
  s_mov_b32 s37, 196608
  s_mov_b32 s38, 458752
  s_mov_b32 s27, 98304
  v_lshlrev_b32 v136, 7, v1
  s_add_u32 s89, s52, 49152
  s_add_u32 s83, s52, 32768
  s_mov_b32 s84, 76
  s_mov_b32 s85, 0
  s_mov_b32 s90, 0
  s_mov_b32 s91, 0
  s_memrealtime s[92:93]
  s_waitcnt lgkmcnt(0)
  s_mov_b32 s94, s92
  s_mov_b32 s95, s92
  s_lshl_b32 s20, s17, 7
  s_add_u32 s83, s83, s20
  s_cmp_eq_u32 s16, 0
  s_cselect_b64 s[42:43], 1, 0
C_loop:
  s_barrier
  s_add_u32 s20, s33, s23
  v_add_u32 v11, s20, v2
  ds_read_b128 v[72:75], v11 offset:0
  ds_read_b128 v[76:79], v11 offset:1024
  ds_read_b128 v[80:83], v11 offset:2048
  ds_read_b128 v[84:87], v11 offset:3072
  ds_read_b128 v[88:91], v11 offset:4096
  ds_read_b128 v[92:95], v11 offset:5120
  ds_read_b128 v[96:99], v11 offset:6144
  ds_read_b128 v[100:103], v11 offset:7168
  ds_read_b128 v[104:107], v11 offset:8192
  ds_read_b128 v[108:111], v11 offset:9216
  ds_read_b128 v[112:115], v11 offset:10240
  ds_read_b128 v[116:119], v11 offset:11264
  ds_read_b128 v[120:123], v11 offset:12288
  ds_read_b128 v[124:127], v11 offset:13312
  ds_read_b128 v[128:131], v11 offset:14336
  ds_read_b128 v[132:135], v11 offset:15360
  v_mov_b32 v12, 0
  v_mov_b32 v144, 0
  v_mov_b32 v13, 0
  v_mov_b32 v145, 0
  v_mov_b32 v14, 0
  v_mov_b32 v146, 0
  v_mov_b32 v15, 0
  v_mov_b32 v147, 0
  s_add_u32 s24, s37, s34
  s_add_u32 s21, s24, 4096
  s_add_u32 s25, s37, s35
  s_add_u32 s26, s38, s36
  s_waitcnt lgkmcnt(0)
  s_add_u32 s88, s30, 1
W_24:
  s_memrealtime s[92:93]
  s_waitcnt lgkmcnt(0)
  s_sub_u32 s93, s95, s92
  s_cmp_gt_i32 s93, 0
  s_cbranch_scc1 W_24
  v_mov_b32 v20, s84
  s_mov_b64 exec, s[42:43]
  buffer_store_dword v20, off, s[4:7], s83 sc1
  s_mov_b64 exec, -1
H_25:
  buffer_load_dwordx2 v[16:17], v136, s[4:7], s89 offen sc1
  s_waitcnt vmcnt(0)
  v_subrev_u32 v18, s88, v16
  v_subrev_u32 v19, s88, v17
  v_or_b32 v18, v18, v19
  v_and_b32 v18, 62, v18
  v_cmp_ne_u32 vcc, 0, v18
  s_cbranch_vccz H_26
  s_add_u32 s32, s32, 1
  s_cmp_gt_u32 s32, 200000
  s_cbranch_scc1 H_26
  s_add_u32 s90, s90, 1
  s_sleep 4
  s_branch H_25
H_26:
  s_lshl_b32 s93, s92, 6
  v_subrev_u32 v16, s93, v16
  v_subrev_u32 v17, s93, v17
  v_max_i32 v16, v16, v17
  v_ashrrev_i32 v16, 6, v16
  s_nop 1
  v_max_i32 v16, v16, v16 row_ror:8 row_mask:0xf bank_mask:0xf
  s_nop 1
  v_max_i32 v16, v16, v16 row_ror:4 row_mask:0xf bank_mask:0xf
  s_nop 1
  v_max_i32 v16, v16, v16 row_ror:2 row_mask:0xf bank_mask:0xf
  s_nop 1
  v_max_i32 v16, v16, v16 row_ror:1 row_mask:0xf bank_mask:0xf
  s_nop 1
  v_readlane_b32 s96, v16, 0
  v_readlane_b32 s93, v16, 16
  s_max_i32 s96, s96, s93
  v_readlane_b32 s97, v16, 32
  v_readlane_b32 s93, v16, 48
  s_max_i32 s97, s97, s93
  s_add_u32 s93, s97, 4
  s_max_i32 s96, s96, s93
  s_min_i32 s96, s96, 2000
  s_add_u32 s96, s96, s92
  s_min_i32 s97, s97, 2000
  s_add_u32 s97, s97, s92
  s_add_u32 s94, s97, 16
  s_add_u32 s95, s96, 99
  s_add_u32 s95, s95, s84
  s_mov_b32 s85, 0
W_27:
  s_memrealtime s[92:93]
  s_waitcnt lgkmcnt(0)
  s_sub_u32 s93, s94, s92
  s_cmp_gt_i32 s93, 0
  s_cbranch_scc1 W_27
C_pollv:
  buffer_load_dwordx4 v[56:59], v2, s[4:7], s26 offen offset:0 sc1
  buffer_load_dwordx4 v[60:63], v2, s[4:7], s26 offen offset:1024 sc1
  buffer_load_dwordx4 v[64:67], v2, s[4:7], s26 offen offset:2048 sc1
  buffer_load_dwordx4 v[68:71], v2, s[4:7], s26 offen offset:3072 sc1
  s_add_u32 s94, s96, 12
W_28:
  s_memrealtime s[92:93]
  s_waitcnt lgkmcnt(0)
  s_sub_u32 s93, s94, s92
  s_cmp_gt_i32 s93, 0
  s_cbranch_scc1 W_28
  s_mov_b32 s81, s92
  buffer_load_dwordx4 v[48:51], v2, s[4:7], s25 offen offset:0 sc1
  buffer_load_dwordx4 v[52:55], v2, s[4:7], s25 offen offset:1024 sc1
  buffer_load_dwordx4 v[16:19], v2, s[4:7], s24 offen offset:0 sc1
  buffer_load_dwordx4 v[20:23], v2, s[4:7], s24 offen offset:1024 sc1
  buffer_load_dwordx4 v[24:27], v2, s[4:7], s24 offen offset:2048 sc1
  buffer_load_dwordx4 v[28:31], v2, s[4:7], s24 offen offset:3072 sc1
  buffer_load_dwordx4 v[32:35], v2, s[4:7], s21 offen offset:0 sc1
  buffer_load_dwordx4 v[36:39], v2, s[4:7], s21 offen offset:1024 sc1
  buffer_load_dwordx4 v[40:43], v2, s[4:7], s21 offen offset:2048 sc1
  buffer_load_dwordx4 v[44:47], v2, s[4:7], s21 offen offset:3072 sc1
  s_waitcnt vmcnt(10)
  v_max3_u32 v9, v56, v58, v60
  v_max3_u32 v9, v9, v62, v64
  v_max3_u32 v9, v9, v66, v68
  v_max_u32 v9, v9, v70
  s_waitcnt vmcnt(9)
  v_smfmac_f32_16x16x64_bf16 v[144:147], v[48:51], v[56:63], v4
  v_max3_u32 v9, v9, v48, v50
  s_waitcnt vmcnt(8)
  v_smfmac_f32_16x16x64_bf16 v[12:15], v[52:55], v[64:71], v4
  v_max3_u32 v9, v9, v52, v54
  s_waitcnt vmcnt(7)
  v_smfmac_f32_16x16x64_bf16 v[144:147], v[16:19], v[72:79], v4
  v_max3_u32 v9, v9, v16, v18
  s_waitcnt vmcnt(6)
  v_smfmac_f32_16x16x64_bf16 v[12:15], v[20:23], v[80:87], v4
  v_max3_u32 v9, v9, v20, v22
  s_waitcnt vmcnt(5)
  v_smfmac_f32_16x16x64_bf16 v[144:147], v[24:27], v[88:95], v4
  v_max3_u32 v9, v9, v24, v26
  s_waitcnt vmcnt(4)
  v_smfmac_f32_16x16x64_bf16 v[12:15], v[28:31], v[96:103], v4
  v_max3_u32 v9, v9, v28, v30
  s_waitcnt vmcnt(3)
  v_smfmac_f32_16x16x64_bf16 v[144:147], v[32:35], v[104:111], v4
  v_max3_u32 v9, v9, v32, v34
  s_waitcnt vmcnt(2)
  v_smfmac_f32_16x16x64_bf16 v[12:15], v[36:39], v[112:119], v4
  v_max3_u32 v9, v9, v36, v38
  s_waitcnt vmcnt(1)
  v_smfmac_f32_16x16x64_bf16 v[144:147], v[40:43], v[120:127], v4
  v_max3_u32 v9, v9, v40, v42
  s_waitcnt vmcnt(0)
  v_smfmac_f32_16x16x64_bf16 v[12:15], v[44:47], v[128:135], v4
  v_max3_u32 v9, v9, v44, v46
  v_cmp_eq_u32 vcc, -1, v9
  s_cbranch_vccz C_go
  s_add_u32 s32, s32, 1
  s_cmp_gt_u32 s32, 200000
  s_cbranch_scc1 C_go
  s_nop 7
  v_mov_b32 v12, 0
  v_mov_b32 v144, 0
  v_mov_b32 v13, 0
  v_mov_b32 v145, 0
  v_mov_b32 v14, 0
  v_mov_b32 v146, 0
  v_mov_b32 v15, 0
  v_mov_b32 v147, 0
  s_add_u32 s91, s91, 1
  s_sleep 6
  s_mov_b32 s85, 1
  s_branch C_pollv
C_go:
  s_cmp_eq_u32 s16, 0
  s_nop 0
  v_permlane32_swap_b32 v144, v146
  v_permlane32_swap_b32 v145, v147
  s_nop 0
  v_pk_add_f32 v[144:145], v[144:145], v[146:147]
  v_permlane32_swap_b32 v12, v14
  v_permlane32_swap_b32 v13, v15
  s_nop 0
  v_pk_add_f32 v[12:13], v[12:13], v[14:15]
  v_pk_add_f32 v[12:13], v[12:13], v[144:145]
  s_cbranch_scc1 C_w0
  v_mov_b32 v14, s85
  ds_write_b128 v6, v[12:15]
  s_waitcnt lgkmcnt(0)
  s_barrier
  s_branch C_next
C_w0:
  s_barrier
  ds_read_b128 v[16:19], v6
  s_waitcnt lgkmcnt(0)
  v_pk_add_f32 v[12:13], v[12:13], v[16:17]
  v_cvt_pk_bf16_f32 v12, v12, v13
  buffer_store_dword v12, v5, s[4:7], s27 offen sc1
  s_memrealtime s[92:93]
  s_waitcnt lgkmcnt(0)
  v_readfirstlane_b32 s93, v18
  s_or_b32 s85, s85, s93
  s_sub_u32 s93, s92, s81
  s_add_u32 s82, s84, 20
  s_cmp_gt_i32 s93, s82
  s_cselect_b32 s93, s84, s93
  s_sub_u32 s82, s84, 1
  s_max_i32 s93, s93, s82
  s_add_u32 s82, s84, 6
  s_min_i32 s93, s93, s82
  s_cmp_eq_u32 s85, 0
  s_cselect_b32 s84, s93, s84
C_next:
  s_add_u32 s27, s27, 32768
  s_cmp_eq_u32 s27, 196608
  s_cselect_b32 s27, 65536, s27
  s_add_u32 s37, s37, 65536
  s_cmp_eq_u32 s37, 458752
  s_cselect_b32 s37, 196608, s37
  s_add_u32 s38, s38, 655360
  s_cmp_eq_u32 s38, 1769472
  s_cselect_b32 s38, 458752, s38
  s_add_u32 s33, s33, 32768
  s_cmp_eq_u32 s33, 98304
  s_cselect_b32 s33, 0, s33
  s_add_u32 s30, s30, 1
  s_cmp_lt_u32 s30, 63
  s_cbranch_scc1 C_loop
  s_endpgm
C_pf:
  s_mul_i32 s29, s17, 40960
  s_add_u32 s29, s29, s23
  s_add_u32 s29, s29, 117440512
  s_lshl_b32 s31, s22, 11
  s_add_u32 s31, s31, 13312
  s_mov_b32 s39, 163840
  s_mov_b32 s34, 0
  s_mov_b32 s40, 0
C_fl:
  s_cmp_gt_u32 s30, s34
  s_cbranch_scc1 C_w
  v_cmp_lt_u32 vcc, s30, v7
  s_cmp_eq_u64 vcc, exec
  s_cbranch_scc1 C_flx
  s_cmp_gt_u32 s30, s40
  s_cbranch_scc1 C_w
  s_add_u32 s32, s32, 1
  s_cmp_gt_u32 s32, 200000
  s_cbranch_scc1 C_flx
  s_sleep 8
  buffer_load_dword v7, v8, s[4:7], s31 offen sc1
  s_waitcnt vmcnt(0)
  s_branch C_fl
C_flx:
  s_add_u32 s20, s33, s23
  s_add_u32 m0, s20, 0
  s_add_u32 s21, s29, 0
  buffer_load_dwordx4 v3, s[4:7], s21 offen offset:0 sc1 nt lds
  buffer_load_dwordx4 v3, s[4:7], s21 offen offset:1024 sc1 nt lds
  buffer_load_dwordx4 v3, s[4:7], s21 offen offset:2048 sc1 nt lds
  buffer_load_dwordx4 v3, s[4:7], s21 offen offset:3072 sc1 nt lds
  s_add_u32 m0, s20, 4096
  s_add_u32 s21, s29, 4096
  buffer_load_dwordx4 v3, s[4:7], s21 offen offset:0 sc1 nt lds
  buffer_load_dwordx4 v3, s[4:7], s21 offen offset:1024 sc1 nt lds
  buffer_load_dwordx4 v3, s[4:7], s21 offen offset:2048 sc1 nt lds
  buffer_load_dwordx4 v3, s[4:7], s21 offen offset:3072 sc1 nt lds
  s_add_u32 m0, s20, 8192
  s_add_u32 s21, s29, 8192
  buffer_load_dwordx4 v3, s[4:7], s21 offen offset:0 sc1 nt lds
  buffer_load_dwordx4 v3, s[4:7], s21 offen offset:1024 sc1 nt lds
  buffer_load_dwordx4 v3, s[4:7], s21 offen offset:2048 sc1 nt lds
  buffer_load_dwordx4 v3, s[4:7], s21 offen offset:3072 sc1 nt lds
  s_add_u32 m0, s20, 12288
  s_add_u32 s21, s29, 12288
  buffer_load_dwordx4 v3, s[4:7], s21 offen offset:0 sc1 nt lds
  buffer_load_dwordx4 v3, s[4:7], s21 offen offset:1024 sc1 nt lds
  buffer_load_dwordx4 v3, s[4:7], s21 offen offset:2048 sc1 nt lds
  buffer_load_dwordx4 v3, s[4:7], s21 offen offset:3072 sc1 nt lds
  s_add_u32 s29, s29, 1638400
  s_add_u32 s33, s33, 32768
  s_cmp_eq_u32 s33, 98304
  s_cselect_b32 s33, 0, s33
  s_add_u32 s30, s30, 1
  s_branch C_fl
C_w:
  s_cmp_eq_u32 s16, 2
  s_cselect_b64 exec, -1, 0
  buffer_store_dword v10, v5, s[4:7], s39 offen sc1
  s_mov_b64 exec, -1
  s_add_u32 s34, s40, 2
  s_cmp_eq_u32 s30, s34
  s_cbranch_scc1 C_w2
  s_waitcnt vmcnt(0)
C_w2:
  s_waitcnt vmcnt(16)
  v_max_u32 v7, v7, v9
  buffer_load_dword v9, v8, s[4:7], s31 offen sc1
  s_add_u32 s39, s39, 32768
  s_cmp_eq_u32 s39, 196608
  s_cselect_b32 s39, 65536, s39
  s_add_u32 s40, s40, 1
  s_min_u32 s34, s34, 62
  s_barrier
  s_barrier
  s_sleep 5
  s_cmp_lt_u32 s40, 63
  s_cbranch_scc1 C_fl
  s_endpgm
R_A:
  s_load_dwordx2 s[8:9], s[0:1], 16
  s_mov_b32 s10, 7864320
  s_mov_b32 s11, 0x20000
  s_load_dwordx2 s[12:13], s[0:1], 24
  s_mov_b32 s14, 7864320
  s_mov_b32 s15, 0x20000
  s_mul_i32 s24, s17, 384
  s_waitcnt lgkmcnt(0)
  v_lshrrev_b32 v40, 3, v1
  s_lshl_b32 s20, s16, 3
  v_add_u32 v40, s20, v40
  v_mul_u32_u24 v40, 12288, v40
  v_and_b32 v41, 7, v1
  s_lshl_b32 s20, s16, 1
  v_xor_b32 v41, s20, v41
  v_lshl_add_u32 v31, v41, 4, v40
  v_lshrrev_b32 v40, 4, v1
  v_and_b32 v41, 1, v40
  v_lshrrev_b32 v40, 1, v40
  v_lshl_or_b32 v40, v41, 1, v40
  v_mul_u32_u24 v41, 3072, v40
  v_bfe_u32 v42, v1, 2, 2
  v_lshl_add_u32 v41, v42, 7, v41
  v_and_b32 v42, 3, v1
  v_lshl_add_u32 v41, v42, 3, v41
  s_mul_i32 s20, s16, 3
  s_add_u32 s20, s20, 0
  s_and_b32 s21, s20, 3
  s_lshr_b32 s20, s20, 2
  s_lshl_b32 s20, s20, 10
  v_xor_b32 v42, s21, v40
  v_lshl_add_u32 v42, v42, 5, v41
  v_add_u32 v28, s20, v42
  s_mul_i32 s20, s16, 3
  s_add_u32 s20, s20, 1
  s_and_b32 s21, s20, 3
  s_lshr_b32 s20, s20, 2
  s_lshl_b32 s20, s20, 10
  v_xor_b32 v42, s21, v40
  v_lshl_add_u32 v42, v42, 5, v41
  v_add_u32 v29, s20, v42
  s_mul_i32 s20, s16, 3
  s_add_u32 s20, s20, 2
  s_and_b32 s21, s20, 3
  s_lshr_b32 s20, s20, 2
  s_lshl_b32 s20, s20, 10
  v_xor_b32 v42, s21, v40
  v_lshl_add_u32 v42, v42, 5, v41
  v_add_u32 v30, s20, v42
  v_lshlrev_b32 v15, 4, v1
  s_mul_i32 s20, s16, 2048
  v_add_u32 v5, s20, v15
  v_add_u32 v22, 65536, v5
  s_mul_i32 s27, s16, 3072
  s_add_u32 m0, s27, 15360
  s_add_u32 s26, s24, 0
  buffer_load_dwordx4 v31, s[8:11], s26 offen lds
  s_add_u32 m0, s27, 16384
  s_add_u32 s26, s24, 128
  buffer_load_dwordx4 v31, s[8:11], s26 offen lds
  s_add_u32 m0, s27, 17408
  s_add_u32 s26, s24, 256
  buffer_load_dwordx4 v31, s[8:11], s26 offen lds
  s_add_u32 m0, s27, 27648
  s_add_u32 s26, s24, 393216
  buffer_load_dwordx4 v31, s[8:11], s26 offen lds
  s_add_u32 m0, s27, 28672
  s_add_u32 s26, s24, 393344
  buffer_load_dwordx4 v31, s[8:11], s26 offen lds
  s_add_u32 m0, s27, 29696
  s_add_u32 s26, s24, 393472
  buffer_load_dwordx4 v31, s[8:11], s26 offen lds
  s_mul_i32 s27, s16, 3072
  s_add_u32 m0, s27, 39936
  s_add_u32 s26, s24, 786432
  buffer_load_dwordx4 v31, s[8:11], s26 offen lds
  s_add_u32 m0, s27, 40960
  s_add_u32 s26, s24, 786560
  buffer_load_dwordx4 v31, s[8:11], s26 offen lds
  s_add_u32 m0, s27, 41984
  s_add_u32 s26, s24, 786688
  buffer_load_dwordx4 v31, s[8:11], s26 offen lds
  s_add_u32 m0, s27, 52224
  s_add_u32 s26, s24, 1179648
  buffer_load_dwordx4 v31, s[8:11], s26 offen lds
  s_add_u32 m0, s27, 53248
  s_add_u32 s26, s24, 1179776
  buffer_load_dwordx4 v31, s[8:11], s26 offen lds
  s_add_u32 m0, s27, 54272
  s_add_u32 s26, s24, 1179904
  buffer_load_dwordx4 v31, s[8:11], s26 offen lds
  s_mul_i32 s27, s16, 3072
  s_add_u32 m0, s27, 64512
  s_add_u32 s26, s24, 1572864
  buffer_load_dwordx4 v31, s[8:11], s26 offen lds
  s_add_u32 m0, s27, 65536
  s_add_u32 s26, s24, 1572992
  buffer_load_dwordx4 v31, s[8:11], s26 offen lds
  s_add_u32 m0, s27, 66560
  s_add_u32 s26, s24, 1573120
  buffer_load_dwordx4 v31, s[8:11], s26 offen lds
  s_add_u32 m0, s27, 76800
  s_add_u32 s26, s24, 1966080
  buffer_load_dwordx4 v31, s[8:11], s26 offen lds
  s_add_u32 m0, s27, 77824
  s_add_u32 s26, s24, 1966208
  buffer_load_dwordx4 v31, s[8:11], s26 offen lds
  s_add_u32 m0, s27, 78848
  s_add_u32 s26, s24, 1966336
  buffer_load_dwordx4 v31, s[8:11], s26 offen lds
  s_mul_i32 s27, s16, 3072
  s_add_u32 m0, s27, 89088
  s_add_u32 s26, s24, 2359296
  buffer_load_dwordx4 v31, s[8:11], s26 offen lds
  s_add_u32 m0, s27, 90112
  s_add_u32 s26, s24, 2359424
  buffer_load_dwordx4 v31, s[8:11], s26 offen lds
  s_add_u32 m0, s27, 91136
  s_add_u32 s26, s24, 2359552
  buffer_load_dwordx4 v31, s[8:11], s26 offen lds
  s_add_u32 m0, s27, 101376
  s_add_u32 s26, s24, 2752512
  buffer_load_dwordx4 v31, s[8:11], s26 offen lds
  s_add_u32 m0, s27, 102400
  s_add_u32 s26, s24, 2752640
  buffer_load_dwordx4 v31, s[8:11], s26 offen lds
  s_add_u32 m0, s27, 103424
  s_add_u32 s26, s24, 2752768
  buffer_load_dwordx4 v31, s[8:11], s26 offen lds
  s_mul_i32 s27, s16, 3072
  s_add_u32 m0, s27, 113664
  s_add_u32 s26, s24, 3145728
  buffer_load_dwordx4 v31, s[8:11], s26 offen lds
  s_add_u32 m0, s27, 114688
  s_add_u32 s26, s24, 3145856
  buffer_load_dwordx4 v31, s[8:11], s26 offen lds
  s_add_u32 m0, s27, 115712
  s_add_u32 s26, s24, 3145984
  buffer_load_dwordx4 v31, s[8:11], s26 offen lds
  s_add_u32 m0, s27, 125952
  s_add_u32 s26, s24, 3538944
  buffer_load_dwordx4 v31, s[8:11], s26 offen lds
  s_add_u32 m0, s27, 126976
  s_add_u32 s26, s24, 3539072
  buffer_load_dwordx4 v31, s[8:11], s26 offen lds
  s_add_u32 m0, s27, 128000
  s_add_u32 s26, s24, 3539200
  buffer_load_dwordx4 v31, s[8:11], s26 offen lds
  s_mul_i32 s27, s16, 3072
  s_add_u32 m0, s27, 138240
  s_add_u32 s26, s24, 3932160
  buffer_load_dwordx4 v31, s[8:11], s26 offen lds
  s_add_u32 m0, s27, 139264
  s_add_u32 s26, s24, 3932288
  buffer_load_dwordx4 v31, s[8:11], s26 offen lds
  s_add_u32 m0, s27, 140288
  s_add_u32 s26, s24, 3932416
  buffer_load_dwordx4 v31, s[8:11], s26 offen lds
  s_add_u32 m0, s27, 150528
  s_add_u32 s26, s24, 4325376
  buffer_load_dwordx4 v31, s[8:11], s26 offen lds
  s_add_u32 m0, s27, 151552
  s_add_u32 s26, s24, 4325504
  buffer_load_dwordx4 v31, s[8:11], s26 offen lds
  s_add_u32 m0, s27, 152576
  s_add_u32 s26, s24, 4325632
  buffer_load_dwordx4 v31, s[8:11], s26 offen lds
  s_waitcnt vmcnt(30)
  s_barrier
  v_add_u32 v40, 15360, v28
  v_add_u32 v41, 15360, v29
  v_add_u32 v42, 15360, v30
  ds_read_b64_tr_b16 a[0:1], v40 offset:0
  ds_read_b64_tr_b16 a[2:3], v40 offset:512
  ds_read_b64_tr_b16 a[4:5], v40 offset:12288
  ds_read_b64_tr_b16 a[6:7], v40 offset:12800
  ds_read_b64_tr_b16 a[80:81], v41 offset:0
  ds_read_b64_tr_b16 a[82:83], v41 offset:512
  ds_read_b64_tr_b16 a[84:85], v41 offset:12288
  ds_read_b64_tr_b16 a[86:87], v41 offset:12800
  ds_read_b64_tr_b16 a[160:161], v42 offset:0
  ds_read_b64_tr_b16 a[162:163], v42 offset:512
  ds_read_b64_tr_b16 a[164:165], v42 offset:12288
  ds_read_b64_tr_b16 a[166:167], v42 offset:12800
  s_waitcnt lgkmcnt(0)
  s_waitcnt vmcnt(24)
  s_barrier
  s_mul_i32 s27, s16, 3072
  s_add_u32 m0, s27, 15360
  s_add_u32 s26, s24, 4718592
  buffer_load_dwordx4 v31, s[8:11], s26 offen lds
  s_add_u32 m0, s27, 16384
  s_add_u32 s26, s24, 4718720
  buffer_load_dwordx4 v31, s[8:11], s26 offen lds
  s_add_u32 m0, s27, 17408
  s_add_u32 s26, s24, 4718848
  buffer_load_dwordx4 v31, s[8:11], s26 offen lds
  s_add_u32 m0, s27, 27648
  s_add_u32 s26, s24, 5111808
  buffer_load_dwordx4 v31, s[8:11], s26 offen lds
  s_add_u32 m0, s27, 28672
  s_add_u32 s26, s24, 5111936
  buffer_load_dwordx4 v31, s[8:11], s26 offen lds
  s_add_u32 m0, s27, 29696
  s_add_u32 s26, s24, 5112064
  buffer_load_dwordx4 v31, s[8:11], s26 offen lds
  v_add_u32 v40, 39936, v28
  v_add_u32 v41, 39936, v29
  v_add_u32 v42, 39936, v30
  ds_read_b64_tr_b16 a[8:9], v40 offset:0
  ds_read_b64_tr_b16 a[10:11], v40 offset:512
  ds_read_b64_tr_b16 a[12:13], v40 offset:12288
  ds_read_b64_tr_b16 a[14:15], v40 offset:12800
  ds_read_b64_tr_b16 a[88:89], v41 offset:0
  ds_read_b64_tr_b16 a[90:91], v41 offset:512
  ds_read_b64_tr_b16 a[92:93], v41 offset:12288
  ds_read_b64_tr_b16 a[94:95], v41 offset:12800
  ds_read_b64_tr_b16 a[168:169], v42 offset:0
  ds_read_b64_tr_b16 a[170:171], v42 offset:512
  ds_read_b64_tr_b16 a[172:173], v42 offset:12288
  ds_read_b64_tr_b16 a[174:175], v42 offset:12800
  s_waitcnt lgkmcnt(0)
  s_waitcnt vmcnt(24)
  s_barrier
  s_mul_i32 s27, s16, 3072
  s_add_u32 m0, s27, 39936
  s_add_u32 s26, s24, 5505024
  buffer_load_dwordx4 v31, s[8:11], s26 offen lds
  s_add_u32 m0, s27, 40960
  s_add_u32 s26, s24, 5505152
  buffer_load_dwordx4 v31, s[8:11], s26 offen lds
  s_add_u32 m0, s27, 41984
  s_add_u32 s26, s24, 5505280
  buffer_load_dwordx4 v31, s[8:11], s26 offen lds
  s_add_u32 m0, s27, 52224
  s_add_u32 s26, s24, 5898240
  buffer_load_dwordx4 v31, s[8:11], s26 offen lds
  s_add_u32 m0, s27, 53248
  s_add_u32 s26, s24, 5898368
  buffer_load_dwordx4 v31, s[8:11], s26 offen lds
  s_add_u32 m0, s27, 54272
  s_add_u32 s26, s24, 5898496
  buffer_load_dwordx4 v31, s[8:11], s26 offen lds
  v_add_u32 v40, 64512, v28
  v_add_u32 v41, 64512, v29
  v_add_u32 v42, 64512, v30
  ds_read_b64_tr_b16 a[16:17], v40 offset:0
  ds_read_b64_tr_b16 a[18:19], v40 offset:512
  ds_read_b64_tr_b16 a[20:21], v40 offset:12288
  ds_read_b64_tr_b16 a[22:23], v40 offset:12800
  ds_read_b64_tr_b16 a[96:97], v41 offset:0
  ds_read_b64_tr_b16 a[98:99], v41 offset:512
  ds_read_b64_tr_b16 a[100:101], v41 offset:12288
  ds_read_b64_tr_b16 a[102:103], v41 offset:12800
  ds_read_b64_tr_b16 a[176:177], v42 offset:0
  ds_read_b64_tr_b16 a[178:179], v42 offset:512
  ds_read_b64_tr_b16 a[180:181], v42 offset:12288
  ds_read_b64_tr_b16 a[182:183], v42 offset:12800
  s_waitcnt lgkmcnt(0)
  s_waitcnt vmcnt(24)
  s_barrier
  s_mul_i32 s27, s16, 3072
  s_add_u32 m0, s27, 64512
  s_add_u32 s26, s24, 6291456
  buffer_load_dwordx4 v31, s[8:11], s26 offen lds
  s_add_u32 m0, s27, 65536
  s_add_u32 s26, s24, 6291584
  buffer_load_dwordx4 v31, s[8:11], s26 offen lds
  s_add_u32 m0, s27, 66560
  s_add_u32 s26, s24, 6291712
  buffer_load_dwordx4 v31, s[8:11], s26 offen lds
  s_add_u32 m0, s27, 76800
  s_add_u32 s26, s24, 6684672
  buffer_load_dwordx4 v31, s[8:11], s26 offen lds
  s_add_u32 m0, s27, 77824
  s_add_u32 s26, s24, 6684800
  buffer_load_dwordx4 v31, s[8:11], s26 offen lds
  s_add_u32 m0, s27, 78848
  s_add_u32 s26, s24, 6684928
  buffer_load_dwordx4 v31, s[8:11], s26 offen lds
  v_add_u32 v40, 89088, v28
  v_add_u32 v41, 89088, v29
  v_add_u32 v42, 89088, v30
  ds_read_b64_tr_b16 a[24:25], v40 offset:0
  ds_read_b64_tr_b16 a[26:27], v40 offset:512
  ds_read_b64_tr_b16 a[28:29], v40 offset:12288
  ds_read_b64_tr_b16 a[30:31], v40 offset:12800
  ds_read_b64_tr_b16 a[104:105], v41 offset:0
  ds_read_b64_tr_b16 a[106:107], v41 offset:512
  ds_read_b64_tr_b16 a[108:109], v41 offset:12288
  ds_read_b64_tr_b16 a[110:111], v41 offset:12800
  ds_read_b64_tr_b16 a[184:185], v42 offset:0
  ds_read_b64_tr_b16 a[186:187], v42 offset:512
  ds_read_b64_tr_b16 a[188:189], v42 offset:12288
  ds_read_b64_tr_b16 a[190:191], v42 offset:12800
  s_waitcnt lgkmcnt(0)
  s_waitcnt vmcnt(24)
  s_barrier
  s_mul_i32 s27, s16, 3072
  s_add_u32 m0, s27, 89088
  s_add_u32 s26, s24, 7077888
  buffer_load_dwordx4 v31, s[8:11], s26 offen lds
  s_add_u32 m0, s27, 90112
  s_add_u32 s26, s24, 7078016
  buffer_load_dwordx4 v31, s[8:11], s26 offen lds
  s_add_u32 m0, s27, 91136
  s_add_u32 s26, s24, 7078144
  buffer_load_dwordx4 v31, s[8:11], s26 offen lds
  s_add_u32 m0, s27, 101376
  s_add_u32 s26, s24, 7471104
  buffer_load_dwordx4 v31, s[8:11], s26 offen lds
  s_add_u32 m0, s27, 102400
  s_add_u32 s26, s24, 7471232
  buffer_load_dwordx4 v31, s[8:11], s26 offen lds
  s_add_u32 m0, s27, 103424
  s_add_u32 s26, s24, 7471360
  buffer_load_dwordx4 v31, s[8:11], s26 offen lds
  v_add_u32 v40, 113664, v28
  v_add_u32 v41, 113664, v29
  v_add_u32 v42, 113664, v30
  ds_read_b64_tr_b16 a[32:33], v40 offset:0
  ds_read_b64_tr_b16 a[34:35], v40 offset:512
  ds_read_b64_tr_b16 a[36:37], v40 offset:12288
  ds_read_b64_tr_b16 a[38:39], v40 offset:12800
  ds_read_b64_tr_b16 a[112:113], v41 offset:0
  ds_read_b64_tr_b16 a[114:115], v41 offset:512
  ds_read_b64_tr_b16 a[116:117], v41 offset:12288
  ds_read_b64_tr_b16 a[118:119], v41 offset:12800
  ds_read_b64_tr_b16 a[192:193], v42 offset:0
  ds_read_b64_tr_b16 a[194:195], v42 offset:512
  ds_read_b64_tr_b16 a[196:197], v42 offset:12288
  ds_read_b64_tr_b16 a[198:199], v42 offset:12800
  s_waitcnt lgkmcnt(0)
  s_waitcnt vmcnt(24)
  s_barrier
  s_mul_i32 s27, s16, 3072
  s_add_u32 m0, s27, 113664
  s_add_u32 s26, s24, 0
  buffer_load_dwordx4 v31, s[12:15], s26 offen lds
  s_add_u32 m0, s27, 114688
  s_add_u32 s26, s24, 128
  buffer_load_dwordx4 v31, s[12:15], s26 offen lds
  s_add_u32 m0, s27, 115712
  s_add_u32 s26, s24, 256
  buffer_load_dwordx4 v31, s[12:15], s26 offen lds
  s_add_u32 m0, s27, 125952
  s_add_u32 s26, s24, 393216
  buffer_load_dwordx4 v31, s[12:15], s26 offen lds
  s_add_u32 m0, s27, 126976
  s_add_u32 s26, s24, 393344
  buffer_load_dwordx4 v31, s[12:15], s26 offen lds
  s_add_u32 m0, s27, 128000
  s_add_u32 s26, s24, 393472
  buffer_load_dwordx4 v31, s[12:15], s26 offen lds
  v_add_u32 v40, 138240, v28
  v_add_u32 v41, 138240, v29
  v_add_u32 v42, 138240, v30
  ds_read_b64_tr_b16 a[40:41], v40 offset:0
  ds_read_b64_tr_b16 a[42:43], v40 offset:512
  ds_read_b64_tr_b16 a[44:45], v40 offset:12288
  ds_read_b64_tr_b16 a[46:47], v40 offset:12800
  ds_read_b64_tr_b16 a[120:121], v41 offset:0
  ds_read_b64_tr_b16 a[122:123], v41 offset:512
  ds_read_b64_tr_b16 a[124:125], v41 offset:12288
  ds_read_b64_tr_b16 a[126:127], v41 offset:12800
  ds_read_b64_tr_b16 a[200:201], v42 offset:0
  ds_read_b64_tr_b16 a[202:203], v42 offset:512
  ds_read_b64_tr_b16 a[204:205], v42 offset:12288
  ds_read_b64_tr_b16 a[206:207], v42 offset:12800
  s_waitcnt lgkmcnt(0)
  s_waitcnt vmcnt(24)
  s_barrier
  s_mul_i32 s27, s16, 3072
  s_add_u32 m0, s27, 138240
  s_add_u32 s26, s24, 786432
  buffer_load_dwordx4 v31, s[12:15], s26 offen lds
  s_add_u32 m0, s27, 139264
  s_add_u32 s26, s24, 786560
  buffer_load_dwordx4 v31, s[12:15], s26 offen lds
  s_add_u32 m0, s27, 140288
  s_add_u32 s26, s24, 786688
  buffer_load_dwordx4 v31, s[12:15], s26 offen lds
  s_add_u32 m0, s27, 150528
  s_add_u32 s26, s24, 1179648
  buffer_load_dwordx4 v31, s[12:15], s26 offen lds
  s_add_u32 m0, s27, 151552
  s_add_u32 s26, s24, 1179776
  buffer_load_dwordx4 v31, s[12:15], s26 offen lds
  s_add_u32 m0, s27, 152576
  s_add_u32 s26, s24, 1179904
  buffer_load_dwordx4 v31, s[12:15], s26 offen lds
  v_add_u32 v40, 15360, v28
  v_add_u32 v41, 15360, v29
  v_add_u32 v42, 15360, v30
  ds_read_b64_tr_b16 a[48:49], v40 offset:0
  ds_read_b64_tr_b16 a[50:51], v40 offset:512
  ds_read_b64_tr_b16 a[52:53], v40 offset:12288
  ds_read_b64_tr_b16 a[54:55], v40 offset:12800
  ds_read_b64_tr_b16 a[128:129], v41 offset:0
  ds_read_b64_tr_b16 a[130:131], v41 offset:512
  ds_read_b64_tr_b16 a[132:133], v41 offset:12288
  ds_read_b64_tr_b16 a[134:135], v41 offset:12800
  ds_read_b64_tr_b16 a[208:209], v42 offset:0
  ds_read_b64_tr_b16 a[210:211], v42 offset:512
  ds_read_b64_tr_b16 a[212:213], v42 offset:12288
  ds_read_b64_tr_b16 a[214:215], v42 offset:12800
  s_waitcnt lgkmcnt(0)
  s_waitcnt vmcnt(24)
  s_barrier
  v_add_u32 v40, 39936, v28
  v_add_u32 v41, 39936, v29
  v_add_u32 v42, 39936, v30
  ds_read_b64_tr_b16 a[56:57], v40 offset:0
  ds_read_b64_tr_b16 a[58:59], v40 offset:512
  ds_read_b64_tr_b16 a[60:61], v40 offset:12288
  ds_read_b64_tr_b16 a[62:63], v40 offset:12800
  ds_read_b64_tr_b16 a[136:137], v41 offset:0
  ds_read_b64_tr_b16 a[138:139], v41 offset:512
  ds_read_b64_tr_b16 a[140:141], v41 offset:12288
  ds_read_b64_tr_b16 a[142:143], v41 offset:12800
  ds_read_b64_tr_b16 a[216:217], v42 offset:0
  ds_read_b64_tr_b16 a[218:219], v42 offset:512
  ds_read_b64_tr_b16 a[220:221], v42 offset:12288
  ds_read_b64_tr_b16 a[222:223], v42 offset:12800
  s_waitcnt lgkmcnt(0)
  s_waitcnt vmcnt(18)
  s_barrier
  s_mul_i32 s27, s16, 3072
  s_add_u32 m0, s27, 39936
  s_add_u32 s26, s24, 1572864
  buffer_load_dwordx4 v31, s[12:15], s26 offen lds
  s_add_u32 m0, s27, 40960
  s_add_u32 s26, s24, 1572992
  buffer_load_dwordx4 v31, s[12:15], s26 offen lds
  s_add_u32 m0, s27, 41984
  s_add_u32 s26, s24, 1573120
  buffer_load_dwordx4 v31, s[12:15], s26 offen lds
  s_add_u32 m0, s27, 52224
  s_add_u32 s26, s24, 1966080
  buffer_load_dwordx4 v31, s[12:15], s26 offen lds
  s_add_u32 m0, s27, 53248
  s_add_u32 s26, s24, 1966208
  buffer_load_dwordx4 v31, s[12:15], s26 offen lds
  s_add_u32 m0, s27, 54272
  s_add_u32 s26, s24, 1966336
  buffer_load_dwordx4 v31, s[12:15], s26 offen lds
  v_add_u32 v40, 64512, v28
  v_add_u32 v41, 64512, v29
  v_add_u32 v42, 64512, v30
  ds_read_b64_tr_b16 a[64:65], v40 offset:0
  ds_read_b64_tr_b16 a[66:67], v40 offset:512
  ds_read_b64_tr_b16 a[68:69], v40 offset:12288
  ds_read_b64_tr_b16 a[70:71], v40 offset:12800
  ds_read_b64_tr_b16 a[144:145], v41 offset:0
  ds_read_b64_tr_b16 a[146:147], v41 offset:512
  ds_read_b64_tr_b16 a[148:149], v41 offset:12288
  ds_read_b64_tr_b16 a[150:151], v41 offset:12800
  ds_read_b64_tr_b16 a[224:225], v42 offset:0
  ds_read_b64_tr_b16 a[226:227], v42 offset:512
  ds_read_b64_tr_b16 a[228:229], v42 offset:12288
  ds_read_b64_tr_b16 a[230:231], v42 offset:12800
  s_waitcnt lgkmcnt(0)
  s_waitcnt vmcnt(18)
  s_barrier
  s_mul_i32 s27, s16, 3072
  s_add_u32 m0, s27, 64512
  s_add_u32 s26, s24, 2359296
  buffer_load_dwordx4 v31, s[12:15], s26 offen lds
  s_add_u32 m0, s27, 65536
  s_add_u32 s26, s24, 2359424
  buffer_load_dwordx4 v31, s[12:15], s26 offen lds
  s_add_u32 m0, s27, 66560
  s_add_u32 s26, s24, 2359552
  buffer_load_dwordx4 v31, s[12:15], s26 offen lds
  s_add_u32 m0, s27, 76800
  s_add_u32 s26, s24, 2752512
  buffer_load_dwordx4 v31, s[12:15], s26 offen lds
  s_add_u32 m0, s27, 77824
  s_add_u32 s26, s24, 2752640
  buffer_load_dwordx4 v31, s[12:15], s26 offen lds
  s_add_u32 m0, s27, 78848
  s_add_u32 s26, s24, 2752768
  buffer_load_dwordx4 v31, s[12:15], s26 offen lds
  v_add_u32 v40, 89088, v28
  v_add_u32 v41, 89088, v29
  v_add_u32 v42, 89088, v30
  ds_read_b64_tr_b16 a[72:73], v40 offset:0
  ds_read_b64_tr_b16 a[74:75], v40 offset:512
  ds_read_b64_tr_b16 a[76:77], v40 offset:12288
  ds_read_b64_tr_b16 a[78:79], v40 offset:12800
  ds_read_b64_tr_b16 a[152:153], v41 offset:0
  ds_read_b64_tr_b16 a[154:155], v41 offset:512
  ds_read_b64_tr_b16 a[156:157], v41 offset:12288
  ds_read_b64_tr_b16 a[158:159], v41 offset:12800
  ds_read_b64_tr_b16 a[232:233], v42 offset:0
  ds_read_b64_tr_b16 a[234:235], v42 offset:512
  ds_read_b64_tr_b16 a[236:237], v42 offset:12288
  ds_read_b64_tr_b16 a[238:239], v42 offset:12800
  s_waitcnt lgkmcnt(0)
  s_waitcnt vmcnt(18)
  s_barrier
  s_mul_i32 s27, s16, 3072
  s_add_u32 m0, s27, 89088
  s_add_u32 s26, s24, 3145728
  buffer_load_dwordx4 v31, s[12:15], s26 offen lds
  s_add_u32 m0, s27, 90112
  s_add_u32 s26, s24, 3145856
  buffer_load_dwordx4 v31, s[12:15], s26 offen lds
  s_add_u32 m0, s27, 91136
  s_add_u32 s26, s24, 3145984
  buffer_load_dwordx4 v31, s[12:15], s26 offen lds
  s_add_u32 m0, s27, 101376
  s_add_u32 s26, s24, 3538944
  buffer_load_dwordx4 v31, s[12:15], s26 offen lds
  s_add_u32 m0, s27, 102400
  s_add_u32 s26, s24, 3539072
  buffer_load_dwordx4 v31, s[12:15], s26 offen lds
  s_add_u32 m0, s27, 103424
  s_add_u32 s26, s24, 3539200
  buffer_load_dwordx4 v31, s[12:15], s26 offen lds
  v_add_u32 v40, 113664, v28
  v_add_u32 v41, 113664, v29
  v_add_u32 v42, 113664, v30
  ds_read_b64_tr_b16 a[240:241], v40 offset:0
  ds_read_b64_tr_b16 a[242:243], v40 offset:512
  ds_read_b64_tr_b16 a[244:245], v40 offset:12288
  ds_read_b64_tr_b16 a[246:247], v40 offset:12800
  ds_read_b64_tr_b16 v[176:177], v41 offset:0
  ds_read_b64_tr_b16 v[178:179], v41 offset:512
  ds_read_b64_tr_b16 v[180:181], v41 offset:12288
  ds_read_b64_tr_b16 v[182:183], v41 offset:12800
  ds_read_b64_tr_b16 v[48:49], v42 offset:0
  ds_read_b64_tr_b16 v[50:51], v42 offset:512
  ds_read_b64_tr_b16 v[52:53], v42 offset:12288
  ds_read_b64_tr_b16 v[54:55], v42 offset:12800
  s_waitcnt lgkmcnt(0)
  ds_write_b128 v5, v[48:51] offset:0
  ds_write_b128 v5, v[52:55] offset:1024
  s_waitcnt lgkmcnt(0)
  s_waitcnt vmcnt(18)
  s_barrier
  s_mul_i32 s27, s16, 3072
  s_add_u32 m0, s27, 113664
  s_add_u32 s26, s24, 3932160
  buffer_load_dwordx4 v31, s[12:15], s26 offen lds
  s_add_u32 m0, s27, 114688
  s_add_u32 s26, s24, 3932288
  buffer_load_dwordx4 v31, s[12:15], s26 offen lds
  s_add_u32 m0, s27, 115712
  s_add_u32 s26, s24, 3932416
  buffer_load_dwordx4 v31, s[12:15], s26 offen lds
  s_add_u32 m0, s27, 125952
  s_add_u32 s26, s24, 4325376
  buffer_load_dwordx4 v31, s[12:15], s26 offen lds
  s_add_u32 m0, s27, 126976
  s_add_u32 s26, s24, 4325504
  buffer_load_dwordx4 v31, s[12:15], s26 offen lds
  s_add_u32 m0, s27, 128000
  s_add_u32 s26, s24, 4325632
  buffer_load_dwordx4 v31, s[12:15], s26 offen lds
  v_add_u32 v40, 138240, v28
  v_add_u32 v41, 138240, v29
  v_add_u32 v42, 138240, v30
  ds_read_b64_tr_b16 a[248:249], v40 offset:0
  ds_read_b64_tr_b16 a[250:251], v40 offset:512
  ds_read_b64_tr_b16 a[252:253], v40 offset:12288
  ds_read_b64_tr_b16 a[254:255], v40 offset:12800
  ds_read_b64_tr_b16 v[184:185], v41 offset:0
  ds_read_b64_tr_b16 v[186:187], v41 offset:512
  ds_read_b64_tr_b16 v[188:189], v41 offset:12288
  ds_read_b64_tr_b16 v[190:191], v41 offset:12800
  ds_read_b64_tr_b16 v[48:49], v42 offset:0
  ds_read_b64_tr_b16 v[50:51], v42 offset:512
  ds_read_b64_tr_b16 v[52:53], v42 offset:12288
  ds_read_b64_tr_b16 v[54:55], v42 offset:12800
  s_waitcnt lgkmcnt(0)
  ds_write_b128 v5, v[48:51] offset:8192
  ds_write_b128 v5, v[52:55] offset:9216
  s_waitcnt lgkmcnt(0)
  s_waitcnt vmcnt(18)
  s_barrier
  s_mul_i32 s27, s16, 3072
  s_add_u32 m0, s27, 138240
  s_add_u32 s26, s24, 4718592
  buffer_load_dwordx4 v31, s[12:15], s26 offen lds
  s_add_u32 m0, s27, 139264
  s_add_u32 s26, s24, 4718720
  buffer_load_dwordx4 v31, s[12:15], s26 offen lds
  s_add_u32 m0, s27, 140288
  s_add_u32 s26, s24, 4718848
  buffer_load_dwordx4 v31, s[12:15], s26 offen lds
  s_add_u32 m0, s27, 150528
  s_add_u32 s26, s24, 5111808
  buffer_load_dwordx4 v31, s[12:15], s26 offen lds
  s_add_u32 m0, s27, 151552
  s_add_u32 s26, s24, 5111936
  buffer_load_dwordx4 v31, s[12:15], s26 offen lds
  s_add_u32 m0, s27, 152576
  s_add_u32 s26, s24, 5112064
  buffer_load_dwordx4 v31, s[12:15], s26 offen lds
  v_add_u32 v40, 39936, v28
  v_add_u32 v41, 39936, v29
  v_add_u32 v42, 39936, v30
  ds_read_b64_tr_b16 v[112:113], v40 offset:0
  ds_read_b64_tr_b16 v[114:115], v40 offset:512
  ds_read_b64_tr_b16 v[116:117], v40 offset:12288
  ds_read_b64_tr_b16 v[118:119], v40 offset:12800
  ds_read_b64_tr_b16 v[192:193], v41 offset:0
  ds_read_b64_tr_b16 v[194:195], v41 offset:512
  ds_read_b64_tr_b16 v[196:197], v41 offset:12288
  ds_read_b64_tr_b16 v[198:199], v41 offset:12800
  ds_read_b64_tr_b16 v[48:49], v42 offset:0
  ds_read_b64_tr_b16 v[50:51], v42 offset:512
  ds_read_b64_tr_b16 v[52:53], v42 offset:12288
  ds_read_b64_tr_b16 v[54:55], v42 offset:12800
  s_waitcnt lgkmcnt(0)
  ds_write_b128 v5, v[48:51] offset:16384
  ds_write_b128 v5, v[52:55] offset:17408
  s_waitcnt lgkmcnt(0)
  s_waitcnt vmcnt(18)
  s_barrier
  v_add_u32 v40, 64512, v28
  v_add_u32 v41, 64512, v29
  v_add_u32 v42, 64512, v30
  ds_read_b64_tr_b16 v[120:121], v40 offset:0
  ds_read_b64_tr_b16 v[122:123], v40 offset:512
  ds_read_b64_tr_b16 v[124:125], v40 offset:12288
  ds_read_b64_tr_b16 v[126:127], v40 offset:12800
  ds_read_b64_tr_b16 v[200:201], v41 offset:0
  ds_read_b64_tr_b16 v[202:203], v41 offset:512
  ds_read_b64_tr_b16 v[204:205], v41 offset:12288
  ds_read_b64_tr_b16 v[206:207], v41 offset:12800
  ds_read_b64_tr_b16 v[48:49], v42 offset:0
  ds_read_b64_tr_b16 v[50:51], v42 offset:512
  ds_read_b64_tr_b16 v[52:53], v42 offset:12288
  ds_read_b64_tr_b16 v[54:55], v42 offset:12800
  s_waitcnt lgkmcnt(0)
  ds_write_b128 v5, v[48:51] offset:24576
  ds_write_b128 v5, v[52:55] offset:25600
  s_waitcnt lgkmcnt(0)
  s_waitcnt vmcnt(12)
  s_barrier
  v_add_u32 v40, 89088, v28
  v_add_u32 v41, 89088, v29
  v_add_u32 v42, 89088, v30
  ds_read_b64_tr_b16 v[128:129], v40 offset:0
  ds_read_b64_tr_b16 v[130:131], v40 offset:512
  ds_read_b64_tr_b16 v[132:133], v40 offset:12288
  ds_read_b64_tr_b16 v[134:135], v40 offset:12800
  ds_read_b64_tr_b16 v[208:209], v41 offset:0
  ds_read_b64_tr_b16 v[210:211], v41 offset:512
  ds_read_b64_tr_b16 v[212:213], v41 offset:12288
  ds_read_b64_tr_b16 v[214:215], v41 offset:12800
  ds_read_b64_tr_b16 v[48:49], v42 offset:0
  ds_read_b64_tr_b16 v[50:51], v42 offset:512
  ds_read_b64_tr_b16 v[52:53], v42 offset:12288
  ds_read_b64_tr_b16 v[54:55], v42 offset:12800
  s_waitcnt lgkmcnt(0)
  ds_write_b128 v5, v[48:51] offset:32768
  ds_write_b128 v5, v[52:55] offset:33792
  s_waitcnt lgkmcnt(0)
  s_waitcnt vmcnt(6)
  s_barrier
  s_mul_i32 s27, s16, 3072
  s_add_u32 m0, s27, 89088
  s_add_u32 s26, s24, 5505024
  buffer_load_dwordx4 v31, s[12:15], s26 offen lds
  s_add_u32 m0, s27, 90112
  s_add_u32 s26, s24, 5505152
  buffer_load_dwordx4 v31, s[12:15], s26 offen lds
  s_add_u32 m0, s27, 91136
  s_add_u32 s26, s24, 5505280
  buffer_load_dwordx4 v31, s[12:15], s26 offen lds
  s_add_u32 m0, s27, 101376
  s_add_u32 s26, s24, 5898240
  buffer_load_dwordx4 v31, s[12:15], s26 offen lds
  s_add_u32 m0, s27, 102400
  s_add_u32 s26, s24, 5898368
  buffer_load_dwordx4 v31, s[12:15], s26 offen lds
  s_add_u32 m0, s27, 103424
  s_add_u32 s26, s24, 5898496
  buffer_load_dwordx4 v31, s[12:15], s26 offen lds
  v_add_u32 v40, 113664, v28
  v_add_u32 v41, 113664, v29
  v_add_u32 v42, 113664, v30
  ds_read_b64_tr_b16 v[136:137], v40 offset:0
  ds_read_b64_tr_b16 v[138:139], v40 offset:512
  ds_read_b64_tr_b16 v[140:141], v40 offset:12288
  ds_read_b64_tr_b16 v[142:143], v40 offset:12800
  ds_read_b64_tr_b16 v[216:217], v41 offset:0
  ds_read_b64_tr_b16 v[218:219], v41 offset:512
  ds_read_b64_tr_b16 v[220:221], v41 offset:12288
  ds_read_b64_tr_b16 v[222:223], v41 offset:12800
  ds_read_b64_tr_b16 v[48:49], v42 offset:0
  ds_read_b64_tr_b16 v[50:51], v42 offset:512
  ds_read_b64_tr_b16 v[52:53], v42 offset:12288
  ds_read_b64_tr_b16 v[54:55], v42 offset:12800
  s_waitcnt lgkmcnt(0)
  ds_write_b128 v5, v[48:51] offset:40960
  ds_write_b128 v5, v[52:55] offset:41984
  s_waitcnt lgkmcnt(0)
  s_waitcnt vmcnt(6)
  s_barrier
  s_mul_i32 s27, s16, 3072
  s_add_u32 m0, s27, 113664
  s_add_u32 s26, s24, 6291456
  buffer_load_dwordx4 v31, s[12:15], s26 offen lds
  s_add_u32 m0, s27, 114688
  s_add_u32 s26, s24, 6291584
  buffer_load_dwordx4 v31, s[12:15], s26 offen lds
  s_add_u32 m0, s27, 115712
  s_add_u32 s26, s24, 6291712
  buffer_load_dwordx4 v31, s[12:15], s26 offen lds
  s_add_u32 m0, s27, 125952
  s_add_u32 s26, s24, 6684672
  buffer_load_dwordx4 v31, s[12:15], s26 offen lds
  s_add_u32 m0, s27, 126976
  s_add_u32 s26, s24, 6684800
  buffer_load_dwordx4 v31, s[12:15], s26 offen lds
  s_add_u32 m0, s27, 128000
  s_add_u32 s26, s24, 6684928
  buffer_load_dwordx4 v31, s[12:15], s26 offen lds
  v_add_u32 v40, 138240, v28
  v_add_u32 v41, 138240, v29
  v_add_u32 v42, 138240, v30
  ds_read_b64_tr_b16 v[144:145], v40 offset:0
  ds_read_b64_tr_b16 v[146:147], v40 offset:512
  ds_read_b64_tr_b16 v[148:149], v40 offset:12288
  ds_read_b64_tr_b16 v[150:151], v40 offset:12800
  ds_read_b64_tr_b16 v[224:225], v41 offset:0
  ds_read_b64_tr_b16 v[226:227], v41 offset:512
  ds_read_b64_tr_b16 v[228:229], v41 offset:12288
  ds_read_b64_tr_b16 v[230:231], v41 offset:12800
  ds_read_b64_tr_b16 v[48:49], v42 offset:0
  ds_read_b64_tr_b16 v[50:51], v42 offset:512
  ds_read_b64_tr_b16 v[52:53], v42 offset:12288
  ds_read_b64_tr_b16 v[54:55], v42 offset:12800
  s_waitcnt lgkmcnt(0)
  ds_write_b128 v5, v[48:51] offset:49152
  ds_write_b128 v5, v[52:55] offset:50176
  s_waitcnt lgkmcnt(0)
  s_waitcnt vmcnt(6)
  s_barrier
  s_mul_i32 s27, s16, 3072
  s_add_u32 m0, s27, 138240
  s_add_u32 s26, s24, 7077888
  buffer_load_dwordx4 v31, s[12:15], s26 offen lds
  s_add_u32 m0, s27, 139264
  s_add_u32 s26, s24, 7078016
  buffer_load_dwordx4 v31, s[12:15], s26 offen lds
  s_add_u32 m0, s27, 140288
  s_add_u32 s26, s24, 7078144
  buffer_load_dwordx4 v31, s[12:15], s26 offen lds
  s_add_u32 m0, s27, 150528
  s_add_u32 s26, s24, 7471104
  buffer_load_dwordx4 v31, s[12:15], s26 offen lds
  s_add_u32 m0, s27, 151552
  s_add_u32 s26, s24, 7471232
  buffer_load_dwordx4 v31, s[12:15], s26 offen lds
  s_add_u32 m0, s27, 152576
  s_add_u32 s26, s24, 7471360
  buffer_load_dwordx4 v31, s[12:15], s26 offen lds
  s_cmp_eq_u32 s16, 0
  s_cbranch_scc0 DI_29
  buffer_load_dwordx2 v[56:57], off, s[48:51], 0 offset:8 sc1
DI_29:
  v_add_u32 v40, 89088, v28
  v_add_u32 v41, 89088, v29
  v_add_u32 v42, 89088, v30
  ds_read_b64_tr_b16 v[152:153], v40 offset:0
  ds_read_b64_tr_b16 v[154:155], v40 offset:512
  ds_read_b64_tr_b16 v[156:157], v40 offset:12288
  ds_read_b64_tr_b16 v[158:159], v40 offset:12800
  ds_read_b64_tr_b16 v[232:233], v41 offset:0
  ds_read_b64_tr_b16 v[234:235], v41 offset:512
  ds_read_b64_tr_b16 v[236:237], v41 offset:12288
  ds_read_b64_tr_b16 v[238:239], v41 offset:12800
  ds_read_b64_tr_b16 v[48:49], v42 offset:0
  ds_read_b64_tr_b16 v[50:51], v42 offset:512
  ds_read_b64_tr_b16 v[52:53], v42 offset:12288
  ds_read_b64_tr_b16 v[54:55], v42 offset:12800
  s_waitcnt lgkmcnt(0)
  ds_write_b128 v5, v[48:51] offset:57344
  ds_write_b128 v5, v[52:55] offset:58368
  s_waitcnt lgkmcnt(0)
  s_waitcnt vmcnt(6)
  s_barrier
  v_add_u32 v40, 113664, v28
  v_add_u32 v41, 113664, v29
  v_add_u32 v42, 113664, v30
  ds_read_b64_tr_b16 v[160:161], v40 offset:0
  ds_read_b64_tr_b16 v[162:163], v40 offset:512
  ds_read_b64_tr_b16 v[164:165], v40 offset:12288
  ds_read_b64_tr_b16 v[166:167], v40 offset:12800
  ds_read_b64_tr_b16 v[240:241], v41 offset:0
  ds_read_b64_tr_b16 v[242:243], v41 offset:512
  ds_read_b64_tr_b16 v[244:245], v41 offset:12288
  ds_read_b64_tr_b16 v[246:247], v41 offset:12800
  ds_read_b64_tr_b16 v[48:49], v42 offset:0
  ds_read_b64_tr_b16 v[50:51], v42 offset:512
  ds_read_b64_tr_b16 v[52:53], v42 offset:12288
  ds_read_b64_tr_b16 v[54:55], v42 offset:12800
  s_waitcnt lgkmcnt(0)
  ds_write_b128 v22, v[48:51] offset:0
  ds_write_b128 v22, v[52:55] offset:1024
  s_waitcnt lgkmcnt(0)
  s_waitcnt vmcnt(0)
  s_barrier
  v_add_u32 v40, 138240, v28
  v_add_u32 v41, 138240, v29
  v_add_u32 v42, 138240, v30
  ds_read_b64_tr_b16 v[168:169], v40 offset:0
  ds_read_b64_tr_b16 v[170:171], v40 offset:512
  ds_read_b64_tr_b16 v[172:173], v40 offset:12288
  ds_read_b64_tr_b16 v[174:175], v40 offset:12800
  ds_read_b64_tr_b16 v[248:249], v41 offset:0
  ds_read_b64_tr_b16 v[250:251], v41 offset:512
  ds_read_b64_tr_b16 v[252:253], v41 offset:12288
  ds_read_b64_tr_b16 v[254:255], v41 offset:12800
  ds_read_b64_tr_b16 v[48:49], v42 offset:0
  ds_read_b64_tr_b16 v[50:51], v42 offset:512
  ds_read_b64_tr_b16 v[52:53], v42 offset:12288
  ds_read_b64_tr_b16 v[54:55], v42 offset:12800
  s_waitcnt lgkmcnt(0)
  ds_write_b128 v22, v[48:51] offset:8192
  ds_write_b128 v22, v[52:55] offset:9216
  s_waitcnt lgkmcnt(0)
  s_cmp_eq_u32 s16, 0
  s_cbranch_scc0 DC_32
  s_mov_b32 s22, 0
DC_30:
  s_waitcnt vmcnt(0)
  v_readfirstlane_b32 s20, v56
  v_readfirstlane_b32 s21, v57
  s_cmp_lg_u32 s21, 0
  s_cbranch_scc1 DC_31
DC_33:
  s_add_u32 s22, s22, 1
  s_cmp_gt_u32 s22, 200000
  s_cbranch_scc1 DC_31
  s_sleep 16
  buffer_load_dwordx2 v[56:57], off, s[48:51], 0 offset:8 sc1
  s_branch DC_30
DC_31:
  s_and_b32 s21, s21, 8192
  v_mov_b32 v56, s21
  v_mov_b32 v57, 163824
  ds_write_b32 v57, v56
  s_waitcnt lgkmcnt(0)
DC_32:
  s_barrier
  v_mov_b32 v57, 163824
  ds_read_b32 v56, v57
  s_waitcnt lgkmcnt(0)
  v_readfirstlane_b32 s52, v56
  v_lshrrev_b32 v40, 4, v1
  v_bfe_u32 v41, v1, 2, 2
  v_and_b32 v42, 3, v1
  v_and_b32 v44, 15, v1
  v_lshrrev_b32 v43, 1, v40
  v_lshlrev_b32 v4, 9, v43
  v_and_b32 v43, 1, v40
  v_lshl_add_u32 v4, v43, 7, v4
  v_lshrrev_b32 v43, 1, v41
  v_lshl_add_u32 v4, v43, 6, v4
  v_lshrrev_b32 v43, 1, v42
  v_lshl_add_u32 v4, v43, 5, v4
  v_and_b32 v43, 1, v41
  v_lshl_add_u32 v4, v43, 4, v4
  v_and_b32 v43, 1, v42
  v_lshl_add_u32 v4, v43, 3, v4
  v_add_u32 v4, 81920, v4
  v_and_b32 v43, 8, v1
  v_cmp_eq_u32 vcc, 0, v43
  v_mov_b32 v6, 0xeeee
  v_mov_b32 v43, 0x4444
  v_cndmask_b32 v6, v6, v43, vcc
  s_mul_i32 s20, s16, 5120
  s_add_u32 s20, s20, 81920
  v_add_u32 v3, s20, v15
  s_lshl_b32 s20, s16, 14
  s_add_u32 s20, s20, s52
  v_add_u32 v2, s20, v15
  s_mul_i32 s21, s16, 768
  s_add_u32 s21, s21, 92160
  v_lshlrev_b32 v7, 4, v44
  v_and_b32 v43, 1, v40
  v_lshl_add_u32 v7, v43, 2, v7
  v_lshrrev_b32 v43, 1, v40
  v_mul_u32_u24 v43, 3072, v43
  v_add3_u32 v7, v7, v43, s21
  v_lshl_add_u32 v43, v40, 2, v41
  v_lshlrev_b32 v8, 4, v43
  v_and_b32 v43, 1, v42
  v_lshl_add_u32 v8, v43, 3, v8
  v_add_u32 v8, s21, v8
  v_lshl_add_u32 v17, v40, 3, v41
  v_lshlrev_b32 v17, 4, v17
  v_lshl_add_u32 v17, v43, 3, v17
  v_add_u32 v17, 95232, v17
  v_lshrrev_b32 v43, 1, v42
  v_mul_u32_u24 v9, 6144, v43
  v_lshrrev_b32 v43, 1, v40
  v_lshl_add_u32 v9, v43, 8, v9
  v_and_b32 v43, 1, v40
  v_lshl_add_u32 v9, v43, 3, v9
  v_lshrrev_b32 v43, 1, v41
  v_lshl_add_u32 v9, v43, 7, v9
  v_and_b32 v43, 1, v41
  v_lshl_add_u32 v9, v43, 5, v9
  v_and_b32 v43, 1, v42
  v_lshl_add_u32 v9, v43, 4, v9
  s_mul_i32 s20, s16, 1536
  v_add_u32 v9, s20, v9
  s_mul_i32 s20, s16, 2304
  s_add_u32 s20, s20, 98304
  v_and_b32 v43, 7, v1
  v_lshlrev_b32 v43, 4, v43
  v_mul_u32_u24 v11, 288, v40
  v_add3_u32 v11, v11, v43, s20
  v_mul_u32_u24 v12, 144, v40
  v_add3_u32 v12, v12, v43, s20
  v_mul_u32_u24 v13, 144, v44
  v_lshl_add_u32 v13, v40, 4, v13
  s_lshl_b32 s20, s16, 6
  s_add_u32 s20, s20, 98304
  v_add_u32 v13, s20, v13
  v_lshrrev_b32 v43, 1, v40
  v_lshlrev_b32 v45, 2, v43
  v_and_b32 v43, 1, v40
  s_lshl_b32 s20, s16, 1
  v_add3_u32 v45, v45, v43, s20
  v_lshrrev_b32 v43, 1, v44
  v_lshl_add_u32 v46, v43, 3, v45
  v_lshlrev_b32 v46, 4, v46
  v_and_b32 v43, 1, v44
  v_lshl_add_u32 v46, v43, 3, v46
  s_lshl_b32 s20, s17, 9
  s_cmp_ge_u32 s17, 16
  s_cselect_b32 s21, 8192, 0
  s_add_u32 s20, s20, s21
  v_add_u32 v46, s20, v46
  v_lshl_add_u32 v47, v43, 3, v45
  v_lshlrev_b32 v47, 4, v47
  s_lshr_b32 s20, s17, 1
  s_lshl_b32 s20, s20, 8
  s_and_b32 s21, s17, 1
  s_lshl_b32 s21, s21, 3
  s_add_u32 s20, s20, s21
  s_add_u32 s20, s20, 32768
  v_add_u32 v47, s20, v47
  v_cmp_gt_u32 vcc, 8, v44
  v_cndmask_b32 v14, v47, v46, vcc
  v_add_u32 v14, s52, v14
  s_and_b32 s20, s17, 3
  s_lshl_b32 s20, s20, 8
  v_lshlrev_b32 v18, 4, v44
  v_lshl_add_u32 v18, v40, 2, v18
  v_add_u32 v18, s20, v18
  v_mov_b32 v16, 0
  v_mov_b32 v24, -1
  v_mov_b32 v25, -1
  v_mov_b32 v108, 0
  v_mov_b32 v109, 0
  v_mov_b32 v48, 0xf04a0000
  v_mov_b32 v49, v48
  v_mov_b32 v50, v48
  v_mov_b32 v51, v48
  s_mul_i32 s20, s16, 2304
  s_add_u32 s20, s20, 98304
  v_add_u32 v43, s20, v15
  ds_write_b128 v43, v[48:51]
  ds_write_b128 v43, v[48:51] offset:1024
  ds_write_b128 v43, v[48:51] offset:1280
  s_and_b32 s22, s16, 1
  s_mul_i32 s20, s22, 3072
  s_add_u32 s20, s20, 156672
  v_add_u32 v27, s20, v15
  s_lshl_b32 s20, s22, 2
  v_lshl_add_u32 v45, v41, 3, v42
  v_add_u32 v45, s20, v45
  v_lshlrev_b32 v46, 3, v40
  v_mov_b32 v47, 0xf1490000
  v_cmp_gt_u32 vcc, 2, v40
  v_cndmask_b32 v52, v47, v16, vcc
  v_mov_b32 v53, v52
  v_mov_b32 v54, v52
  v_mov_b32 v55, v52
  v_add_u32 v43, 0, v46
  v_cmp_le_u32 vcc, v43, v45
  v_cndmask_b32 v56, v47, v16, vcc
  v_add_u32 v43, 1, v46
  v_cmp_le_u32 vcc, v43, v45
  v_cndmask_b32 v57, v47, v16, vcc
  v_add_u32 v43, 2, v46
  v_cmp_le_u32 vcc, v43, v45
  v_cndmask_b32 v58, v47, v16, vcc
  v_add_u32 v43, 3, v46
  v_cmp_le_u32 vcc, v43, v45
  v_cndmask_b32 v59, v47, v16, vcc
  v_add_u32 v43, 4, v46
  v_cmp_le_u32 vcc, v43, v45
  v_cndmask_b32 v60, v47, v16, vcc
  v_add_u32 v43, 5, v46
  v_cmp_le_u32 vcc, v43, v45
  v_cndmask_b32 v61, v47, v16, vcc
  v_add_u32 v43, 6, v46
  v_cmp_le_u32 vcc, v43, v45
  v_cndmask_b32 v62, v47, v16, vcc
  v_add_u32 v43, 7, v46
  v_cmp_le_u32 vcc, v43, v45
  v_cndmask_b32 v63, v47, v16, vcc
  s_cmp_lt_u32 s16, 2
  s_cbranch_scc1 A_nomask
  ds_write_b128 v27, v[52:55] offset:0
  ds_write_b128 v27, v[56:59] offset:1024
  ds_write_b128 v27, v[60:63] offset:2048
A_nomask:
  s_mov_b32 s24, 65536
  s_mov_b32 s25, 196608
  s_mov_b32 s26, 393216
  s_mul_i32 s44, s17, 786432
  s_add_u32 s44, s44, 33554432
  s_mul_i32 s33, s22, 6144
  s_add_u32 s44, s44, s33
  s_add_u32 s27, s44, 25165824
  s_lshl_b32 s45, s17, 7
  s_add_u32 s45, s45, 0
  s_add_u32 s28, s45, 4096
  s_lshl_b32 s29, s17, 7
  s_lshl_b32 s20, s22, 2
  s_add_u32 s29, s29, s20
  s_add_u32 s29, s29, 18432
  s_lshl_b32 s34, s17, 11
  s_lshl_b32 s20, s22, 10
  s_add_u32 s34, s34, s20
  s_add_u32 s34, s34, 5767168
  s_lshr_b32 s35, s17, 2
  s_lshl_b32 s35, s35, 11
  s_add_u32 s35, s35, s20
  s_add_u32 s35, s35, 9961472
  s_mov_b32 s30, 0
  s_mov_b32 s31, 107520
  s_mov_b32 s32, 0
  s_mov_b32 s36, 0
  s_cmp_lt_u32 s16, 2
  s_cselect_b32 s42, 0x03ff03ff, 0
  s_mov_b32 s43, s42
  s_cmp_lt_u32 s16, 2
  s_cbranch_scc1 A_nopre
  v_mov_b32 v84, 0
  v_mov_b32 v85, 0
  v_mov_b32 v86, 0
  v_mov_b32 v87, 0
  v_mov_b32 v88, 0
  v_mov_b32 v89, 0
  v_mov_b32 v90, 0
  v_mov_b32 v91, 0
  s_add_u32 s38, s33, 107520
Af_34:
  v_min_u32 v84, v84, v85
  v_min3_u32 v84, v84, v86, v87
  s_nop 0
  v_readfirstlane_b32 s37, v84
  s_cmp_gt_u32 s37, s36
  s_cbranch_scc1 Afx_35
  s_add_u32 s32, s32, 1
  s_cmp_gt_u32 s32, 200000
  s_cbranch_scc1 Afx_35
  s_sleep 6
  buffer_load_dwordx4 v[84:87], v16, s[4:7], s28 offen sc1
  s_waitcnt vmcnt(0)
  s_branch Af_34
Afx_35:
  s_add_u32 m0, s38, 0
  s_add_u32 s21, s27, 0
  buffer_load_dwordx4 v15, s[4:7], s21 offen sc1 lds
  s_add_u32 m0, s38, 1024
  s_add_u32 s21, s27, 1024
  buffer_load_dwordx4 v15, s[4:7], s21 offen sc1 lds
  s_add_u32 m0, s38, 2048
  s_add_u32 s21, s27, 2048
  buffer_load_dwordx4 v15, s[4:7], s21 offen sc1 lds
  s_add_u32 m0, s38, 3072
  s_add_u32 s21, s27, 3072
  buffer_load_dwordx4 v15, s[4:7], s21 offen sc1 lds
  s_add_u32 m0, s38, 4096
  s_add_u32 s21, s27, 4096
  buffer_load_dwordx4 v15, s[4:7], s21 offen sc1 lds
  s_add_u32 m0, s38, 5120
  s_add_u32 s21, s27, 5120
  buffer_load_dwordx4 v15, s[4:7], s21 offen sc1 lds
  s_add_u32 s27, s27, 12288
  s_waitcnt vmcnt(0)
A_nopre:
  v_lshlrev_b32 v20, 7, v1
  s_add_u32 s89, s52, 49152
  s_add_u32 s83, s52, 32768
  s_mov_b32 s84, 112
  s_mov_b32 s85, 0
  s_mov_b32 s90, 0
  s_mov_b32 s91, 0
  s_memrealtime s[92:93]
  s_waitcnt lgkmcnt(0)
  s_mov_b32 s94, s92
  s_mov_b32 s95, s92
  s_lshl_b32 s87, s17, 7
  s_lshl_b32 s20, s22, 2
  s_add_u32 s87, s87, s20
  s_add_u32 s87, s87, s89
  s_mov_b32 s86, 0
  s_mov_b32 s47, 0
A_loop:
  v_mov_b32 v28, 0
  v_mov_b32 v29, 0
  v_mov_b32 v30, 0
  v_mov_b32 v31, 0
  v_mov_b32 v32, 0
  v_mov_b32 v33, 0
  v_mov_b32 v34, 0
  v_mov_b32 v35, 0
  v_mov_b32 v36, 0
  v_mov_b32 v37, 0
  v_mov_b32 v38, 0
  v_mov_b32 v39, 0
  v_mov_b32 v40, 0
  v_mov_b32 v41, 0
  v_mov_b32 v42, 0
  v_mov_b32 v43, 0
  v_mov_b32 v44, 0
  v_mov_b32 v45, 0
  v_mov_b32 v46, 0
  v_mov_b32 v47, 0
  v_mov_b32 v48, 0
  v_mov_b32 v49, 0
  v_mov_b32 v50, 0
  v_mov_b32 v51, 0
  ds_read_b128 v[76:79], v5 offset:0
  ds_read_b128 v[80:83], v5 offset:1024
  ds_read_b128 v[84:87], v5 offset:8192
  ds_read_b128 v[88:91], v5 offset:9216
  ds_read_b128 v[92:95], v5 offset:16384
  ds_read_b128 v[96:99], v5 offset:17408
  ds_read_b128 v[100:103], v5 offset:24576
  ds_read_b128 v[104:107], v5 offset:25600
  v_add_u32 v10, s31, v9
  v_add_u32 v19, s31, v15
  s_add_u32 s36, s30, 1
  s_min_u32 s36, s36, 63
  s_sub_u32 s38, 227328, s31
  s_add_u32 s38, s38, s33
  s_add_u32 s39, s38, 24576
  s_mov_b64 s[40:41], exec
  s_cmp_lt_u32 s16, 2
  s_cbranch_scc0 A_dma
  s_cmp_eq_u32 s30, 0
  s_cbranch_scc1 A_g0
W_36:
  s_memrealtime s[92:93]
  s_waitcnt lgkmcnt(0)
  s_sub_u32 s93, s95, s92
  s_cmp_gt_i32 s93, 0
  s_cbranch_scc1 W_36
  buffer_load_dword v56, v20, s[4:7], s83 offen sc1
H_37:
  buffer_load_dwordx2 v[52:53], v20, s[4:7], s89 offen sc1
  s_waitcnt vmcnt(0)
  v_subrev_u32 v54, s30, v52
  v_subrev_u32 v55, s30, v53
  v_or_b32 v54, v54, v55
  v_and_b32 v54, 62, v54
  v_cmp_ne_u32 vcc, 0, v54
  s_cbranch_vccz H_38
  s_add_u32 s32, s32, 1
  s_cmp_gt_u32 s32, 200000
  s_cbranch_scc1 H_38
  s_add_u32 s90, s90, 1
  s_sleep 4
  s_branch H_37
H_38:
  s_lshl_b32 s93, s92, 6
  v_subrev_u32 v52, s93, v52
  v_subrev_u32 v53, s93, v53
  v_max_i32 v52, v52, v53
  v_ashrrev_i32 v52, 6, v52
  s_nop 1
  v_max_i32 v52, v52, v52 row_ror:8 row_mask:0xf bank_mask:0xf
  v_max_i32 v56, v56, v56 row_ror:8 row_mask:0xf bank_mask:0xf
  s_nop 0
  v_max_i32 v52, v52, v52 row_ror:4 row_mask:0xf bank_mask:0xf
  v_max_i32 v56, v56, v56 row_ror:4 row_mask:0xf bank_mask:0xf
  s_nop 0
  v_max_i32 v52, v52, v52 row_ror:2 row_mask:0xf bank_mask:0xf
  v_max_i32 v56, v56, v56 row_ror:2 row_mask:0xf bank_mask:0xf
  s_nop 0
  v_max_i32 v52, v52, v52 row_ror:1 row_mask:0xf bank_mask:0xf
  v_max_i32 v56, v56, v56 row_ror:1 row_mask:0xf bank_mask:0xf
  s_nop 1
  v_readlane_b32 s96, v52, 0
  v_readlane_b32 s93, v52, 16
  s_max_i32 s96, s96, s93
  v_readlane_b32 s97, v52, 32
  v_readlane_b32 s93, v52, 48
  s_max_i32 s97, s97, s93
  s_add_u32 s93, s97, 4
  s_max_i32 s96, s96, s93
  s_min_i32 s96, s96, 2000
  s_add_u32 s96, s96, s92
  v_readlane_b32 s97, v56, 0
  v_readlane_b32 s93, v56, 16
  s_max_i32 s97, s97, s93
  v_readlane_b32 s93, v56, 32
  s_max_i32 s97, s97, s93
  s_min_i32 s97, s97, 300
  s_add_u32 s97, s97, s96
  s_add_u32 s94, s97, 19
W_39:
  s_memrealtime s[92:93]
  s_waitcnt lgkmcnt(0)
  s_sub_u32 s93, s94, s92
  s_cmp_gt_i32 s93, 0
  s_cbranch_scc1 W_39
A_g0:
  s_add_u32 s20, s24, 4096
  buffer_load_dwordx4 v[52:55], v2, s[4:7], s24 offen offset:0 sc1
  buffer_load_dwordx4 v[56:59], v2, s[4:7], s24 offen offset:1024 sc1
  buffer_load_dwordx4 v[60:63], v2, s[4:7], s24 offen offset:2048 sc1
  buffer_load_dwordx4 v[64:67], v2, s[4:7], s24 offen offset:3072 sc1
  buffer_load_dwordx4 v[68:71], v2, s[4:7], s20 offen offset:0 sc1
  s_mov_b32 s85, 0
  s_barrier
  s_branch Ag2_41
Ag_40:
  buffer_load_dwordx4 v[52:55], v2, s[4:7], s24 offen offset:0 sc1
  buffer_load_dwordx4 v[56:59], v2, s[4:7], s24 offen offset:1024 sc1
  buffer_load_dwordx4 v[60:63], v2, s[4:7], s24 offen offset:2048 sc1
  buffer_load_dwordx4 v[64:67], v2, s[4:7], s24 offen offset:3072 sc1
  buffer_load_dwordx4 v[68:71], v2, s[4:7], s20 offen offset:0 sc1
  s_mov_b32 s85, 15
Ag2_41:
  s_waitcnt vmcnt(4)
  ds_write_b128 v3, v[52:55] offset:0
  v_max3_u32 v26, v52, v53, v54
  v_max_u32 v26, v26, v55
  s_waitcnt vmcnt(3)
  ds_write_b128 v3, v[56:59] offset:1024
  v_max3_u32 v26, v56, v57, v26
  v_max3_u32 v26, v58, v59, v26
  s_waitcnt vmcnt(2)
  ds_write_b128 v3, v[60:63] offset:2048
  v_max3_u32 v26, v60, v61, v26
  v_max3_u32 v26, v62, v63, v26
  s_waitcnt vmcnt(1)
  s_memrealtime s[92:93]
  ds_write_b128 v3, v[64:67] offset:3072
  v_max3_u32 v26, v64, v65, v26
  v_max3_u32 v26, v66, v67, v26
  s_waitcnt vmcnt(0)
  ds_write_b128 v3, v[68:71] offset:4096
  v_max3_u32 v26, v68, v69, v26
  v_max3_u32 v26, v70, v71, v26
  v_cmp_eq_u32 vcc, -1, v26
  s_cbranch_vccz A_b1
  s_add_u32 s32, s32, 1
  s_cmp_gt_u32 s32, 200000
  s_cbranch_scc1 A_b1
  s_add_u32 s91, s91, 1
  s_sleep 6
  s_branch Ag_40
A_dma:
  s_barrier
  s_cmp_eq_u32 s30, 0
  s_cbranch_scc1 A_b1
  buffer_store_dwordx4 v[64:67], v15, s[4:7], s34 offen sc1
  s_mov_b64 exec, 0xffff
  buffer_store_dwordx4 v[60:63], v18, s[4:7], s35 offen sc1
  s_mov_b64 exec, -1
  s_add_u32 s34, s34, 65536
  s_add_u32 s35, s35, 16384
Af_42:
  v_min_u32 v52, v52, v53
  v_min3_u32 v52, v52, v54, v55
  s_nop 0
  v_readfirstlane_b32 s37, v52
  s_cmp_gt_u32 s37, s36
  s_cbranch_scc1 Afx_43
  s_add_u32 s32, s32, 1
  s_cmp_gt_u32 s32, 200000
  s_cbranch_scc1 Afx_43
  s_sleep 6
  buffer_load_dwordx4 v[52:55], v16, s[4:7], s28 offen sc1
  s_waitcnt vmcnt(0)
  s_branch Af_42
Afx_43:
Af_44:
  v_min_u32 v56, v56, v57
  v_min3_u32 v56, v56, v58, v59
  s_nop 0
  v_readfirstlane_b32 s37, v56
  s_cmp_gt_u32 s37, s36
  s_cbranch_scc1 Afx_45
  s_add_u32 s32, s32, 1
  s_cmp_gt_u32 s32, 200000
  s_cbranch_scc1 Afx_45
  s_sleep 6
  buffer_load_dwordx4 v[56:59], v16, s[4:7], s45 offen sc1
  s_waitcnt vmcnt(0)
  s_branch Af_44
Afx_45:
A_b1:
  s_waitcnt lgkmcnt(0)
  s_barrier
  ds_read_b64_tr_b16 v[52:53], v4 offset:0
  ds_read_b64_tr_b16 v[54:55], v4 offset:256
  ds_read_b64_tr_b16 v[56:57], v4 offset:1024
  ds_read_b64_tr_b16 v[58:59], v4 offset:1280
  ds_read_b64_tr_b16 v[60:61], v4 offset:2048
  ds_read_b64_tr_b16 v[62:63], v4 offset:2304
  s_add_u32 s86, s92, s85
  s_add_u32 s86, s86, s84
  s_mov_b32 s81, s92
  s_lshl_b32 s86, s86, 6
  s_add_u32 s93, s30, 1
  s_and_b32 s93, s93, 63
  s_or_b32 s86, s86, s93
  s_cmp_eq_u32 s47, 1
  s_cbranch_scc0 A_p1lo
  s_waitcnt lgkmcnt(4)
  v_smfmac_f32_16x16x64_bf16 v[48:51], v[52:55], v[76:83], v6
  v_smfmac_f32_16x16x64_bf16 v[28:31], v[52:55], a[0:7], v6
  ds_read_b128 v[76:79], v5 offset:32768
  ds_read_b128 v[80:83], v5 offset:33792
  v_smfmac_f32_16x16x64_bf16 v[32:35], v[52:55], a[80:87], v6
  s_add_u32 m0, s38, 0
  s_add_u32 s21, s27, 0
  buffer_load_dwordx4 v15, s[4:7], s21 offen offset:0 sc1 nt lds
  v_smfmac_f32_16x16x64_bf16 v[36:39], v[52:55], a[160:167], v6
  ds_read_b64_tr_b16 v[64:65], v4 offset:3072
  ds_read_b64_tr_b16 v[66:67], v4 offset:3328
  v_smfmac_f32_16x16x64_bf16 v[40:43], v[52:55], a[240:247], v6
  v_smfmac_f32_16x16x64_bf16 v[44:47], v[52:55], v[176:183], v6
  buffer_load_dwordx4 v15, s[4:7], s21 offen offset:1024 sc1 nt lds
  s_waitcnt lgkmcnt(6)
  v_smfmac_f32_16x16x64_bf16 v[48:51], v[56:59], v[84:91], v6
  buffer_load_dwordx4 v15, s[4:7], s21 offen offset:2048 sc1 nt lds
  v_smfmac_f32_16x16x64_bf16 v[28:31], v[56:59], a[8:15], v6
  ds_read_b128 v[84:87], v5 offset:40960
  ds_read_b128 v[88:91], v5 offset:41984
  v_smfmac_f32_16x16x64_bf16 v[32:35], v[56:59], a[88:95], v6
  buffer_load_dwordx4 v15, s[4:7], s21 offen offset:3072 sc1 nt lds
  v_smfmac_f32_16x16x64_bf16 v[36:39], v[56:59], a[168:175], v6
  ds_read_b64_tr_b16 v[68:69], v4 offset:4096
  ds_read_b64_tr_b16 v[70:71], v4 offset:4352
  v_smfmac_f32_16x16x64_bf16 v[40:43], v[56:59], a[248:255], v6
  v_smfmac_f32_16x16x64_bf16 v[44:47], v[56:59], v[184:191], v6
  s_add_u32 m0, s38, 4096
  s_add_u32 s21, s27, 4096
  buffer_load_dwordx4 v15, s[4:7], s21 offen offset:0 sc1 nt lds
  s_waitcnt lgkmcnt(8)
  v_smfmac_f32_16x16x64_bf16 v[48:51], v[60:63], v[92:99], v6
  buffer_load_dwordx4 v15, s[4:7], s21 offen offset:1024 sc1 nt lds
  s_add_u32 s27, s27, 12288
  v_smfmac_f32_16x16x64_bf16 v[28:31], v[60:63], a[16:23], v6
  ds_read_b128 v[92:95], v5 offset:49152
  ds_read_b128 v[96:99], v5 offset:50176
  v_smfmac_f32_16x16x64_bf16 v[32:35], v[60:63], a[96:103], v6
  s_add_u32 m0, s39, 0
  s_add_u32 s21, s44, 0
  buffer_load_dwordx4 v15, s[4:7], s21 offen offset:0 sc1 nt lds
  v_smfmac_f32_16x16x64_bf16 v[36:39], v[60:63], a[176:183], v6
  ds_read_b64_tr_b16 v[72:73], v4 offset:5120
  ds_read_b64_tr_b16 v[74:75], v4 offset:5376
  v_smfmac_f32_16x16x64_bf16 v[40:43], v[60:63], v[112:119], v6
  ds_read_b64_tr_b16 v[52:53], v4 offset:6144
  ds_read_b64_tr_b16 v[54:55], v4 offset:6400
  v_smfmac_f32_16x16x64_bf16 v[44:47], v[60:63], v[192:199], v6
  buffer_load_dwordx4 v15, s[4:7], s21 offen offset:1024 sc1 nt lds
  s_waitcnt lgkmcnt(10)
  v_smfmac_f32_16x16x64_bf16 v[48:51], v[64:67], v[100:107], v6
  buffer_load_dwordx4 v15, s[4:7], s21 offen offset:2048 sc1 nt lds
  v_smfmac_f32_16x16x64_bf16 v[28:31], v[64:67], a[24:31], v6
  ds_read_b128 v[100:103], v5 offset:57344
  ds_read_b128 v[104:107], v5 offset:58368
  v_smfmac_f32_16x16x64_bf16 v[32:35], v[64:67], a[104:111], v6
  buffer_load_dwordx4 v15, s[4:7], s21 offen offset:3072 sc1 nt lds
  v_smfmac_f32_16x16x64_bf16 v[36:39], v[64:67], a[184:191], v6
  ds_read_b64_tr_b16 v[56:57], v4 offset:7168
  ds_read_b64_tr_b16 v[58:59], v4 offset:7424
  v_smfmac_f32_16x16x64_bf16 v[40:43], v[64:67], v[120:127], v6
  ds_read_b64_tr_b16 v[60:61], v4 offset:8192
  ds_read_b64_tr_b16 v[62:63], v4 offset:8448
  v_smfmac_f32_16x16x64_bf16 v[44:47], v[64:67], v[200:207], v6
  s_add_u32 m0, s39, 4096
  s_add_u32 s21, s44, 4096
  buffer_load_dwordx4 v15, s[4:7], s21 offen offset:0 sc1 nt lds
  s_waitcnt lgkmcnt(12)
  v_smfmac_f32_16x16x64_bf16 v[48:51], v[68:71], v[76:83], v6
  buffer_load_dwordx4 v15, s[4:7], s21 offen offset:1024 sc1 nt lds
  s_add_u32 s44, s44, 12288
  v_smfmac_f32_16x16x64_bf16 v[28:31], v[68:71], a[32:39], v6
  ds_read_b128 v[76:79], v22 offset:0
  ds_read_b128 v[80:83], v22 offset:1024
  v_smfmac_f32_16x16x64_bf16 v[32:35], v[68:71], a[112:119], v6
  v_smfmac_f32_16x16x64_bf16 v[36:39], v[68:71], a[192:199], v6
  ds_read_b64_tr_b16 v[64:65], v4 offset:9216
  ds_read_b64_tr_b16 v[66:67], v4 offset:9472
  v_smfmac_f32_16x16x64_bf16 v[40:43], v[68:71], v[128:135], v6
  v_smfmac_f32_16x16x64_bf16 v[44:47], v[68:71], v[208:215], v6
  s_branch A_p1x
A_p1lo:
  s_waitcnt lgkmcnt(4)
  v_smfmac_f32_16x16x64_bf16 v[48:51], v[52:55], v[76:83], v6
  v_mov_b32 v26, s86
  s_mov_b64 exec, s[42:43]
  buffer_store_dword v26, v16, s[4:7], s87 offen sc1
  s_mov_b64 exec, -1
  v_smfmac_f32_16x16x64_bf16 v[28:31], v[52:55], a[0:7], v6
  ds_read_b128 v[76:79], v5 offset:32768
  ds_read_b128 v[80:83], v5 offset:33792
  v_smfmac_f32_16x16x64_bf16 v[32:35], v[52:55], a[80:87], v6
  v_smfmac_f32_16x16x64_bf16 v[36:39], v[52:55], a[160:167], v6
  ds_read_b64_tr_b16 v[64:65], v4 offset:3072
  ds_read_b64_tr_b16 v[66:67], v4 offset:3328
  v_smfmac_f32_16x16x64_bf16 v[40:43], v[52:55], a[240:247], v6
  v_smfmac_f32_16x16x64_bf16 v[44:47], v[52:55], v[176:183], v6
  s_waitcnt lgkmcnt(6)
  v_smfmac_f32_16x16x64_bf16 v[48:51], v[56:59], v[84:91], v6
  v_smfmac_f32_16x16x64_bf16 v[28:31], v[56:59], a[8:15], v6
  ds_read_b128 v[84:87], v5 offset:40960
  ds_read_b128 v[88:91], v5 offset:41984
  v_smfmac_f32_16x16x64_bf16 v[32:35], v[56:59], a[88:95], v6
  v_smfmac_f32_16x16x64_bf16 v[36:39], v[56:59], a[168:175], v6
  ds_read_b64_tr_b16 v[68:69], v4 offset:4096
  ds_read_b64_tr_b16 v[70:71], v4 offset:4352
  v_smfmac_f32_16x16x64_bf16 v[40:43], v[56:59], a[248:255], v6
  v_smfmac_f32_16x16x64_bf16 v[44:47], v[56:59], v[184:191], v6
  s_mov_b64 exec, s[42:43]
  buffer_store_dwordx2 v[24:25], v14, s[4:7], s26 offen sc1
  s_mov_b64 exec, -1
  s_waitcnt lgkmcnt(8)
  v_smfmac_f32_16x16x64_bf16 v[48:51], v[60:63], v[92:99], v6
  v_smfmac_f32_16x16x64_bf16 v[28:31], v[60:63], a[16:23], v6
  ds_read_b128 v[92:95], v5 offset:49152
  ds_read_b128 v[96:99], v5 offset:50176
  v_smfmac_f32_16x16x64_bf16 v[32:35], v[60:63], a[96:103], v6
  v_smfmac_f32_16x16x64_bf16 v[36:39], v[60:63], a[176:183], v6
  ds_read_b64_tr_b16 v[72:73], v4 offset:5120
  ds_read_b64_tr_b16 v[74:75], v4 offset:5376
  v_smfmac_f32_16x16x64_bf16 v[40:43], v[60:63], v[112:119], v6
  ds_read_b64_tr_b16 v[52:53], v4 offset:6144
  ds_read_b64_tr_b16 v[54:55], v4 offset:6400
  v_smfmac_f32_16x16x64_bf16 v[44:47], v[60:63], v[192:199], v6
  s_waitcnt lgkmcnt(10)
  v_smfmac_f32_16x16x64_bf16 v[48:51], v[64:67], v[100:107], v6
  v_smfmac_f32_16x16x64_bf16 v[28:31], v[64:67], a[24:31], v6
  ds_read_b128 v[100:103], v5 offset:57344
  ds_read_b128 v[104:107], v5 offset:58368
  v_smfmac_f32_16x16x64_bf16 v[32:35], v[64:67], a[104:111], v6
  v_smfmac_f32_16x16x64_bf16 v[36:39], v[64:67], a[184:191], v6
  ds_read_b64_tr_b16 v[56:57], v4 offset:7168
  ds_read_b64_tr_b16 v[58:59], v4 offset:7424
  v_smfmac_f32_16x16x64_bf16 v[40:43], v[64:67], v[120:127], v6
  ds_read_b64_tr_b16 v[60:61], v4 offset:8192
  ds_read_b64_tr_b16 v[62:63], v4 offset:8448
  v_smfmac_f32_16x16x64_bf16 v[44:47], v[64:67], v[200:207], v6
  s_waitcnt lgkmcnt(12)
  v_smfmac_f32_16x16x64_bf16 v[48:51], v[68:71], v[76:83], v6
  v_smfmac_f32_16x16x64_bf16 v[28:31], v[68:71], a[32:39], v6
  ds_read_b128 v[76:79], v22 offset:0
  ds_read_b128 v[80:83], v22 offset:1024
  v_smfmac_f32_16x16x64_bf16 v[32:35], v[68:71], a[112:119], v6
  v_smfmac_f32_16x16x64_bf16 v[36:39], v[68:71], a[192:199], v6
  ds_read_b64_tr_b16 v[64:65], v4 offset:9216
  ds_read_b64_tr_b16 v[66:67], v4 offset:9472
  v_smfmac_f32_16x16x64_bf16 v[40:43], v[68:71], v[128:135], v6
  v_smfmac_f32_16x16x64_bf16 v[44:47], v[68:71], v[208:215], v6
A_p1x:
  s_waitcnt lgkmcnt(12)
  v_smfmac_f32_16x16x64_bf16 v[48:51], v[72:75], v[84:91], v6
  v_smfmac_f32_16x16x64_bf16 v[36:39], v[72:75], a[200:207], v6
  ds_read_b128 v[84:87], v22 offset:8192
  ds_read_b128 v[88:91], v22 offset:9216
  s_waitcnt lgkmcnt(12)
  v_smfmac_f32_16x16x64_bf16 v[48:51], v[52:55], v[92:99], v6
  v_smfmac_f32_16x16x64_bf16 v[36:39], v[52:55], a[208:215], v6
  s_waitcnt lgkmcnt(8)
  v_smfmac_f32_16x16x64_bf16 v[48:51], v[56:59], v[100:107], v6
  v_smfmac_f32_16x16x64_bf16 v[36:39], v[56:59], a[216:223], v6
  ds_read_b64 v[94:95], v10 offset:0
  ds_read_b64 v[96:97], v10 offset:512
  s_waitcnt lgkmcnt(6)
  v_smfmac_f32_16x16x64_bf16 v[48:51], v[60:63], v[76:83], v6
  ds_read_b64 v[92:93], v10 offset:1024
  v_smfmac_f32_16x16x64_bf16 v[36:39], v[60:63], a[224:231], v6
  ds_read_b64 v[102:103], v10 offset:64
  ds_read_b64 v[104:105], v10 offset:576
  s_waitcnt lgkmcnt(5)
  v_smfmac_f32_16x16x64_bf16 v[48:51], v[64:67], v[84:91], v6
  ds_read_b64 v[100:101], v10 offset:1088
  v_smfmac_f32_16x16x64_bf16 v[36:39], v[64:67], a[232:239], v6
  v_smfmac_f32_16x16x64_bf16 v[40:43], v[72:75], v[136:143], v6
  v_smfmac_f32_16x16x64_bf16 v[28:31], v[72:75], a[40:47], v6
  v_permlane32_swap_b32 v36, v48
  v_permlane32_swap_b32 v37, v49
  v_smfmac_f32_16x16x64_bf16 v[40:43], v[52:55], v[144:151], v6
  v_permlane32_swap_b32 v38, v50
  v_smfmac_f32_16x16x64_bf16 v[28:31], v[52:55], a[48:55], v6
  v_permlane32_swap_b32 v39, v51
  v_add_f32 v36, v36, v48
  v_smfmac_f32_16x16x64_bf16 v[40:43], v[56:59], v[152:159], v6
  v_add_f32 v37, v37, v49
  v_smfmac_f32_16x16x64_bf16 v[28:31], v[56:59], a[56:63], v6
  v_add_f32 v38, v38, v50
  v_add_f32 v39, v39, v51
  v_smfmac_f32_16x16x64_bf16 v[40:43], v[60:63], v[160:167], v6
  v_cvt_pk_bf16_f32 v36, v36, v37
  v_smfmac_f32_16x16x64_bf16 v[28:31], v[60:63], a[64:71], v6
  v_cvt_pk_bf16_f32 v37, v38, v39
  ds_write2_b32 v7, v36, v37 offset0:128 offset1:130
  v_smfmac_f32_16x16x64_bf16 v[40:43], v[64:67], v[168:175], v6
  ds_read_b64_tr_b16 v[84:85], v8 offset:512
  v_smfmac_f32_16x16x64_bf16 v[28:31], v[64:67], a[72:79], v6
  ds_read_b64_tr_b16 v[76:77], v8 offset:3584
  v_smfmac_f32_16x16x64_bf16 v[44:47], v[72:75], v[216:223], v6
  v_smfmac_f32_16x16x64_bf16 v[32:35], v[72:75], a[120:127], v6
  v_permlane32_swap_b32 v28, v40
  v_permlane32_swap_b32 v29, v41
  v_smfmac_f32_16x16x64_bf16 v[44:47], v[52:55], v[224:231], v6
  v_permlane32_swap_b32 v30, v42
  v_smfmac_f32_16x16x64_bf16 v[32:35], v[52:55], a[128:135], v6
  v_permlane32_swap_b32 v31, v43
  v_add_f32 v28, v28, v40
  v_smfmac_f32_16x16x64_bf16 v[44:47], v[56:59], v[232:239], v6
  v_add_f32 v29, v29, v41
  v_smfmac_f32_16x16x64_bf16 v[32:35], v[56:59], a[136:143], v6
  v_add_f32 v30, v30, v42
  v_add_f32 v31, v31, v43
  v_smfmac_f32_16x16x64_bf16 v[44:47], v[60:63], v[240:247], v6
  v_cvt_pk_bf16_f32 v28, v28, v29
  v_smfmac_f32_16x16x64_bf16 v[32:35], v[60:63], a[144:151], v6
  v_cvt_pk_bf16_f32 v29, v30, v31
  ds_write2_b32 v7, v28, v29 offset0:0 offset1:2
  v_smfmac_f32_16x16x64_bf16 v[44:47], v[64:67], v[248:255], v6
  ds_read_b64_tr_b16 v[86:87], v8 offset:0
  v_smfmac_f32_16x16x64_bf16 v[32:35], v[64:67], a[152:159], v6
  ds_read_b64_tr_b16 v[78:79], v8 offset:3072
  s_nop 6
  v_permlane32_swap_b32 v32, v44
  v_permlane32_swap_b32 v33, v45
  v_permlane32_swap_b32 v34, v46
  v_permlane32_swap_b32 v35, v47
  v_add_f32 v32, v32, v44
  v_add_f32 v33, v33, v45
  v_add_f32 v34, v34, v46
  v_add_f32 v35, v35, v47
  v_cvt_pk_bf16_f32 v32, v32, v33
  v_cvt_pk_bf16_f32 v33, v34, v35
  ds_write2_b32 v7, v32, v33 offset0:64 offset1:66
  ds_read_b64_tr_b16 v[110:111], v8 offset:256
  ds_read_b64_tr_b16 v[80:81], v8 offset:3328
  s_waitcnt lgkmcnt(3)
  v_mfma_f32_16x16x32_bf16 v[68:71], v[92:95], v[84:87], 0
  v_mfma_f32_16x16x32_bf16 v[48:51], v[100:103], v[84:87], 0
  v_mfma_f32_16x16x32_bf16 v[88:91], v[76:79], v[84:87], 0
  s_mov_b32 exec_lo, 0x00ff00ff
  s_mov_b32 exec_hi, 0x00ff00ff
  s_cmp_lt_u32 s16, 2
  s_waitcnt lgkmcnt(1)
  v_mfma_f32_16x16x32_bf16 v[68:71], v[94:97], v[108:111], v[68:71]
  v_mfma_f32_16x16x32_bf16 v[48:51], v[102:105], v[108:111], v[48:51]
  s_waitcnt lgkmcnt(0)
  v_mfma_f32_16x16x32_bf16 v[88:91], v[78:81], v[108:111], v[88:91]
  s_nop 0
  ds_write_b128 v11, v[68:71]
  s_nop 2
  ds_write_b128 v11, v[48:51] offset:144
  s_mov_b32 exec_hi, 0
  s_nop 1
  ds_write_b128 v12, v[88:91] offset:1152
  s_mov_b64 exec, s[40:41]
  s_waitcnt lgkmcnt(0)
  s_barrier
  s_cbranch_scc0 A_px
  ds_read_b128 v[52:55], v13 offset:0
  ds_read_b128 v[56:59], v13 offset:2304
  ds_read_b128 v[60:63], v13 offset:4608
  ds_read_b128 v[64:67], v13 offset:6912
  v_mov_b32 v69, 0.10411754627697264
  s_waitcnt lgkmcnt(2)
  v_pk_add_f32 v[52:53], v[52:53], v[56:57]
  v_pk_add_f32 v[54:55], v[54:55], v[58:59]
  s_waitcnt lgkmcnt(1)
  v_pk_add_f32 v[52:53], v[52:53], v[60:61]
  v_pk_add_f32 v[54:55], v[54:55], v[62:63]
  s_waitcnt lgkmcnt(0)
  v_pk_add_f32 v[52:53], v[52:53], v[64:65]
  v_pk_add_f32 v[54:55], v[54:55], v[66:67]
  v_max_f32 v68, v52, v53
  v_max3_f32 v68, v68, v54, v55
  s_nop 1
  v_max_f32 v68, v68, v68 row_ror:8 row_mask:0xf bank_mask:0xf
  s_nop 1
  v_max_f32 v68, v68, v68 row_ror:4 row_mask:0xf bank_mask:0xf
  s_nop 1
  v_max_f32 v68, v68, v68 row_ror:2 row_mask:0xf bank_mask:0xf
  s_nop 1
  v_max_f32 v68, v68, v68 row_ror:1 row_mask:0xf bank_mask:0xf
  v_mul_f32 v68, v68, v69
  v_fma_f32 v52, v52, v69, -v68
  v_fma_f32 v53, v53, v69, -v68
  v_fma_f32 v54, v54, v69, -v68
  v_fma_f32 v55, v55, v69, -v68
  v_exp_f32 v52, v52
  v_exp_f32 v53, v53
  v_exp_f32 v54, v54
  v_exp_f32 v55, v55
  v_add_f32 v68, v52, v53
  v_add_f32 v69, v54, v55
  v_add_f32 v68, v68, v69
  s_nop 1
  v_add_f32 v68, v68, v68 row_ror:8 row_mask:0xf bank_mask:0xf
  s_nop 1
  v_add_f32 v68, v68, v68 row_ror:4 row_mask:0xf bank_mask:0xf
  s_nop 1
  v_add_f32 v68, v68, v68 row_ror:2 row_mask:0xf bank_mask:0xf
  s_nop 1
  v_add_f32 v68, v68, v68 row_ror:1 row_mask:0xf bank_mask:0xf
  v_rcp_f32 v68, v68
  s_mov_b64 exec, s[42:43]
  v_pk_mul_f32 v[52:53], v[52:53], v[68:69] op_sel_hi:[1,0]
  v_pk_mul_f32 v[54:55], v[54:55], v[68:69] op_sel_hi:[1,0]
  v_cvt_pk_bf16_f32 v52, v52, v53
  v_cvt_pk_bf16_f32 v53, v54, v55
  buffer_store_dwordx2 v[52:53], v14, s[4:7], s25 offen sc1
  s_memrealtime s[92:93]
  s_waitcnt lgkmcnt(0)
  s_mov_b64 exec, s[40:41]
  s_sub_u32 s93, s92, s81
  s_add_u32 s82, s84, 20
  s_cmp_gt_i32 s93, s82
  s_cselect_b32 s93, s84, s93
  s_sub_u32 s82, s84, 1
  s_max_i32 s93, s93, s82
  s_add_u32 s82, s84, 8
  s_min_i32 s93, s93, s82
  s_cmp_eq_u32 s85, 0
  s_cselect_b32 s84, s93, s84
  s_branch A_next
A_px:
  s_cmp_eq_u32 s30, 0
  s_cbranch_scc0 A_px1
  v_mov_b32 v84, 0
  v_mov_b32 v85, 0
  v_mov_b32 v86, 0
  v_mov_b32 v87, 0
  v_mov_b32 v88, 0
  v_mov_b32 v89, 0
  v_mov_b32 v90, 0
  v_mov_b32 v91, 0
  s_add_u32 s46, s33, 132096
Af_46:
  v_min_u32 v88, v88, v89
  v_min3_u32 v88, v88, v90, v91
  s_nop 0
  v_readfirstlane_b32 s37, v88
  s_cmp_gt_u32 s37, s30
  s_cbranch_scc1 Afx_47
  s_add_u32 s32, s32, 1
  s_cmp_gt_u32 s32, 200000
  s_cbranch_scc1 Afx_47
  s_sleep 6
  buffer_load_dwordx4 v[88:91], v16, s[4:7], s45 offen sc1
  s_waitcnt vmcnt(0)
  s_branch Af_46
Afx_47:
  s_add_u32 m0, s46, 0
  s_add_u32 s21, s44, 0
  buffer_load_dwordx4 v15, s[4:7], s21 offen sc1 lds
  s_add_u32 m0, s46, 1024
  s_add_u32 s21, s44, 1024
  buffer_load_dwordx4 v15, s[4:7], s21 offen sc1 lds
  s_add_u32 m0, s46, 2048
  s_add_u32 s21, s44, 2048
  buffer_load_dwordx4 v15, s[4:7], s21 offen sc1 lds
  s_add_u32 m0, s46, 3072
  s_add_u32 s21, s44, 3072
  buffer_load_dwordx4 v15, s[4:7], s21 offen sc1 lds
  s_add_u32 m0, s46, 4096
  s_add_u32 s21, s44, 4096
  buffer_load_dwordx4 v15, s[4:7], s21 offen sc1 lds
  s_add_u32 m0, s46, 5120
  s_add_u32 s21, s44, 5120
  buffer_load_dwordx4 v15, s[4:7], s21 offen sc1 lds
  s_add_u32 s44, s44, 12288
Af_48:
  v_min_u32 v84, v84, v85
  v_min3_u32 v84, v84, v86, v87
  s_nop 0
  v_readfirstlane_b32 s37, v84
  s_cmp_gt_u32 s37, s36
  s_cbranch_scc1 Afx_49
  s_add_u32 s32, s32, 1
  s_cmp_gt_u32 s32, 200000
  s_cbranch_scc1 Afx_49
  s_sleep 6
  buffer_load_dwordx4 v[84:87], v16, s[4:7], s28 offen sc1
  s_waitcnt vmcnt(0)
  s_branch Af_48
Afx_49:
  s_add_u32 m0, s38, 0
  s_add_u32 s21, s27, 0
  buffer_load_dwordx4 v15, s[4:7], s21 offen sc1 lds
  s_add_u32 m0, s38, 1024
  s_add_u32 s21, s27, 1024
  buffer_load_dwordx4 v15, s[4:7], s21 offen sc1 lds
  s_add_u32 m0, s38, 2048
  s_add_u32 s21, s27, 2048
  buffer_load_dwordx4 v15, s[4:7], s21 offen sc1 lds
  s_add_u32 m0, s38, 3072
  s_add_u32 s21, s27, 3072
  buffer_load_dwordx4 v15, s[4:7], s21 offen sc1 lds
  s_add_u32 m0, s38, 4096
  s_add_u32 s21, s27, 4096
  buffer_load_dwordx4 v15, s[4:7], s21 offen sc1 lds
  s_add_u32 m0, s38, 5120
  s_add_u32 s21, s27, 5120
  buffer_load_dwordx4 v15, s[4:7], s21 offen sc1 lds
  s_add_u32 s27, s27, 12288
Af_50:
  v_min_u32 v88, v88, v89
  v_min3_u32 v88, v88, v90, v91
  s_nop 0
  v_readfirstlane_b32 s37, v88
  s_cmp_gt_u32 s37, s36
  s_cbranch_scc1 Afx_51
  s_add_u32 s32, s32, 1
  s_cmp_gt_u32 s32, 200000
  s_cbranch_scc1 Afx_51
  s_sleep 6
  buffer_load_dwordx4 v[88:91], v16, s[4:7], s45 offen sc1
  s_waitcnt vmcnt(0)
  s_branch Af_50
Afx_51:
  s_add_u32 m0, s39, 0
  s_add_u32 s21, s44, 0
  buffer_load_dwordx4 v15, s[4:7], s21 offen sc1 lds
  s_add_u32 m0, s39, 1024
  s_add_u32 s21, s44, 1024
  buffer_load_dwordx4 v15, s[4:7], s21 offen sc1 lds
  s_add_u32 m0, s39, 2048
  s_add_u32 s21, s44, 2048
  buffer_load_dwordx4 v15, s[4:7], s21 offen sc1 lds
  s_add_u32 m0, s39, 3072
  s_add_u32 s21, s44, 3072
  buffer_load_dwordx4 v15, s[4:7], s21 offen sc1 lds
  s_add_u32 m0, s39, 4096
  s_add_u32 s21, s44, 4096
  buffer_load_dwordx4 v15, s[4:7], s21 offen sc1 lds
  s_add_u32 m0, s39, 5120
  s_add_u32 s21, s44, 5120
  buffer_load_dwordx4 v15, s[4:7], s21 offen sc1 lds
  s_add_u32 s44, s44, 12288
  s_waitcnt vmcnt(0)
A_px1:
  s_add_u32 s20, s33, 24576
  v_add_u32 v26, s20, v19
  ds_read_b128 v[60:63], v27 offset:0
  ds_read_b128 v[64:67], v27 offset:1024
  ds_read_b128 v[68:71], v27 offset:2048
  ds_read_b128 v[28:31], v26 offset:0
  ds_read_b64_tr_b16 v[32:33], v17 offset:0
  ds_read_b64_tr_b16 v[34:35], v17 offset:64
  ds_read_b128 v[36:39], v19 offset:0
  ds_read_b128 v[40:43], v19 offset:6144
  ds_read_b128 v[44:47], v26 offset:1024
  ds_read_b64_tr_b16 v[48:49], v17 offset:512
  ds_read_b64_tr_b16 v[50:51], v17 offset:576
  ds_read_b128 v[52:55], v19 offset:1024
  ds_read_b128 v[56:59], v19 offset:7168
  buffer_load_dwordx4 v[84:87], v16, s[4:7], s28 offen sc1
  buffer_load_dwordx4 v[88:91], v16, s[4:7], s45 offen sc1
  s_waitcnt lgkmcnt(5)
  v_mfma_f32_16x16x32_bf16 v[60:63], v[32:35], v[28:31], v[60:63]
  v_mfma_f32_16x16x32_bf16 v[64:67], v[36:39], v[28:31], v[64:67]
  v_mfma_f32_16x16x32_bf16 v[68:71], v[40:43], v[28:31], v[68:71]
  s_nop 3
  ds_read_b128 v[28:31], v26 offset:2048
  ds_read_b64_tr_b16 v[32:33], v17 offset:1024
  ds_read_b64_tr_b16 v[34:35], v17 offset:1088
  ds_read_b128 v[36:39], v19 offset:2048
  ds_read_b128 v[40:43], v19 offset:8192
  s_waitcnt lgkmcnt(5)
  v_mfma_f32_16x16x32_bf16 v[60:63], v[48:51], v[44:47], v[60:63]
  v_mfma_f32_16x16x32_bf16 v[64:67], v[52:55], v[44:47], v[64:67]
  v_mfma_f32_16x16x32_bf16 v[68:71], v[56:59], v[44:47], v[68:71]
  s_nop 3
  ds_read_b128 v[44:47], v26 offset:3072
  ds_read_b64_tr_b16 v[48:49], v17 offset:1536
  ds_read_b64_tr_b16 v[50:51], v17 offset:1600
  ds_read_b128 v[52:55], v19 offset:3072
  ds_read_b128 v[56:59], v19 offset:9216
  s_waitcnt lgkmcnt(5)
  v_mfma_f32_16x16x32_bf16 v[60:63], v[32:35], v[28:31], v[60:63]
  v_mfma_f32_16x16x32_bf16 v[64:67], v[36:39], v[28:31], v[64:67]
  v_mfma_f32_16x16x32_bf16 v[68:71], v[40:43], v[28:31], v[68:71]
  s_nop 3
  ds_read_b128 v[28:31], v26 offset:4096
  ds_read_b64_tr_b16 v[32:33], v17 offset:2048
  ds_read_b64_tr_b16 v[34:35], v17 offset:2112
  ds_read_b128 v[36:39], v19 offset:4096
  ds_read_b128 v[40:43], v19 offset:10240
  s_waitcnt lgkmcnt(5)
  v_mfma_f32_16x16x32_bf16 v[60:63], v[48:51], v[44:47], v[60:63]
  v_mfma_f32_16x16x32_bf16 v[64:67], v[52:55], v[44:47], v[64:67]
  v_mfma_f32_16x16x32_bf16 v[68:71], v[56:59], v[44:47], v[68:71]
  s_nop 3
  ds_read_b128 v[44:47], v26 offset:5120
  ds_read_b64_tr_b16 v[48:49], v17 offset:2560
  ds_read_b64_tr_b16 v[50:51], v17 offset:2624
  ds_read_b128 v[52:55], v19 offset:5120
  ds_read_b128 v[56:59], v19 offset:11264
  s_waitcnt lgkmcnt(5)
  v_mfma_f32_16x16x32_bf16 v[60:63], v[32:35], v[28:31], v[60:63]
  v_mfma_f32_16x16x32_bf16 v[64:67], v[36:39], v[28:31], v[64:67]
  v_mfma_f32_16x16x32_bf16 v[68:71], v[40:43], v[28:31], v[68:71]
  s_waitcnt lgkmcnt(0)
  v_mfma_f32_16x16x32_bf16 v[60:63], v[48:51], v[44:47], v[60:63]
  v_mfma_f32_16x16x32_bf16 v[64:67], v[52:55], v[44:47], v[64:67]
  v_mfma_f32_16x16x32_bf16 v[68:71], v[56:59], v[44:47], v[68:71]
  s_nop 7
  v_max3_f32 v72, v60, v61, v62
  v_max3_f32 v72, v72, v63, v64
  v_max3_f32 v72, v72, v65, v66
  v_max3_f32 v72, v72, v67, v68
  v_max3_f32 v72, v72, v69, v70
  v_max_f32 v72, v72, v71
  v_mov_b32 v73, v72
  s_nop 1
  v_permlane32_swap_b32 v73, v72
  s_nop 1
  v_max_f32 v72, v72, v73
  v_mov_b32 v73, v72
  s_nop 1
  v_permlane16_swap_b32 v73, v72
  s_nop 1
  v_max_f32 v72, v72, v73
  v_mov_b32 v73, 0.10411754627697264
  v_mul_f32 v72, v72, v73
  v_fma_f32 v60, v60, v73, -v72
  v_fma_f32 v61, v61, v73, -v72
  v_fma_f32 v62, v62, v73, -v72
  v_fma_f32 v63, v63, v73, -v72
  v_fma_f32 v64, v64, v73, -v72
  v_fma_f32 v65, v65, v73, -v72
  v_fma_f32 v66, v66, v73, -v72
  v_fma_f32 v67, v67, v73, -v72
  v_fma_f32 v68, v68, v73, -v72
  v_fma_f32 v69, v69, v73, -v72
  v_fma_f32 v70, v70, v73, -v72
  v_fma_f32 v71, v71, v73, -v72
  v_exp_f32 v60, v60
  v_exp_f32 v61, v61
  v_exp_f32 v62, v62
  v_exp_f32 v63, v63
  v_exp_f32 v64, v64
  v_exp_f32 v65, v65
  v_exp_f32 v66, v66
  v_exp_f32 v67, v67
  v_exp_f32 v68, v68
  v_exp_f32 v69, v69
  v_exp_f32 v70, v70
  v_exp_f32 v71, v71
  v_add_f32 v72, v60, v61
  v_add_f32 v72, v72, v62
  v_add_f32 v72, v72, v63
  v_add_f32 v72, v72, v64
  v_add_f32 v72, v72, v65
  v_add_f32 v72, v72, v66
  v_add_f32 v72, v72, v67
  v_add_f32 v72, v72, v68
  v_add_f32 v72, v72, v69
  v_add_f32 v72, v72, v70
  v_add_f32 v72, v72, v71
  v_mov_b32 v73, v72
  s_nop 1
  v_permlane32_swap_b32 v73, v72
  s_nop 1
  v_add_f32 v72, v72, v73
  v_mov_b32 v73, v72
  s_nop 1
  v_permlane16_swap_b32 v73, v72
  s_nop 1
  v_add_f32 v72, v72, v73
  v_rcp_f32 v72, v72
  s_nop 0
  v_mul_f32 v60, v60, v72
  v_mul_f32 v61, v61, v72
  v_mul_f32 v62, v62, v72
  v_mul_f32 v63, v63, v72
  v_mul_f32 v64, v64, v72
  v_mul_f32 v65, v65, v72
  v_mul_f32 v66, v66, v72
  v_mul_f32 v67, v67, v72
  v_mul_f32 v68, v68, v72
  v_mul_f32 v69, v69, v72
  v_mul_f32 v70, v70, v72
  v_mul_f32 v71, v71, v72
  v_cvt_pk_bf16_f32 v60, v60, v61
  v_cvt_pk_bf16_f32 v62, v62, v63
  v_cvt_pk_bf16_f32 v64, v64, v65
  v_cvt_pk_bf16_f32 v65, v66, v67
  v_cvt_pk_bf16_f32 v66, v68, v69
  v_cvt_pk_bf16_f32 v67, v70, v71
  v_mov_b32 v61, v60
  v_mov_b32 v63, v62
  v_mov_b32 v72, v60
  v_mov_b32 v73, v62
  s_nop 1
  v_permlane16_swap_b32 v72, v61
  v_permlane16_swap_b32 v73, v63
  s_waitcnt vmcnt(0)
  v_mov_b32 v72, s30
  buffer_store_dword v72, v16, s[4:7], s29 offen sc1
  v_mov_b32 v52, v84
  v_mov_b32 v53, v85
  v_mov_b32 v54, v86
  v_mov_b32 v55, v87
  v_mov_b32 v56, v88
  v_mov_b32 v57, v89
  v_mov_b32 v58, v90
  v_mov_b32 v59, v91
  s_mov_b32 s47, 1
A_next:
  s_mov_b32 s26, s25
  s_sub_u32 s31, 227328, s31
  s_add_u32 s24, s24, 32768
  s_cmp_eq_u32 s24, 196608
  s_cselect_b32 s24, 65536, s24
  s_add_u32 s25, s25, 65536
  s_cmp_eq_u32 s25, 458752
  s_cselect_b32 s25, 196608, s25
  s_add_u32 s30, s30, 1
  s_cmp_lt_u32 s30, 64
  s_cbranch_scc1 A_loop
  s_cmp_lt_u32 s16, 2
  s_cbranch_scc1 A_end
  buffer_store_dwordx4 v[64:67], v15, s[4:7], s34 offen sc1
  s_mov_b64 exec, 0xffff
  buffer_store_dwordx4 v[60:63], v18, s[4:7], s35 offen sc1
  s_mov_b64 exec, -1
  s_add_u32 s34, s34, 65536
  s_add_u32 s35, s35, 16384
  s_waitcnt vmcnt(0)
  v_mov_b32 v72, s30
  buffer_store_dword v72, v16, s[4:7], s29 offen sc1
A_end:
  s_endpgm
R_B:
  s_load_dwordx2 s[8:9], s[0:1], 32
  s_mov_b32 s10, 7864320
  s_mov_b32 s11, 0x20000
  s_load_dwordx2 s[12:13], s[0:1], 40
  s_mov_b32 s14, 7864320
  s_mov_b32 s15, 0x20000
  s_mul_i32 s24, s17, 384
  s_mul_i32 s25, s17, 245760
  s_waitcnt lgkmcnt(0)
  v_lshrrev_b32 v40, 3, v1
  s_lshl_b32 s20, s16, 3
  v_add_u32 v40, s20, v40
  v_mul_u32_u24 v40, 12288, v40
  v_and_b32 v41, 7, v1
  s_lshl_b32 s20, s16, 1
  v_xor_b32 v41, s20, v41
  v_lshl_add_u32 v2, v41, 4, v40
  v_lshrrev_b32 v40, 4, v1
  v_and_b32 v41, 1, v40
  v_lshrrev_b32 v40, 1, v40
  v_lshl_or_b32 v40, v41, 1, v40
  v_mul_u32_u24 v41, 3072, v40
  v_bfe_u32 v42, v1, 2, 2
  v_lshl_add_u32 v41, v42, 7, v41
  v_and_b32 v42, 3, v1
  v_lshl_add_u32 v41, v42, 3, v41
  s_mul_i32 s20, s16, 3
  s_add_u32 s20, s20, 0
  s_and_b32 s21, s20, 3
  s_lshr_b32 s20, s20, 2
  s_lshl_b32 s20, s20, 10
  v_xor_b32 v42, s21, v40
  v_lshl_add_u32 v42, v42, 5, v41
  v_add_u32 v6, s20, v42
  s_mul_i32 s20, s16, 3
  s_add_u32 s20, s20, 1
  s_and_b32 s21, s20, 3
  s_lshr_b32 s20, s20, 2
  s_lshl_b32 s20, s20, 10
  v_xor_b32 v42, s21, v40
  v_lshl_add_u32 v42, v42, 5, v41
  v_add_u32 v7, s20, v42
  s_mul_i32 s20, s16, 3
  s_add_u32 s20, s20, 2
  s_and_b32 s21, s20, 3
  s_lshr_b32 s20, s20, 2
  s_lshl_b32 s20, s20, 10
  v_xor_b32 v42, s21, v40
  v_lshl_add_u32 v42, v42, 5, v41
  v_add_u32 v8, s20, v42
  v_lshrrev_b32 v40, 3, v1
  s_lshl_b32 s20, s16, 3
  v_add_u32 v40, s20, v40
  v_mul_u32_u24 v40, 1280, v40
  v_and_b32 v41, 7, v1
  s_lshl_b32 s20, s16, 1
  v_xor_b32 v41, s20, v41
  v_lshl_add_u32 v3, v41, 4, v40
  v_lshrrev_b32 v40, 4, v1
  v_and_b32 v41, 1, v40
  v_lshrrev_b32 v40, 1, v40
  v_lshl_or_b32 v40, v41, 1, v40
  v_mul_u32_u24 v41, 10240, v40
  v_bfe_u32 v42, v1, 2, 2
  v_lshl_add_u32 v41, v42, 7, v41
  v_and_b32 v42, 3, v1
  v_lshl_add_u32 v41, v42, 3, v41
  s_mul_i32 s20, s16, 10
  s_add_u32 s20, s20, 0
  s_and_b32 s21, s20, 3
  s_lshr_b32 s20, s20, 2
  s_lshl_b32 s20, s20, 10
  v_xor_b32 v42, s21, v40
  v_lshl_add_u32 v42, v42, 5, v41
  v_add_u32 v9, s20, v42
  s_mul_i32 s20, s16, 10
  s_add_u32 s20, s20, 1
  s_and_b32 s21, s20, 3
  s_lshr_b32 s20, s20, 2
  s_lshl_b32 s20, s20, 10
  v_xor_b32 v42, s21, v40
  v_lshl_add_u32 v42, v42, 5, v41
  v_add_u32 v10, s20, v42
  s_mul_i32 s20, s16, 10
  s_add_u32 s20, s20, 2
  s_and_b32 s21, s20, 3
  s_lshr_b32 s20, s20, 2
  s_lshl_b32 s20, s20, 10
  v_xor_b32 v42, s21, v40
  v_lshl_add_u32 v42, v42, 5, v41
  v_add_u32 v11, s20, v42
  s_mul_i32 s20, s16, 10
  s_add_u32 s20, s20, 3
  s_and_b32 s21, s20, 3
  s_lshr_b32 s20, s20, 2
  s_lshl_b32 s20, s20, 10
  v_xor_b32 v42, s21, v40
  v_lshl_add_u32 v42, v42, 5, v41
  v_add_u32 v12, s20, v42
  s_mul_i32 s20, s16, 10
  s_add_u32 s20, s20, 4
  s_and_b32 s21, s20, 3
  s_lshr_b32 s20, s20, 2
  s_lshl_b32 s20, s20, 10
  v_xor_b32 v42, s21, v40
  v_lshl_add_u32 v42, v42, 5, v41
  v_add_u32 v13, s20, v42
  s_mul_i32 s20, s16, 10
  s_add_u32 s20, s20, 5
  s_and_b32 s21, s20, 3
  s_lshr_b32 s20, s20, 2
  s_lshl_b32 s20, s20, 10
  v_xor_b32 v42, s21, v40
  v_lshl_add_u32 v42, v42, 5, v41
  v_add_u32 v14, s20, v42
  s_mul_i32 s20, s16, 10
  s_add_u32 s20, s20, 6
  s_and_b32 s21, s20, 3
  s_lshr_b32 s20, s20, 2
  s_lshl_b32 s20, s20, 10
  v_xor_b32 v42, s21, v40
  v_lshl_add_u32 v42, v42, 5, v41
  v_add_u32 v15, s20, v42
  s_mul_i32 s20, s16, 10
  s_add_u32 s20, s20, 7
  s_and_b32 s21, s20, 3
  s_lshr_b32 s20, s20, 2
  s_lshl_b32 s20, s20, 10
  v_xor_b32 v42, s21, v40
  v_lshl_add_u32 v42, v42, 5, v41
  v_add_u32 v16, s20, v42
  s_mul_i32 s20, s16, 10
  s_add_u32 s20, s20, 8
  s_and_b32 s21, s20, 3
  s_lshr_b32 s20, s20, 2
  s_lshl_b32 s20, s20, 10
  v_xor_b32 v42, s21, v40
  v_lshl_add_u32 v42, v42, 5, v41
  v_add_u32 v17, s20, v42
  s_mul_i32 s20, s16, 10
  s_add_u32 s20, s20, 9
  s_and_b32 s21, s20, 3
  s_lshr_b32 s20, s20, 2
  s_lshl_b32 s20, s20, 10
  v_xor_b32 v42, s21, v40
  v_lshl_add_u32 v42, v42, 5, v41
  v_add_u32 v18, s20, v42
  v_lshlrev_b32 v5, 4, v1
  s_mul_i32 s20, s16, 30720
  v_add_u32 v5, s20, v5
  s_mul_i32 s27, s16, 3072
  s_add_u32 m0, s27, 0
  s_add_u32 s26, s24, 0
  buffer_load_dwordx4 v2, s[8:11], s26 offen lds
  s_add_u32 m0, s27, 1024
  s_add_u32 s26, s24, 128
  buffer_load_dwordx4 v2, s[8:11], s26 offen lds
  s_add_u32 m0, s27, 2048
  s_add_u32 s26, s24, 256
  buffer_load_dwordx4 v2, s[8:11], s26 offen lds
  s_add_u32 m0, s27, 12288
  s_add_u32 s26, s24, 393216
  buffer_load_dwordx4 v2, s[8:11], s26 offen lds
  s_add_u32 m0, s27, 13312
  s_add_u32 s26, s24, 393344
  buffer_load_dwordx4 v2, s[8:11], s26 offen lds
  s_add_u32 m0, s27, 14336
  s_add_u32 s26, s24, 393472
  buffer_load_dwordx4 v2, s[8:11], s26 offen lds
  s_add_u32 m0, s27, 24576
  s_add_u32 s26, s24, 786432
  buffer_load_dwordx4 v2, s[8:11], s26 offen lds
  s_add_u32 m0, s27, 25600
  s_add_u32 s26, s24, 786560
  buffer_load_dwordx4 v2, s[8:11], s26 offen lds
  s_add_u32 m0, s27, 26624
  s_add_u32 s26, s24, 786688
  buffer_load_dwordx4 v2, s[8:11], s26 offen lds
  s_add_u32 m0, s27, 36864
  s_add_u32 s26, s24, 1179648
  buffer_load_dwordx4 v2, s[8:11], s26 offen lds
  s_add_u32 m0, s27, 37888
  s_add_u32 s26, s24, 1179776
  buffer_load_dwordx4 v2, s[8:11], s26 offen lds
  s_add_u32 m0, s27, 38912
  s_add_u32 s26, s24, 1179904
  buffer_load_dwordx4 v2, s[8:11], s26 offen lds
  s_mul_i32 s27, s16, 3072
  s_add_u32 m0, s27, 49152
  s_add_u32 s26, s24, 1572864
  buffer_load_dwordx4 v2, s[8:11], s26 offen lds
  s_add_u32 m0, s27, 50176
  s_add_u32 s26, s24, 1572992
  buffer_load_dwordx4 v2, s[8:11], s26 offen lds
  s_add_u32 m0, s27, 51200
  s_add_u32 s26, s24, 1573120
  buffer_load_dwordx4 v2, s[8:11], s26 offen lds
  s_add_u32 m0, s27, 61440
  s_add_u32 s26, s24, 1966080
  buffer_load_dwordx4 v2, s[8:11], s26 offen lds
  s_add_u32 m0, s27, 62464
  s_add_u32 s26, s24, 1966208
  buffer_load_dwordx4 v2, s[8:11], s26 offen lds
  s_add_u32 m0, s27, 63488
  s_add_u32 s26, s24, 1966336
  buffer_load_dwordx4 v2, s[8:11], s26 offen lds
  s_add_u32 m0, s27, 73728
  s_add_u32 s26, s24, 2359296
  buffer_load_dwordx4 v2, s[8:11], s26 offen lds
  s_add_u32 m0, s27, 74752
  s_add_u32 s26, s24, 2359424
  buffer_load_dwordx4 v2, s[8:11], s26 offen lds
  s_add_u32 m0, s27, 75776
  s_add_u32 s26, s24, 2359552
  buffer_load_dwordx4 v2, s[8:11], s26 offen lds
  s_add_u32 m0, s27, 86016
  s_add_u32 s26, s24, 2752512
  buffer_load_dwordx4 v2, s[8:11], s26 offen lds
  s_add_u32 m0, s27, 87040
  s_add_u32 s26, s24, 2752640
  buffer_load_dwordx4 v2, s[8:11], s26 offen lds
  s_add_u32 m0, s27, 88064
  s_add_u32 s26, s24, 2752768
  buffer_load_dwordx4 v2, s[8:11], s26 offen lds
  s_mul_i32 s27, s16, 3072
  s_add_u32 m0, s27, 98304
  s_add_u32 s26, s24, 3145728
  buffer_load_dwordx4 v2, s[8:11], s26 offen lds
  s_add_u32 m0, s27, 99328
  s_add_u32 s26, s24, 3145856
  buffer_load_dwordx4 v2, s[8:11], s26 offen lds
  s_add_u32 m0, s27, 100352
  s_add_u32 s26, s24, 3145984
  buffer_load_dwordx4 v2, s[8:11], s26 offen lds
  s_add_u32 m0, s27, 110592
  s_add_u32 s26, s24, 3538944
  buffer_load_dwordx4 v2, s[8:11], s26 offen lds
  s_add_u32 m0, s27, 111616
  s_add_u32 s26, s24, 3539072
  buffer_load_dwordx4 v2, s[8:11], s26 offen lds
  s_add_u32 m0, s27, 112640
  s_add_u32 s26, s24, 3539200
  buffer_load_dwordx4 v2, s[8:11], s26 offen lds
  s_add_u32 m0, s27, 122880
  s_add_u32 s26, s24, 3932160
  buffer_load_dwordx4 v2, s[8:11], s26 offen lds
  s_add_u32 m0, s27, 123904
  s_add_u32 s26, s24, 3932288
  buffer_load_dwordx4 v2, s[8:11], s26 offen lds
  s_add_u32 m0, s27, 124928
  s_add_u32 s26, s24, 3932416
  buffer_load_dwordx4 v2, s[8:11], s26 offen lds
  s_add_u32 m0, s27, 135168
  s_add_u32 s26, s24, 4325376
  buffer_load_dwordx4 v2, s[8:11], s26 offen lds
  s_add_u32 m0, s27, 136192
  s_add_u32 s26, s24, 4325504
  buffer_load_dwordx4 v2, s[8:11], s26 offen lds
  s_add_u32 m0, s27, 137216
  s_add_u32 s26, s24, 4325632
  buffer_load_dwordx4 v2, s[8:11], s26 offen lds
  s_waitcnt vmcnt(24)
  s_barrier
  v_add_u32 v19, 0, v6
  v_add_u32 v20, 0, v7
  v_add_u32 v21, 0, v8
  ds_read_b64_tr_b16 a[0:1], v19 offset:0
  ds_read_b64_tr_b16 a[2:3], v19 offset:512
  ds_read_b64_tr_b16 a[4:5], v19 offset:12288
  ds_read_b64_tr_b16 a[6:7], v19 offset:12800
  ds_read_b64_tr_b16 a[8:9], v19 offset:24576
  ds_read_b64_tr_b16 a[10:11], v19 offset:25088
  ds_read_b64_tr_b16 a[12:13], v19 offset:36864
  ds_read_b64_tr_b16 a[14:15], v19 offset:37376
  ds_read_b64_tr_b16 a[80:81], v20 offset:0
  ds_read_b64_tr_b16 a[82:83], v20 offset:512
  ds_read_b64_tr_b16 a[84:85], v20 offset:12288
  ds_read_b64_tr_b16 a[86:87], v20 offset:12800
  ds_read_b64_tr_b16 a[88:89], v20 offset:24576
  ds_read_b64_tr_b16 a[90:91], v20 offset:25088
  ds_read_b64_tr_b16 a[92:93], v20 offset:36864
  ds_read_b64_tr_b16 a[94:95], v20 offset:37376
  ds_read_b64_tr_b16 a[160:161], v21 offset:0
  ds_read_b64_tr_b16 a[162:163], v21 offset:512
  ds_read_b64_tr_b16 a[164:165], v21 offset:12288
  ds_read_b64_tr_b16 a[166:167], v21 offset:12800
  ds_read_b64_tr_b16 a[168:169], v21 offset:24576
  ds_read_b64_tr_b16 a[170:171], v21 offset:25088
  ds_read_b64_tr_b16 a[172:173], v21 offset:36864
  ds_read_b64_tr_b16 a[174:175], v21 offset:37376
  s_waitcnt lgkmcnt(0)
  s_waitcnt vmcnt(12)
  s_barrier
  s_mul_i32 s27, s16, 3072
  s_add_u32 m0, s27, 0
  s_add_u32 s26, s24, 4718592
  buffer_load_dwordx4 v2, s[8:11], s26 offen lds
  s_add_u32 m0, s27, 1024
  s_add_u32 s26, s24, 4718720
  buffer_load_dwordx4 v2, s[8:11], s26 offen lds
  s_add_u32 m0, s27, 2048
  s_add_u32 s26, s24, 4718848
  buffer_load_dwordx4 v2, s[8:11], s26 offen lds
  s_add_u32 m0, s27, 12288
  s_add_u32 s26, s24, 5111808
  buffer_load_dwordx4 v2, s[8:11], s26 offen lds
  s_add_u32 m0, s27, 13312
  s_add_u32 s26, s24, 5111936
  buffer_load_dwordx4 v2, s[8:11], s26 offen lds
  s_add_u32 m0, s27, 14336
  s_add_u32 s26, s24, 5112064
  buffer_load_dwordx4 v2, s[8:11], s26 offen lds
  s_add_u32 m0, s27, 24576
  s_add_u32 s26, s24, 5505024
  buffer_load_dwordx4 v2, s[8:11], s26 offen lds
  s_add_u32 m0, s27, 25600
  s_add_u32 s26, s24, 5505152
  buffer_load_dwordx4 v2, s[8:11], s26 offen lds
  s_add_u32 m0, s27, 26624
  s_add_u32 s26, s24, 5505280
  buffer_load_dwordx4 v2, s[8:11], s26 offen lds
  s_add_u32 m0, s27, 36864
  s_add_u32 s26, s24, 5898240
  buffer_load_dwordx4 v2, s[8:11], s26 offen lds
  s_add_u32 m0, s27, 37888
  s_add_u32 s26, s24, 5898368
  buffer_load_dwordx4 v2, s[8:11], s26 offen lds
  s_add_u32 m0, s27, 38912
  s_add_u32 s26, s24, 5898496
  buffer_load_dwordx4 v2, s[8:11], s26 offen lds
  v_add_u32 v19, 49152, v6
  v_add_u32 v20, 49152, v7
  v_add_u32 v21, 49152, v8
  ds_read_b64_tr_b16 a[16:17], v19 offset:0
  ds_read_b64_tr_b16 a[18:19], v19 offset:512
  ds_read_b64_tr_b16 a[20:21], v19 offset:12288
  ds_read_b64_tr_b16 a[22:23], v19 offset:12800
  ds_read_b64_tr_b16 a[24:25], v19 offset:24576
  ds_read_b64_tr_b16 a[26:27], v19 offset:25088
  ds_read_b64_tr_b16 a[28:29], v19 offset:36864
  ds_read_b64_tr_b16 a[30:31], v19 offset:37376
  ds_read_b64_tr_b16 a[96:97], v20 offset:0
  ds_read_b64_tr_b16 a[98:99], v20 offset:512
  ds_read_b64_tr_b16 a[100:101], v20 offset:12288
  ds_read_b64_tr_b16 a[102:103], v20 offset:12800
  ds_read_b64_tr_b16 a[104:105], v20 offset:24576
  ds_read_b64_tr_b16 a[106:107], v20 offset:25088
  ds_read_b64_tr_b16 a[108:109], v20 offset:36864
  ds_read_b64_tr_b16 a[110:111], v20 offset:37376
  ds_read_b64_tr_b16 a[176:177], v21 offset:0
  ds_read_b64_tr_b16 a[178:179], v21 offset:512
  ds_read_b64_tr_b16 a[180:181], v21 offset:12288
  ds_read_b64_tr_b16 a[182:183], v21 offset:12800
  ds_read_b64_tr_b16 a[184:185], v21 offset:24576
  ds_read_b64_tr_b16 a[186:187], v21 offset:25088
  ds_read_b64_tr_b16 a[188:189], v21 offset:36864
  ds_read_b64_tr_b16 a[190:191], v21 offset:37376
  s_waitcnt lgkmcnt(0)
  s_waitcnt vmcnt(12)
  s_barrier
  s_mul_i32 s27, s16, 3072
  s_add_u32 m0, s27, 49152
  s_add_u32 s26, s24, 6291456
  buffer_load_dwordx4 v2, s[8:11], s26 offen lds
  s_add_u32 m0, s27, 50176
  s_add_u32 s26, s24, 6291584
  buffer_load_dwordx4 v2, s[8:11], s26 offen lds
  s_add_u32 m0, s27, 51200
  s_add_u32 s26, s24, 6291712
  buffer_load_dwordx4 v2, s[8:11], s26 offen lds
  s_add_u32 m0, s27, 61440
  s_add_u32 s26, s24, 6684672
  buffer_load_dwordx4 v2, s[8:11], s26 offen lds
  s_add_u32 m0, s27, 62464
  s_add_u32 s26, s24, 6684800
  buffer_load_dwordx4 v2, s[8:11], s26 offen lds
  s_add_u32 m0, s27, 63488
  s_add_u32 s26, s24, 6684928
  buffer_load_dwordx4 v2, s[8:11], s26 offen lds
  s_add_u32 m0, s27, 73728
  s_add_u32 s26, s24, 7077888
  buffer_load_dwordx4 v2, s[8:11], s26 offen lds
  s_add_u32 m0, s27, 74752
  s_add_u32 s26, s24, 7078016
  buffer_load_dwordx4 v2, s[8:11], s26 offen lds
  s_add_u32 m0, s27, 75776
  s_add_u32 s26, s24, 7078144
  buffer_load_dwordx4 v2, s[8:11], s26 offen lds
  s_add_u32 m0, s27, 86016
  s_add_u32 s26, s24, 7471104
  buffer_load_dwordx4 v2, s[8:11], s26 offen lds
  s_add_u32 m0, s27, 87040
  s_add_u32 s26, s24, 7471232
  buffer_load_dwordx4 v2, s[8:11], s26 offen lds
  s_add_u32 m0, s27, 88064
  s_add_u32 s26, s24, 7471360
  buffer_load_dwordx4 v2, s[8:11], s26 offen lds
  v_add_u32 v19, 98304, v6
  v_add_u32 v20, 98304, v7
  v_add_u32 v21, 98304, v8
  ds_read_b64_tr_b16 a[32:33], v19 offset:0
  ds_read_b64_tr_b16 a[34:35], v19 offset:512
  ds_read_b64_tr_b16 a[36:37], v19 offset:12288
  ds_read_b64_tr_b16 a[38:39], v19 offset:12800
  ds_read_b64_tr_b16 a[40:41], v19 offset:24576
  ds_read_b64_tr_b16 a[42:43], v19 offset:25088
  ds_read_b64_tr_b16 a[44:45], v19 offset:36864
  ds_read_b64_tr_b16 a[46:47], v19 offset:37376
  ds_read_b64_tr_b16 a[112:113], v20 offset:0
  ds_read_b64_tr_b16 a[114:115], v20 offset:512
  ds_read_b64_tr_b16 a[116:117], v20 offset:12288
  ds_read_b64_tr_b16 a[118:119], v20 offset:12800
  ds_read_b64_tr_b16 a[120:121], v20 offset:24576
  ds_read_b64_tr_b16 a[122:123], v20 offset:25088
  ds_read_b64_tr_b16 a[124:125], v20 offset:36864
  ds_read_b64_tr_b16 a[126:127], v20 offset:37376
  ds_read_b64_tr_b16 a[192:193], v21 offset:0
  ds_read_b64_tr_b16 a[194:195], v21 offset:512
  ds_read_b64_tr_b16 a[196:197], v21 offset:12288
  ds_read_b64_tr_b16 a[198:199], v21 offset:12800
  ds_read_b64_tr_b16 a[200:201], v21 offset:24576
  ds_read_b64_tr_b16 a[202:203], v21 offset:25088
  ds_read_b64_tr_b16 a[204:205], v21 offset:36864
  ds_read_b64_tr_b16 a[206:207], v21 offset:37376
  s_waitcnt lgkmcnt(0)
  s_waitcnt vmcnt(12)
  s_barrier
  s_mul_i32 s27, s16, 10240
  s_add_u32 m0, s27, 98304
  s_add_u32 s26, s25, 0
  buffer_load_dwordx4 v3, s[12:15], s26 offen lds
  s_add_u32 m0, s27, 99328
  s_add_u32 s26, s25, 128
  buffer_load_dwordx4 v3, s[12:15], s26 offen lds
  s_add_u32 m0, s27, 100352
  s_add_u32 s26, s25, 256
  buffer_load_dwordx4 v3, s[12:15], s26 offen lds
  s_add_u32 m0, s27, 101376
  s_add_u32 s26, s25, 384
  buffer_load_dwordx4 v3, s[12:15], s26 offen lds
  s_add_u32 m0, s27, 102400
  s_add_u32 s26, s25, 512
  buffer_load_dwordx4 v3, s[12:15], s26 offen lds
  s_add_u32 m0, s27, 103424
  s_add_u32 s26, s25, 640
  buffer_load_dwordx4 v3, s[12:15], s26 offen lds
  s_add_u32 m0, s27, 104448
  s_add_u32 s26, s25, 768
  buffer_load_dwordx4 v3, s[12:15], s26 offen lds
  s_add_u32 m0, s27, 105472
  s_add_u32 s26, s25, 896
  buffer_load_dwordx4 v3, s[12:15], s26 offen lds
  s_add_u32 m0, s27, 106496
  s_add_u32 s26, s25, 1024
  buffer_load_dwordx4 v3, s[12:15], s26 offen lds
  s_add_u32 m0, s27, 107520
  s_add_u32 s26, s25, 1152
  buffer_load_dwordx4 v3, s[12:15], s26 offen lds
  v_add_u32 v19, 0, v6
  v_add_u32 v20, 0, v7
  v_add_u32 v21, 0, v8
  ds_read_b64_tr_b16 a[48:49], v19 offset:0
  ds_read_b64_tr_b16 a[50:51], v19 offset:512
  ds_read_b64_tr_b16 a[52:53], v19 offset:12288
  ds_read_b64_tr_b16 a[54:55], v19 offset:12800
  ds_read_b64_tr_b16 a[56:57], v19 offset:24576
  ds_read_b64_tr_b16 a[58:59], v19 offset:25088
  ds_read_b64_tr_b16 a[60:61], v19 offset:36864
  ds_read_b64_tr_b16 a[62:63], v19 offset:37376
  ds_read_b64_tr_b16 a[128:129], v20 offset:0
  ds_read_b64_tr_b16 a[130:131], v20 offset:512
  ds_read_b64_tr_b16 a[132:133], v20 offset:12288
  ds_read_b64_tr_b16 a[134:135], v20 offset:12800
  ds_read_b64_tr_b16 a[136:137], v20 offset:24576
  ds_read_b64_tr_b16 a[138:139], v20 offset:25088
  ds_read_b64_tr_b16 a[140:141], v20 offset:36864
  ds_read_b64_tr_b16 a[142:143], v20 offset:37376
  ds_read_b64_tr_b16 a[208:209], v21 offset:0
  ds_read_b64_tr_b16 a[210:211], v21 offset:512
  ds_read_b64_tr_b16 a[212:213], v21 offset:12288
  ds_read_b64_tr_b16 a[214:215], v21 offset:12800
  ds_read_b64_tr_b16 a[216:217], v21 offset:24576
  ds_read_b64_tr_b16 a[218:219], v21 offset:25088
  ds_read_b64_tr_b16 a[220:221], v21 offset:36864
  ds_read_b64_tr_b16 a[222:223], v21 offset:37376
  s_waitcnt lgkmcnt(0)
  s_waitcnt vmcnt(10)
  s_barrier
  s_mul_i32 s27, s16, 10240
  s_add_u32 m0, s27, 0
  s_add_u32 s26, s25, 40960
  buffer_load_dwordx4 v3, s[12:15], s26 offen lds
  s_add_u32 m0, s27, 1024
  s_add_u32 s26, s25, 41088
  buffer_load_dwordx4 v3, s[12:15], s26 offen lds
  s_add_u32 m0, s27, 2048
  s_add_u32 s26, s25, 41216
  buffer_load_dwordx4 v3, s[12:15], s26 offen lds
  s_add_u32 m0, s27, 3072
  s_add_u32 s26, s25, 41344
  buffer_load_dwordx4 v3, s[12:15], s26 offen lds
  s_add_u32 m0, s27, 4096
  s_add_u32 s26, s25, 41472
  buffer_load_dwordx4 v3, s[12:15], s26 offen lds
  s_add_u32 m0, s27, 5120
  s_add_u32 s26, s25, 41600
  buffer_load_dwordx4 v3, s[12:15], s26 offen lds
  s_add_u32 m0, s27, 6144
  s_add_u32 s26, s25, 41728
  buffer_load_dwordx4 v3, s[12:15], s26 offen lds
  s_add_u32 m0, s27, 7168
  s_add_u32 s26, s25, 41856
  buffer_load_dwordx4 v3, s[12:15], s26 offen lds
  s_add_u32 m0, s27, 8192
  s_add_u32 s26, s25, 41984
  buffer_load_dwordx4 v3, s[12:15], s26 offen lds
  s_add_u32 m0, s27, 9216
  s_add_u32 s26, s25, 42112
  buffer_load_dwordx4 v3, s[12:15], s26 offen lds
  v_add_u32 v19, 49152, v6
  v_add_u32 v20, 49152, v7
  v_add_u32 v21, 49152, v8
  ds_read_b64_tr_b16 a[64:65], v19 offset:0
  ds_read_b64_tr_b16 a[66:67], v19 offset:512
  ds_read_b64_tr_b16 a[68:69], v19 offset:12288
  ds_read_b64_tr_b16 a[70:71], v19 offset:12800
  ds_read_b64_tr_b16 a[72:73], v19 offset:24576
  ds_read_b64_tr_b16 a[74:75], v19 offset:25088
  ds_read_b64_tr_b16 a[76:77], v19 offset:36864
  ds_read_b64_tr_b16 a[78:79], v19 offset:37376
  ds_read_b64_tr_b16 a[144:145], v20 offset:0
  ds_read_b64_tr_b16 a[146:147], v20 offset:512
  ds_read_b64_tr_b16 a[148:149], v20 offset:12288
  ds_read_b64_tr_b16 a[150:151], v20 offset:12800
  ds_read_b64_tr_b16 a[152:153], v20 offset:24576
  ds_read_b64_tr_b16 a[154:155], v20 offset:25088
  ds_read_b64_tr_b16 a[156:157], v20 offset:36864
  ds_read_b64_tr_b16 a[158:159], v20 offset:37376
  ds_read_b64_tr_b16 a[224:225], v21 offset:0
  ds_read_b64_tr_b16 a[226:227], v21 offset:512
  ds_read_b64_tr_b16 a[228:229], v21 offset:12288
  ds_read_b64_tr_b16 a[230:231], v21 offset:12800
  ds_read_b64_tr_b16 a[232:233], v21 offset:24576
  ds_read_b64_tr_b16 a[234:235], v21 offset:25088
  ds_read_b64_tr_b16 a[236:237], v21 offset:36864
  ds_read_b64_tr_b16 a[238:239], v21 offset:37376
  s_waitcnt lgkmcnt(0)
  s_waitcnt vmcnt(10)
  s_barrier
  s_mul_i32 s27, s16, 10240
  s_add_u32 m0, s27, 49152
  s_add_u32 s26, s25, 81920
  buffer_load_dwordx4 v3, s[12:15], s26 offen lds
  s_add_u32 m0, s27, 50176
  s_add_u32 s26, s25, 82048
  buffer_load_dwordx4 v3, s[12:15], s26 offen lds
  s_add_u32 m0, s27, 51200
  s_add_u32 s26, s25, 82176
  buffer_load_dwordx4 v3, s[12:15], s26 offen lds
  s_add_u32 m0, s27, 52224
  s_add_u32 s26, s25, 82304
  buffer_load_dwordx4 v3, s[12:15], s26 offen lds
  s_add_u32 m0, s27, 53248
  s_add_u32 s26, s25, 82432
  buffer_load_dwordx4 v3, s[12:15], s26 offen lds
  s_add_u32 m0, s27, 54272
  s_add_u32 s26, s25, 82560
  buffer_load_dwordx4 v3, s[12:15], s26 offen lds
  s_add_u32 m0, s27, 55296
  s_add_u32 s26, s25, 82688
  buffer_load_dwordx4 v3, s[12:15], s26 offen lds
  s_add_u32 m0, s27, 56320
  s_add_u32 s26, s25, 82816
  buffer_load_dwordx4 v3, s[12:15], s26 offen lds
  s_add_u32 m0, s27, 57344
  s_add_u32 s26, s25, 82944
  buffer_load_dwordx4 v3, s[12:15], s26 offen lds
  s_add_u32 m0, s27, 58368
  s_add_u32 s26, s25, 83072
  buffer_load_dwordx4 v3, s[12:15], s26 offen lds
  v_add_u32 v19, 98304, v9
  v_add_u32 v20, 98304, v10
  v_add_u32 v21, 98304, v11
  v_add_u32 v22, 98304, v12
  v_add_u32 v23, 98304, v13
  v_add_u32 v24, 98304, v14
  v_add_u32 v25, 98304, v15
  v_add_u32 v26, 98304, v16
  v_add_u32 v27, 98304, v17
  v_add_u32 v28, 98304, v18
  ds_read_b64_tr_b16 v[32:33], v19 offset:0
  ds_read_b64_tr_b16 v[34:35], v19 offset:512
  ds_read_b64_tr_b16 v[36:37], v20 offset:0
  ds_read_b64_tr_b16 v[38:39], v20 offset:512
  ds_read_b64_tr_b16 v[40:41], v21 offset:0
  ds_read_b64_tr_b16 v[42:43], v21 offset:512
  ds_read_b64_tr_b16 v[44:45], v22 offset:0
  ds_read_b64_tr_b16 v[46:47], v22 offset:512
  ds_read_b64_tr_b16 v[48:49], v23 offset:0
  ds_read_b64_tr_b16 v[50:51], v23 offset:512
  ds_read_b64_tr_b16 a[240:241], v24 offset:0
  ds_read_b64_tr_b16 a[242:243], v24 offset:512
  ds_read_b64_tr_b16 v[160:161], v25 offset:0
  ds_read_b64_tr_b16 v[162:163], v25 offset:512
  ds_read_b64_tr_b16 v[184:185], v26 offset:0
  ds_read_b64_tr_b16 v[186:187], v26 offset:512
  ds_read_b64_tr_b16 v[208:209], v27 offset:0
  ds_read_b64_tr_b16 v[210:211], v27 offset:512
  ds_read_b64_tr_b16 v[232:233], v28 offset:0
  ds_read_b64_tr_b16 v[234:235], v28 offset:512
  s_waitcnt lgkmcnt(0)
  s_waitcnt vmcnt(10)
  s_barrier
  s_mul_i32 s27, s16, 10240
  s_add_u32 m0, s27, 98304
  s_add_u32 s26, s25, 122880
  buffer_load_dwordx4 v3, s[12:15], s26 offen lds
  s_add_u32 m0, s27, 99328
  s_add_u32 s26, s25, 123008
  buffer_load_dwordx4 v3, s[12:15], s26 offen lds
  s_add_u32 m0, s27, 100352
  s_add_u32 s26, s25, 123136
  buffer_load_dwordx4 v3, s[12:15], s26 offen lds
  s_add_u32 m0, s27, 101376
  s_add_u32 s26, s25, 123264
  buffer_load_dwordx4 v3, s[12:15], s26 offen lds
  s_add_u32 m0, s27, 102400
  s_add_u32 s26, s25, 123392
  buffer_load_dwordx4 v3, s[12:15], s26 offen lds
  s_add_u32 m0, s27, 103424
  s_add_u32 s26, s25, 123520
  buffer_load_dwordx4 v3, s[12:15], s26 offen lds
  s_add_u32 m0, s27, 104448
  s_add_u32 s26, s25, 123648
  buffer_load_dwordx4 v3, s[12:15], s26 offen lds
  s_add_u32 m0, s27, 105472
  s_add_u32 s26, s25, 123776
  buffer_load_dwordx4 v3, s[12:15], s26 offen lds
  s_add_u32 m0, s27, 106496
  s_add_u32 s26, s25, 123904
  buffer_load_dwordx4 v3, s[12:15], s26 offen lds
  s_add_u32 m0, s27, 107520
  s_add_u32 s26, s25, 124032
  buffer_load_dwordx4 v3, s[12:15], s26 offen lds
  v_add_u32 v19, 0, v9
  v_add_u32 v20, 0, v10
  v_add_u32 v21, 0, v11
  v_add_u32 v22, 0, v12
  v_add_u32 v23, 0, v13
  v_add_u32 v24, 0, v14
  v_add_u32 v25, 0, v15
  v_add_u32 v26, 0, v16
  v_add_u32 v27, 0, v17
  v_add_u32 v28, 0, v18
  ds_read_b64_tr_b16 v[52:53], v19 offset:0
  ds_read_b64_tr_b16 v[54:55], v19 offset:512
  ds_read_b64_tr_b16 v[56:57], v20 offset:0
  ds_read_b64_tr_b16 v[58:59], v20 offset:512
  ds_read_b64_tr_b16 v[60:61], v21 offset:0
  ds_read_b64_tr_b16 v[62:63], v21 offset:512
  ds_read_b64_tr_b16 v[64:65], v22 offset:0
  ds_read_b64_tr_b16 v[66:67], v22 offset:512
  ds_read_b64_tr_b16 v[68:69], v23 offset:0
  ds_read_b64_tr_b16 v[70:71], v23 offset:512
  ds_read_b64_tr_b16 a[244:245], v24 offset:0
  ds_read_b64_tr_b16 a[246:247], v24 offset:512
  ds_read_b64_tr_b16 v[164:165], v25 offset:0
  ds_read_b64_tr_b16 v[166:167], v25 offset:512
  ds_read_b64_tr_b16 v[188:189], v26 offset:0
  ds_read_b64_tr_b16 v[190:191], v26 offset:512
  ds_read_b64_tr_b16 v[212:213], v27 offset:0
  ds_read_b64_tr_b16 v[214:215], v27 offset:512
  ds_read_b64_tr_b16 v[236:237], v28 offset:0
  ds_read_b64_tr_b16 v[238:239], v28 offset:512
  s_waitcnt lgkmcnt(0)
  s_waitcnt vmcnt(10)
  s_barrier
  s_mul_i32 s27, s16, 10240
  s_add_u32 m0, s27, 0
  s_add_u32 s26, s25, 163840
  buffer_load_dwordx4 v3, s[12:15], s26 offen lds
  s_add_u32 m0, s27, 1024
  s_add_u32 s26, s25, 163968
  buffer_load_dwordx4 v3, s[12:15], s26 offen lds
  s_add_u32 m0, s27, 2048
  s_add_u32 s26, s25, 164096
  buffer_load_dwordx4 v3, s[12:15], s26 offen lds
  s_add_u32 m0, s27, 3072
  s_add_u32 s26, s25, 164224
  buffer_load_dwordx4 v3, s[12:15], s26 offen lds
  s_add_u32 m0, s27, 4096
  s_add_u32 s26, s25, 164352
  buffer_load_dwordx4 v3, s[12:15], s26 offen lds
  s_add_u32 m0, s27, 5120
  s_add_u32 s26, s25, 164480
  buffer_load_dwordx4 v3, s[12:15], s26 offen lds
  s_add_u32 m0, s27, 6144
  s_add_u32 s26, s25, 164608
  buffer_load_dwordx4 v3, s[12:15], s26 offen lds
  s_add_u32 m0, s27, 7168
  s_add_u32 s26, s25, 164736
  buffer_load_dwordx4 v3, s[12:15], s26 offen lds
  s_add_u32 m0, s27, 8192
  s_add_u32 s26, s25, 164864
  buffer_load_dwordx4 v3, s[12:15], s26 offen lds
  s_add_u32 m0, s27, 9216
  s_add_u32 s26, s25, 164992
  buffer_load_dwordx4 v3, s[12:15], s26 offen lds
  v_add_u32 v19, 49152, v9
  v_add_u32 v20, 49152, v10
  v_add_u32 v21, 49152, v11
  v_add_u32 v22, 49152, v12
  v_add_u32 v23, 49152, v13
  v_add_u32 v24, 49152, v14
  v_add_u32 v25, 49152, v15
  v_add_u32 v26, 49152, v16
  v_add_u32 v27, 49152, v17
  v_add_u32 v28, 49152, v18
  ds_read_b64_tr_b16 v[72:73], v19 offset:0
  ds_read_b64_tr_b16 v[74:75], v19 offset:512
  ds_read_b64_tr_b16 v[76:77], v20 offset:0
  ds_read_b64_tr_b16 v[78:79], v20 offset:512
  ds_read_b64_tr_b16 v[80:81], v21 offset:0
  ds_read_b64_tr_b16 v[82:83], v21 offset:512
  ds_read_b64_tr_b16 v[84:85], v22 offset:0
  ds_read_b64_tr_b16 v[86:87], v22 offset:512
  ds_read_b64_tr_b16 v[88:89], v23 offset:0
  ds_read_b64_tr_b16 v[90:91], v23 offset:512
  ds_read_b64_tr_b16 a[248:249], v24 offset:0
  ds_read_b64_tr_b16 a[250:251], v24 offset:512
  ds_read_b64_tr_b16 v[168:169], v25 offset:0
  ds_read_b64_tr_b16 v[170:171], v25 offset:512
  ds_read_b64_tr_b16 v[192:193], v26 offset:0
  ds_read_b64_tr_b16 v[194:195], v26 offset:512
  ds_read_b64_tr_b16 v[216:217], v27 offset:0
  ds_read_b64_tr_b16 v[218:219], v27 offset:512
  ds_read_b64_tr_b16 v[240:241], v28 offset:0
  ds_read_b64_tr_b16 v[242:243], v28 offset:512
  s_waitcnt lgkmcnt(0)
  s_waitcnt vmcnt(10)
  s_barrier
  s_mul_i32 s27, s16, 10240
  s_add_u32 m0, s27, 49152
  s_add_u32 s26, s25, 204800
  buffer_load_dwordx4 v3, s[12:15], s26 offen lds
  s_add_u32 m0, s27, 50176
  s_add_u32 s26, s25, 204928
  buffer_load_dwordx4 v3, s[12:15], s26 offen lds
  s_add_u32 m0, s27, 51200
  s_add_u32 s26, s25, 205056
  buffer_load_dwordx4 v3, s[12:15], s26 offen lds
  s_add_u32 m0, s27, 52224
  s_add_u32 s26, s25, 205184
  buffer_load_dwordx4 v3, s[12:15], s26 offen lds
  s_add_u32 m0, s27, 53248
  s_add_u32 s26, s25, 205312
  buffer_load_dwordx4 v3, s[12:15], s26 offen lds
  s_add_u32 m0, s27, 54272
  s_add_u32 s26, s25, 205440
  buffer_load_dwordx4 v3, s[12:15], s26 offen lds
  s_add_u32 m0, s27, 55296
  s_add_u32 s26, s25, 205568
  buffer_load_dwordx4 v3, s[12:15], s26 offen lds
  s_add_u32 m0, s27, 56320
  s_add_u32 s26, s25, 205696
  buffer_load_dwordx4 v3, s[12:15], s26 offen lds
  s_add_u32 m0, s27, 57344
  s_add_u32 s26, s25, 205824
  buffer_load_dwordx4 v3, s[12:15], s26 offen lds
  s_add_u32 m0, s27, 58368
  s_add_u32 s26, s25, 205952
  buffer_load_dwordx4 v3, s[12:15], s26 offen lds
  s_cmp_eq_u32 s16, 0
  s_cbranch_scc0 DI_52
  buffer_load_dwordx2 v[30:31], off, s[48:51], 0 offset:8 sc1
DI_52:
  v_add_u32 v19, 98304, v9
  v_add_u32 v20, 98304, v10
  v_add_u32 v21, 98304, v11
  v_add_u32 v22, 98304, v12
  v_add_u32 v23, 98304, v13
  v_add_u32 v24, 98304, v14
  v_add_u32 v25, 98304, v15
  v_add_u32 v26, 98304, v16
  v_add_u32 v27, 98304, v17
  v_add_u32 v28, 98304, v18
  ds_read_b64_tr_b16 v[92:93], v19 offset:0
  ds_read_b64_tr_b16 v[94:95], v19 offset:512
  ds_read_b64_tr_b16 v[96:97], v20 offset:0
  ds_read_b64_tr_b16 v[98:99], v20 offset:512
  ds_read_b64_tr_b16 v[100:101], v21 offset:0
  ds_read_b64_tr_b16 v[102:103], v21 offset:512
  ds_read_b64_tr_b16 v[104:105], v22 offset:0
  ds_read_b64_tr_b16 v[106:107], v22 offset:512
  ds_read_b64_tr_b16 v[108:109], v23 offset:0
  ds_read_b64_tr_b16 v[110:111], v23 offset:512
  ds_read_b64_tr_b16 a[252:253], v24 offset:0
  ds_read_b64_tr_b16 a[254:255], v24 offset:512
  ds_read_b64_tr_b16 v[172:173], v25 offset:0
  ds_read_b64_tr_b16 v[174:175], v25 offset:512
  ds_read_b64_tr_b16 v[196:197], v26 offset:0
  ds_read_b64_tr_b16 v[198:199], v26 offset:512
  ds_read_b64_tr_b16 v[220:221], v27 offset:0
  ds_read_b64_tr_b16 v[222:223], v27 offset:512
  ds_read_b64_tr_b16 v[244:245], v28 offset:0
  ds_read_b64_tr_b16 v[246:247], v28 offset:512
  s_waitcnt lgkmcnt(0)
  s_waitcnt vmcnt(10)
  s_barrier
  v_add_u32 v19, 0, v9
  v_add_u32 v20, 0, v10
  v_add_u32 v21, 0, v11
  v_add_u32 v22, 0, v12
  v_add_u32 v23, 0, v13
  v_add_u32 v24, 0, v14
  v_add_u32 v25, 0, v15
  v_add_u32 v26, 0, v16
  v_add_u32 v27, 0, v17
  v_add_u32 v28, 0, v18
  ds_read_b64_tr_b16 v[112:113], v19 offset:0
  ds_read_b64_tr_b16 v[114:115], v19 offset:512
  ds_read_b64_tr_b16 v[116:117], v20 offset:0
  ds_read_b64_tr_b16 v[118:119], v20 offset:512
  ds_read_b64_tr_b16 v[120:121], v21 offset:0
  ds_read_b64_tr_b16 v[122:123], v21 offset:512
  ds_read_b64_tr_b16 v[124:125], v22 offset:0
  ds_read_b64_tr_b16 v[126:127], v22 offset:512
  ds_read_b64_tr_b16 v[128:129], v23 offset:0
  ds_read_b64_tr_b16 v[130:131], v23 offset:512
  ds_read_b64_tr_b16 v[152:153], v24 offset:0
  ds_read_b64_tr_b16 v[154:155], v24 offset:512
  ds_read_b64_tr_b16 v[176:177], v25 offset:0
  ds_read_b64_tr_b16 v[178:179], v25 offset:512
  ds_read_b64_tr_b16 v[200:201], v26 offset:0
  ds_read_b64_tr_b16 v[202:203], v26 offset:512
  ds_read_b64_tr_b16 v[224:225], v27 offset:0
  ds_read_b64_tr_b16 v[226:227], v27 offset:512
  ds_read_b64_tr_b16 v[248:249], v28 offset:0
  ds_read_b64_tr_b16 v[250:251], v28 offset:512
  s_waitcnt lgkmcnt(0)
  s_waitcnt vmcnt(0)
  s_barrier
  v_add_u32 v19, 49152, v9
  v_add_u32 v20, 49152, v10
  v_add_u32 v21, 49152, v11
  v_add_u32 v22, 49152, v12
  v_add_u32 v23, 49152, v13
  v_add_u32 v24, 49152, v14
  v_add_u32 v25, 49152, v15
  v_add_u32 v26, 49152, v16
  v_add_u32 v27, 49152, v17
  v_add_u32 v28, 49152, v18
  ds_read_b64_tr_b16 v[132:133], v19 offset:0
  ds_read_b64_tr_b16 v[134:135], v19 offset:512
  ds_read_b64_tr_b16 v[136:137], v20 offset:0
  ds_read_b64_tr_b16 v[138:139], v20 offset:512
  ds_read_b64_tr_b16 v[140:141], v21 offset:0
  ds_read_b64_tr_b16 v[142:143], v21 offset:512
  ds_read_b64_tr_b16 v[144:145], v22 offset:0
  ds_read_b64_tr_b16 v[146:147], v22 offset:512
  ds_read_b64_tr_b16 v[148:149], v23 offset:0
  ds_read_b64_tr_b16 v[150:151], v23 offset:512
  ds_read_b64_tr_b16 v[156:157], v24 offset:0
  ds_read_b64_tr_b16 v[158:159], v24 offset:512
  ds_read_b64_tr_b16 v[180:181], v25 offset:0
  ds_read_b64_tr_b16 v[182:183], v25 offset:512
  ds_read_b64_tr_b16 v[204:205], v26 offset:0
  ds_read_b64_tr_b16 v[206:207], v26 offset:512
  ds_read_b64_tr_b16 v[228:229], v27 offset:0
  ds_read_b64_tr_b16 v[230:231], v27 offset:512
  ds_read_b64_tr_b16 v[252:253], v28 offset:0
  ds_read_b64_tr_b16 v[254:255], v28 offset:512
  s_waitcnt lgkmcnt(0)
  s_cmp_eq_u32 s16, 0
  s_cbranch_scc0 DC_55
  s_mov_b32 s22, 0
DC_53:
  s_waitcnt vmcnt(0)
  v_readfirstlane_b32 s20, v30
  v_readfirstlane_b32 s21, v31
  s_cmp_lg_u32 s21, 0
  s_cbranch_scc1 DC_54
DC_56:
  s_add_u32 s22, s22, 1
  s_cmp_gt_u32 s22, 200000
  s_cbranch_scc1 DC_54
  s_sleep 16
  buffer_load_dwordx2 v[30:31], off, s[48:51], 0 offset:8 sc1
  s_branch DC_53
DC_54:
  s_and_b32 s21, s21, 8192
  v_mov_b32 v30, s21
  v_mov_b32 v31, 163824
  ds_write_b32 v31, v30
  s_waitcnt lgkmcnt(0)
DC_55:
  s_barrier
  v_mov_b32 v31, 163824
  ds_read_b32 v30, v31
  s_waitcnt lgkmcnt(0)
  v_readfirstlane_b32 s52, v30
  ds_write_b128 v5, v[32:35] offset:0
  ds_write_b128 v5, v[36:39] offset:6144
  ds_write_b128 v5, v[40:43] offset:12288
  ds_write_b128 v5, v[44:47] offset:18432
  ds_write_b128 v5, v[48:51] offset:24576
  ds_write_b128 v5, v[52:55] offset:1024
  ds_write_b128 v5, v[56:59] offset:7168
  ds_write_b128 v5, v[60:63] offset:13312
  ds_write_b128 v5, v[64:67] offset:19456
  ds_write_b128 v5, v[68:71] offset:25600
  ds_write_b128 v5, v[72:75] offset:2048
  ds_write_b128 v5, v[76:79] offset:8192
  ds_write_b128 v5, v[80:83] offset:14336
  ds_write_b128 v5, v[84:87] offset:20480
  ds_write_b128 v5, v[88:91] offset:26624
  ds_write_b128 v5, v[92:95] offset:3072
  ds_write_b128 v5, v[96:99] offset:9216
  ds_write_b128 v5, v[100:103] offset:15360
  ds_write_b128 v5, v[104:107] offset:21504
  ds_write_b128 v5, v[108:111] offset:27648
  ds_write_b128 v5, v[112:115] offset:4096
  ds_write_b128 v5, v[116:119] offset:10240
  ds_write_b128 v5, v[120:123] offset:16384
  ds_write_b128 v5, v[124:127] offset:22528
  ds_write_b128 v5, v[128:131] offset:28672
  ds_write_b128 v5, v[132:135] offset:5120
  ds_write_b128 v5, v[136:139] offset:11264
  ds_write_b128 v5, v[140:143] offset:17408
  ds_write_b128 v5, v[144:147] offset:23552
  ds_write_b128 v5, v[148:151] offset:29696
  s_waitcnt lgkmcnt(0)
  v_lshrrev_b32 v40, 4, v1
  v_bfe_u32 v41, v1, 2, 2
  v_and_b32 v42, 3, v1
  v_lshrrev_b32 v43, 1, v40
  v_lshlrev_b32 v4, 9, v43
  v_and_b32 v43, 1, v40
  v_lshl_add_u32 v4, v43, 7, v4
  v_lshrrev_b32 v43, 1, v41
  v_lshl_add_u32 v4, v43, 6, v4
  v_lshrrev_b32 v43, 1, v42
  v_lshl_add_u32 v4, v43, 5, v4
  v_and_b32 v43, 1, v41
  v_lshl_add_u32 v4, v43, 4, v4
  v_and_b32 v43, 1, v42
  v_lshl_add_u32 v4, v43, 3, v4
  v_add_u32 v4, 122880, v4
  v_add_u32 v8, 10240, v4
  v_and_b32 v43, 8, v1
  v_cmp_eq_u32 vcc, 0, v43
  v_mov_b32 v6, 0xeeee
  v_mov_b32 v43, 0x4444
  v_cndmask_b32 v6, v6, v43, vcc
  v_lshlrev_b32 v2, 4, v1
  s_mul_i32 s20, s16, 5120
  s_add_u32 s20, s20, 122880
  v_add_u32 v3, s20, v2
  s_lshl_b32 s20, s16, 14
  s_add_u32 s20, s20, s52
  v_add_u32 v2, s20, v2
  v_and_b32 v43, 15, v1
  v_lshlrev_b32 v7, 4, v43
  v_and_b32 v44, 1, v40
  v_lshl_add_u32 v7, v44, 3, v7
  v_mov_b32 v9, v7
  v_lshrrev_b32 v44, 1, v40
  v_lshl_add_u32 v7, v44, 2, v7
  s_mul_i32 s20, s16, 768
  s_add_u32 s20, s20, 133120
  v_add_u32 v7, s20, v7
  v_mul_u32_u24 v44, 81920, v44
  v_add_u32 v9, v9, v44
  s_mul_i32 s20, s16, 163840
  s_lshl_b32 s21, s17, 8
  s_add_u32 s20, s20, s21
  s_add_u32 s20, s20, s52
  v_add_u32 v9, s20, v9
  v_mov_b32 v10, 0
  v_lshlrev_b32 v12, 4, v43
  v_and_b32 v44, 1, v40
  v_lshl_add_u32 v12, v44, 3, v12
  v_lshrrev_b32 v44, 1, v40
  v_mul_u32_u24 v44, 1280, v44
  s_mul_i32 s20, s16, 2560
  s_add_u32 s20, s20, 136192
  v_add3_u32 v12, v12, v44, s20
  s_and_b32 s22, s16, 1
  s_mul_i32 s20, s22, 5120
  s_add_u32 s20, s20, 136192
  v_lshl_add_u32 v13, v1, 4, s20
  v_lshlrev_b32 v144, 14, v40
  v_lshl_add_u32 v144, v43, 4, v144
  s_mul_i32 s20, s22, 327680
  s_add_u32 s20, s20, s21
  v_add_u32 v144, s20, v144
  v_mov_b32 v140, -1
  v_mov_b32 v141, -1
  v_mov_b32 v142, -1
  v_mov_b32 v143, -1
  s_mov_b32 s24, 65536
  s_mov_b32 s25, 458752
  s_add_u32 s26, s52, 1114112
  s_mov_b32 s27, 11796480
  s_lshl_b32 s29, s17, 7
  s_lshl_b32 s20, s22, 2
  s_add_u32 s29, s29, s20
  s_add_u32 s29, s29, 22528
  s_mov_b32 s30, 0
  s_mov_b32 s32, 0
  v_lshlrev_b32 v146, 7, v1
  s_add_u32 s89, s52, 49152
  s_add_u32 s83, s52, 32768
  s_mov_b32 s84, 104
  s_mov_b32 s85, 0
  s_mov_b32 s90, 0
  s_mov_b32 s91, 0
  s_memrealtime s[92:93]
  s_waitcnt lgkmcnt(0)
  s_mov_b32 s94, s92
  s_mov_b32 s95, s92
  s_mov_b32 s86, 0
  s_add_u32 s87, s17, 32
  s_lshl_b32 s87, s87, 7
  s_lshl_b32 s20, s22, 2
  s_add_u32 s87, s87, s20
  s_add_u32 s87, s87, s89
  s_cmp_lt_u32 s16, 2
  s_cselect_b64 s[42:43], 1, 0
B_loop:
  v_mov_b32 v16, 0
  v_mov_b32 v17, 0
  v_mov_b32 v18, 0
  v_mov_b32 v19, 0
  v_mov_b32 v20, 0
  v_mov_b32 v21, 0
  v_mov_b32 v22, 0
  v_mov_b32 v23, 0
  v_mov_b32 v24, 0
  v_mov_b32 v25, 0
  v_mov_b32 v26, 0
  v_mov_b32 v27, 0
  v_mov_b32 v52, 0
  v_mov_b32 v53, 0
  v_mov_b32 v54, 0
  v_mov_b32 v55, 0
  v_mov_b32 v56, 0
  v_mov_b32 v57, 0
  v_mov_b32 v58, 0
  v_mov_b32 v59, 0
  v_mov_b32 v60, 0
  v_mov_b32 v61, 0
  v_mov_b32 v62, 0
  v_mov_b32 v63, 0
  v_mov_b32 v64, 0
  v_mov_b32 v65, 0
  v_mov_b32 v66, 0
  v_mov_b32 v67, 0
  v_mov_b32 v68, 0
  v_mov_b32 v69, 0
  v_mov_b32 v70, 0
  v_mov_b32 v71, 0
  v_mov_b32 v72, 0
  v_mov_b32 v73, 0
  v_mov_b32 v74, 0
  v_mov_b32 v75, 0
  v_mov_b32 v76, 0
  v_mov_b32 v77, 0
  v_mov_b32 v78, 0
  v_mov_b32 v79, 0
  v_mov_b32 v80, 0
  v_mov_b32 v81, 0
  v_mov_b32 v82, 0
  v_mov_b32 v83, 0
  v_mov_b32 v84, 0
  v_mov_b32 v85, 0
  v_mov_b32 v86, 0
  v_mov_b32 v87, 0
  v_mov_b32 v88, 0
  v_mov_b32 v89, 0
  v_mov_b32 v90, 0
  v_mov_b32 v91, 0
  ds_read_b128 v[92:95], v5 offset:0
  ds_read_b128 v[96:99], v5 offset:1024
  ds_read_b128 v[100:103], v5 offset:2048
  ds_read_b128 v[104:107], v5 offset:3072
  ds_read_b128 v[108:111], v5 offset:4096
  ds_read_b128 v[112:115], v5 offset:5120
  ds_read_b128 v[116:119], v5 offset:6144
  ds_read_b128 v[120:123], v5 offset:7168
  ds_read_b128 v[124:127], v5 offset:8192
  ds_read_b128 v[128:131], v5 offset:9216
  ds_read_b128 v[132:135], v5 offset:10240
  ds_read_b128 v[136:139], v5 offset:11264
  s_cmp_lt_u32 s16, 2
  s_cbranch_scc0 B_cp
  s_cmp_eq_u32 s30, 0
  s_cbranch_scc1 B_g0
W_57:
  s_memrealtime s[92:93]
  s_waitcnt lgkmcnt(0)
  s_sub_u32 s93, s95, s92
  s_cmp_gt_i32 s93, 0
  s_cbranch_scc1 W_57
  buffer_load_dword v32, v146, s[4:7], s83 offen sc1
H_58:
  buffer_load_dwordx2 v[28:29], v146, s[4:7], s89 offen sc1
  s_waitcnt vmcnt(0)
  v_subrev_u32 v30, s30, v28
  v_subrev_u32 v31, s30, v29
  v_or_b32 v30, v30, v31
  v_and_b32 v30, 62, v30
  v_cmp_ne_u32 vcc, 0, v30
  s_cbranch_vccz H_59
  s_add_u32 s32, s32, 1
  s_cmp_gt_u32 s32, 200000
  s_cbranch_scc1 H_59
  s_add_u32 s90, s90, 1
  s_sleep 4
  s_branch H_58
H_59:
  s_lshl_b32 s93, s92, 6
  v_subrev_u32 v28, s93, v28
  v_subrev_u32 v29, s93, v29
  v_max_i32 v28, v28, v29
  v_ashrrev_i32 v28, 6, v28
  s_nop 1
  v_max_i32 v28, v28, v28 row_ror:8 row_mask:0xf bank_mask:0xf
  v_max_i32 v32, v32, v32 row_ror:8 row_mask:0xf bank_mask:0xf
  s_nop 0
  v_max_i32 v28, v28, v28 row_ror:4 row_mask:0xf bank_mask:0xf
  v_max_i32 v32, v32, v32 row_ror:4 row_mask:0xf bank_mask:0xf
  s_nop 0
  v_max_i32 v28, v28, v28 row_ror:2 row_mask:0xf bank_mask:0xf
  v_max_i32 v32, v32, v32 row_ror:2 row_mask:0xf bank_mask:0xf
  s_nop 0
  v_max_i32 v28, v28, v28 row_ror:1 row_mask:0xf bank_mask:0xf
  v_max_i32 v32, v32, v32 row_ror:1 row_mask:0xf bank_mask:0xf
  s_nop 1
  v_readlane_b32 s96, v28, 0
  v_readlane_b32 s93, v28, 16
  s_max_i32 s96, s96, s93
  v_readlane_b32 s97, v28, 32
  v_readlane_b32 s93, v28, 48
  s_max_i32 s97, s97, s93
  s_add_u32 s93, s97, 4
  s_max_i32 s96, s96, s93
  s_min_i32 s96, s96, 2000
  s_add_u32 s96, s96, s92
  v_readlane_b32 s97, v32, 0
  v_readlane_b32 s93, v32, 16
  s_max_i32 s97, s97, s93
  v_readlane_b32 s93, v32, 32
  s_max_i32 s97, s97, s93
  s_min_i32 s97, s97, 300
  s_add_u32 s97, s97, s96
  s_add_u32 s94, s97, 19
W_60:
  s_memrealtime s[92:93]
  s_waitcnt lgkmcnt(0)
  s_sub_u32 s93, s94, s92
  s_cmp_gt_i32 s93, 0
  s_cbranch_scc1 W_60
B_g0:
  s_add_u32 s20, s24, 4096
  buffer_load_dwordx4 v[28:31], v2, s[4:7], s24 offen offset:0 sc1
  buffer_load_dwordx4 v[32:35], v2, s[4:7], s24 offen offset:1024 sc1
  buffer_load_dwordx4 v[36:39], v2, s[4:7], s24 offen offset:2048 sc1
  buffer_load_dwordx4 v[40:43], v2, s[4:7], s24 offen offset:3072 sc1
  buffer_load_dwordx4 v[44:47], v2, s[4:7], s20 offen offset:0 sc1
  s_mov_b32 s85, 0
  s_barrier
  s_branch Bg2_62
Bg_61:
  buffer_load_dwordx4 v[28:31], v2, s[4:7], s24 offen offset:0 sc1
  buffer_load_dwordx4 v[32:35], v2, s[4:7], s24 offen offset:1024 sc1
  buffer_load_dwordx4 v[36:39], v2, s[4:7], s24 offen offset:2048 sc1
  buffer_load_dwordx4 v[40:43], v2, s[4:7], s24 offen offset:3072 sc1
  buffer_load_dwordx4 v[44:47], v2, s[4:7], s20 offen offset:0 sc1
  s_mov_b32 s85, 15
Bg2_62:
  s_waitcnt vmcnt(4)
  ds_write_b128 v3, v[28:31] offset:0
  v_max3_u32 v11, v28, v29, v30
  v_max_u32 v11, v11, v31
  s_waitcnt vmcnt(3)
  ds_write_b128 v3, v[32:35] offset:1024
  v_max3_u32 v11, v32, v33, v11
  v_max3_u32 v11, v34, v35, v11
  s_waitcnt vmcnt(2)
  ds_write_b128 v3, v[36:39] offset:2048
  v_max3_u32 v11, v36, v37, v11
  v_max3_u32 v11, v38, v39, v11
  s_waitcnt vmcnt(1)
  s_memrealtime s[92:93]
  ds_write_b128 v3, v[40:43] offset:3072
  v_max3_u32 v11, v40, v41, v11
  v_max3_u32 v11, v42, v43, v11
  s_waitcnt vmcnt(0)
  ds_write_b128 v3, v[44:47] offset:4096
  v_max3_u32 v11, v44, v45, v11
  v_max3_u32 v11, v46, v47, v11
  v_cmp_eq_u32 vcc, -1, v11
  s_cbranch_vccz B_b1
  s_add_u32 s32, s32, 1
  s_cmp_gt_u32 s32, 200000
  s_cbranch_scc1 B_b1
  s_add_u32 s91, s91, 1
  s_sleep 6
  s_branch Bg_61
B_cp:
  ds_read_b128 v[28:31], v13 offset:0
  ds_read_b128 v[32:35], v13 offset:1024
  ds_read_b128 v[36:39], v13 offset:2048
  ds_read_b128 v[40:43], v13 offset:3072
  ds_read_b128 v[44:47], v13 offset:4096
  s_waitcnt lgkmcnt(0)
  s_barrier
  s_cmp_eq_u32 s30, 0
  s_cbranch_scc1 B_b1
  s_add_u32 s20, s27, 0
  buffer_store_dwordx4 v[28:31], v144, s[4:7], s20 offen sc1
  s_add_u32 s20, s27, 65536
  buffer_store_dwordx4 v[32:35], v144, s[4:7], s20 offen sc1
  s_add_u32 s20, s27, 131072
  buffer_store_dwordx4 v[36:39], v144, s[4:7], s20 offen sc1
  s_add_u32 s20, s27, 196608
  buffer_store_dwordx4 v[40:43], v144, s[4:7], s20 offen sc1
  s_add_u32 s20, s27, 262144
  buffer_store_dwordx4 v[44:47], v144, s[4:7], s20 offen sc1
  s_bitcmp0_b32 s30, 0
  s_movk_i32 s20, 8192
  s_cselect_b32 s20, 647168, s20
  s_add_u32 s27, s27, s20
B_b1:
  s_waitcnt lgkmcnt(0)
  s_barrier
  ds_read_b64_tr_b16 v[28:29], v4 offset:0
  ds_read_b64_tr_b16 v[30:31], v4 offset:256
  ds_read_b64_tr_b16 v[32:33], v4 offset:1024
  ds_read_b64_tr_b16 v[34:35], v4 offset:1280
  s_add_u32 s86, s92, s85
  s_add_u32 s86, s86, s84
  s_mov_b32 s81, s92
  s_lshl_b32 s86, s86, 6
  s_add_u32 s93, s30, 1
  s_and_b32 s93, s93, 63
  s_or_b32 s86, s86, s93
  s_add_u32 s95, s92, 100
  ds_read_b64_tr_b16 v[36:37], v4 offset:2048
  ds_read_b64_tr_b16 v[38:39], v4 offset:2304
  s_waitcnt lgkmcnt(4)
  v_smfmac_f32_16x16x64_bf16 v[16:19], v[28:31], a[0:7], v6
  v_mov_b32 v11, s86
  s_mov_b64 exec, s[42:43]
  v_smfmac_f32_16x16x64_bf16 v[20:23], v[28:31], a[80:87], v6
  buffer_store_dword v11, v10, s[4:7], s87 offen sc1
  s_mov_b64 exec, -1
  v_smfmac_f32_16x16x64_bf16 v[24:27], v[28:31], a[160:167], v6
  ds_read_b64_tr_b16 v[28:29], v4 offset:3072
  ds_read_b64_tr_b16 v[30:31], v4 offset:3328
  s_waitcnt lgkmcnt(4)
  v_smfmac_f32_16x16x64_bf16 v[16:19], v[32:35], a[8:15], v6
  v_smfmac_f32_16x16x64_bf16 v[20:23], v[32:35], a[88:95], v6
  v_smfmac_f32_16x16x64_bf16 v[24:27], v[32:35], a[168:175], v6
  ds_read_b64_tr_b16 v[32:33], v4 offset:4096
  ds_read_b64_tr_b16 v[34:35], v4 offset:4352
  s_waitcnt lgkmcnt(4)
  v_smfmac_f32_16x16x64_bf16 v[16:19], v[36:39], a[16:23], v6
  v_smfmac_f32_16x16x64_bf16 v[20:23], v[36:39], a[96:103], v6
  v_smfmac_f32_16x16x64_bf16 v[24:27], v[36:39], a[176:183], v6
  ds_read_b64_tr_b16 v[36:37], v4 offset:5120
  ds_read_b64_tr_b16 v[38:39], v4 offset:5376
  s_waitcnt lgkmcnt(4)
  v_smfmac_f32_16x16x64_bf16 v[16:19], v[28:31], a[24:31], v6
  v_smfmac_f32_16x16x64_bf16 v[20:23], v[28:31], a[104:111], v6
  v_smfmac_f32_16x16x64_bf16 v[24:27], v[28:31], a[184:191], v6
  ds_read_b64_tr_b16 v[28:29], v4 offset:6144
  ds_read_b64_tr_b16 v[30:31], v4 offset:6400
  s_waitcnt lgkmcnt(4)
  v_smfmac_f32_16x16x64_bf16 v[16:19], v[32:35], a[32:39], v6
  v_smfmac_f32_16x16x64_bf16 v[20:23], v[32:35], a[112:119], v6
  v_smfmac_f32_16x16x64_bf16 v[24:27], v[32:35], a[192:199], v6
  ds_read_b64_tr_b16 v[32:33], v4 offset:7168
  ds_read_b64_tr_b16 v[34:35], v4 offset:7424
  s_waitcnt lgkmcnt(4)
  v_smfmac_f32_16x16x64_bf16 v[16:19], v[36:39], a[40:47], v6
  v_smfmac_f32_16x16x64_bf16 v[20:23], v[36:39], a[120:127], v6
  v_smfmac_f32_16x16x64_bf16 v[24:27], v[36:39], a[200:207], v6
  ds_read_b64_tr_b16 v[36:37], v4 offset:8192
  ds_read_b64_tr_b16 v[38:39], v4 offset:8448
  s_waitcnt lgkmcnt(4)
  v_smfmac_f32_16x16x64_bf16 v[16:19], v[28:31], a[48:55], v6
  v_smfmac_f32_16x16x64_bf16 v[20:23], v[28:31], a[128:135], v6
  v_smfmac_f32_16x16x64_bf16 v[24:27], v[28:31], a[208:215], v6
  ds_read_b64_tr_b16 v[28:29], v4 offset:9216
  ds_read_b64_tr_b16 v[30:31], v4 offset:9472
  s_waitcnt lgkmcnt(4)
  v_smfmac_f32_16x16x64_bf16 v[16:19], v[32:35], a[56:63], v6
  v_smfmac_f32_16x16x64_bf16 v[20:23], v[32:35], a[136:143], v6
  v_smfmac_f32_16x16x64_bf16 v[24:27], v[32:35], a[216:223], v6
  s_waitcnt lgkmcnt(2)
  v_smfmac_f32_16x16x64_bf16 v[16:19], v[36:39], a[64:71], v6
  v_smfmac_f32_16x16x64_bf16 v[20:23], v[36:39], a[144:151], v6
  v_smfmac_f32_16x16x64_bf16 v[24:27], v[36:39], a[224:231], v6
  s_waitcnt lgkmcnt(0)
  v_smfmac_f32_16x16x64_bf16 v[16:19], v[28:31], a[72:79], v6
  v_smfmac_f32_16x16x64_bf16 v[20:23], v[28:31], a[152:159], v6
  v_smfmac_f32_16x16x64_bf16 v[24:27], v[28:31], a[232:239], v6
  s_nop 3
  s_nop 1
  v_permlane32_swap_b32 v16, v18
  v_permlane32_swap_b32 v17, v19
  s_nop 0
  v_add_f32 v16, v16, v18
  v_add_f32 v17, v17, v19
  v_cvt_pk_bf16_f32 v16, v16, v17
  ds_write_b32 v7, v16 offset:0
  s_nop 1
  v_permlane32_swap_b32 v20, v22
  v_permlane32_swap_b32 v21, v23
  s_nop 0
  v_add_f32 v20, v20, v22
  v_add_f32 v21, v21, v23
  v_cvt_pk_bf16_f32 v20, v20, v21
  ds_write_b32 v7, v20 offset:256
  s_nop 1
  v_permlane32_swap_b32 v24, v26
  v_permlane32_swap_b32 v25, v27
  s_nop 0
  v_add_f32 v24, v24, v26
  v_add_f32 v25, v25, v27
  v_cvt_pk_bf16_f32 v24, v24, v25
  ds_write_b32 v7, v24 offset:512
  s_waitcnt lgkmcnt(0)
  s_barrier
  ds_read_b64_tr_b16 v[40:41], v8 offset:0
  ds_read_b64_tr_b16 v[42:43], v8 offset:256
  ds_read_b64_tr_b16 v[44:45], v8 offset:1024
  ds_read_b64_tr_b16 v[46:47], v8 offset:1280
  ds_read_b64_tr_b16 v[48:49], v8 offset:2048
  ds_read_b64_tr_b16 v[50:51], v8 offset:2304
  s_waitcnt lgkmcnt(4)
  v_smfmac_f32_16x16x64_bf16 v[52:55], v[40:43], v[92:99], v6
  v_smfmac_f32_16x16x64_bf16 v[56:59], v[40:43], a[240:247], v6
  ds_read_b128 v[92:95], v5 offset:12288
  ds_read_b128 v[96:99], v5 offset:13312
  s_waitcnt lgkmcnt(4)
  v_smfmac_f32_16x16x64_bf16 v[52:55], v[44:47], v[100:107], v6
  v_smfmac_f32_16x16x64_bf16 v[56:59], v[44:47], a[248:255], v6
  ds_read_b128 v[100:103], v5 offset:14336
  ds_read_b128 v[104:107], v5 offset:15360
  s_waitcnt lgkmcnt(4)
  v_smfmac_f32_16x16x64_bf16 v[52:55], v[48:51], v[108:115], v6
  v_smfmac_f32_16x16x64_bf16 v[56:59], v[48:51], v[152:159], v6
  ds_read_b128 v[108:111], v5 offset:16384
  ds_read_b128 v[112:115], v5 offset:17408
  v_smfmac_f32_16x16x64_bf16 v[60:63], v[40:43], v[116:123], v6
  v_smfmac_f32_16x16x64_bf16 v[64:67], v[40:43], v[160:167], v6
  ds_read_b128 v[116:119], v5 offset:18432
  ds_read_b128 v[120:123], v5 offset:19456
  v_smfmac_f32_16x16x64_bf16 v[60:63], v[44:47], v[124:131], v6
  v_smfmac_f32_16x16x64_bf16 v[64:67], v[44:47], v[168:175], v6
  ds_read_b128 v[124:127], v5 offset:20480
  ds_read_b128 v[128:131], v5 offset:21504
  v_permlane32_swap_b32 v52, v56
  v_permlane32_swap_b32 v53, v57
  v_permlane32_swap_b32 v54, v58
  v_permlane32_swap_b32 v55, v59
  v_add_f32 v52, v52, v56
  v_add_f32 v53, v53, v57
  v_add_f32 v54, v54, v58
  v_add_f32 v55, v55, v59
  v_cvt_pk_bf16_f32 v52, v52, v53
  v_cvt_pk_bf16_f32 v53, v54, v55
  s_add_u32 s20, s25, 0
  buffer_store_dwordx2 v[52:53], v9, s[4:7], s20 offen sc1
  v_smfmac_f32_16x16x64_bf16 v[60:63], v[48:51], v[132:139], v6
  v_smfmac_f32_16x16x64_bf16 v[64:67], v[48:51], v[176:183], v6
  ds_read_b128 v[132:135], v5 offset:22528
  ds_read_b128 v[136:139], v5 offset:23552
  s_waitcnt lgkmcnt(10)
  v_smfmac_f32_16x16x64_bf16 v[68:71], v[40:43], v[92:99], v6
  v_smfmac_f32_16x16x64_bf16 v[72:75], v[40:43], v[184:191], v6
  ds_read_b128 v[92:95], v5 offset:24576
  ds_read_b128 v[96:99], v5 offset:25600
  s_waitcnt lgkmcnt(10)
  v_smfmac_f32_16x16x64_bf16 v[68:71], v[44:47], v[100:107], v6
  v_smfmac_f32_16x16x64_bf16 v[72:75], v[44:47], v[192:199], v6
  ds_read_b128 v[100:103], v5 offset:26624
  ds_read_b128 v[104:107], v5 offset:27648
  v_permlane32_swap_b32 v60, v64
  v_permlane32_swap_b32 v61, v65
  v_permlane32_swap_b32 v62, v66
  v_permlane32_swap_b32 v63, v67
  v_add_f32 v60, v60, v64
  v_add_f32 v61, v61, v65
  v_add_f32 v62, v62, v66
  v_add_f32 v63, v63, v67
  v_cvt_pk_bf16_f32 v60, v60, v61
  v_cvt_pk_bf16_f32 v61, v62, v63
  s_add_u32 s20, s25, 16384
  buffer_store_dwordx2 v[60:61], v9, s[4:7], s20 offen sc1
  s_waitcnt lgkmcnt(10)
  v_smfmac_f32_16x16x64_bf16 v[68:71], v[48:51], v[108:115], v6
  v_smfmac_f32_16x16x64_bf16 v[72:75], v[48:51], v[200:207], v6
  ds_read_b128 v[108:111], v5 offset:28672
  ds_read_b128 v[112:115], v5 offset:29696
  s_waitcnt lgkmcnt(10)
  v_smfmac_f32_16x16x64_bf16 v[76:79], v[40:43], v[116:123], v6
  v_smfmac_f32_16x16x64_bf16 v[80:83], v[40:43], v[208:215], v6
  s_waitcnt lgkmcnt(8)
  v_smfmac_f32_16x16x64_bf16 v[76:79], v[44:47], v[124:131], v6
  v_smfmac_f32_16x16x64_bf16 v[80:83], v[44:47], v[216:223], v6
  v_permlane32_swap_b32 v68, v72
  v_permlane32_swap_b32 v69, v73
  v_permlane32_swap_b32 v70, v74
  v_permlane32_swap_b32 v71, v75
  v_add_f32 v68, v68, v72
  v_add_f32 v69, v69, v73
  v_add_f32 v70, v70, v74
  v_add_f32 v71, v71, v75
  v_cvt_pk_bf16_f32 v68, v68, v69
  v_cvt_pk_bf16_f32 v69, v70, v71
  s_add_u32 s20, s25, 32768
  buffer_store_dwordx2 v[68:69], v9, s[4:7], s20 offen sc1
  s_waitcnt lgkmcnt(6)
  v_smfmac_f32_16x16x64_bf16 v[76:79], v[48:51], v[132:139], v6
  v_smfmac_f32_16x16x64_bf16 v[80:83], v[48:51], v[224:231], v6
  s_waitcnt lgkmcnt(4)
  v_smfmac_f32_16x16x64_bf16 v[84:87], v[40:43], v[92:99], v6
  v_smfmac_f32_16x16x64_bf16 v[88:91], v[40:43], v[232:239], v6
  s_waitcnt lgkmcnt(2)
  v_smfmac_f32_16x16x64_bf16 v[84:87], v[44:47], v[100:107], v6
  v_smfmac_f32_16x16x64_bf16 v[88:91], v[44:47], v[240:247], v6
  v_permlane32_swap_b32 v76, v80
  v_permlane32_swap_b32 v77, v81
  v_permlane32_swap_b32 v78, v82
  v_permlane32_swap_b32 v79, v83
  v_add_f32 v76, v76, v80
  v_add_f32 v77, v77, v81
  v_add_f32 v78, v78, v82
  v_add_f32 v79, v79, v83
  v_cvt_pk_bf16_f32 v76, v76, v77
  v_cvt_pk_bf16_f32 v77, v78, v79
  s_add_u32 s20, s25, 49152
  buffer_store_dwordx2 v[76:77], v9, s[4:7], s20 offen sc1
  s_waitcnt lgkmcnt(0)
  v_smfmac_f32_16x16x64_bf16 v[84:87], v[48:51], v[108:115], v6
  v_smfmac_f32_16x16x64_bf16 v[88:91], v[48:51], v[248:255], v6
  s_nop 7
  v_permlane32_swap_b32 v84, v88
  v_permlane32_swap_b32 v85, v89
  v_permlane32_swap_b32 v86, v90
  v_permlane32_swap_b32 v87, v91
  v_add_f32 v84, v84, v88
  v_add_f32 v85, v85, v89
  v_add_f32 v86, v86, v90
  v_add_f32 v87, v87, v91
  v_cvt_pk_bf16_f32 v84, v84, v85
  v_cvt_pk_bf16_f32 v85, v86, v87
  s_add_u32 s20, s25, 65536
  buffer_store_dwordx2 v[84:85], v9, s[4:7], s20 offen sc1
  s_memrealtime s[92:93]
  s_waitcnt lgkmcnt(0)
  s_sub_u32 s93, s92, s81
  s_add_u32 s82, s84, 20
  s_cmp_gt_i32 s93, s82
  s_cselect_b32 s93, s84, s93
  s_sub_u32 s82, s84, 1
  s_max_i32 s93, s93, s82
  s_add_u32 s82, s84, 8
  s_min_i32 s93, s93, s82
  s_cmp_eq_u32 s85, 0
  s_cselect_b32 s84, s93, s84
  ds_write_b64 v12, v[52:53] offset:0
  ds_write_b64 v12, v[60:61] offset:256
  ds_write_b64 v12, v[68:69] offset:512
  ds_write_b64 v12, v[76:77] offset:768
  ds_write_b64 v12, v[84:85] offset:1024
  s_cmp_lt_u32 s16, 2
  s_waitcnt lgkmcnt(0)
  s_barrier
  s_cbranch_scc1 B_next
  s_add_u32 s20, s26, 0
  buffer_store_dwordx4 v[140:143], v144, s[4:7], s20 offen sc1
  s_add_u32 s20, s26, 65536
  buffer_store_dwordx4 v[140:143], v144, s[4:7], s20 offen sc1
  s_add_u32 s20, s26, 131072
  buffer_store_dwordx4 v[140:143], v144, s[4:7], s20 offen sc1
  s_add_u32 s20, s26, 196608
  buffer_store_dwordx4 v[140:143], v144, s[4:7], s20 offen sc1
  s_add_u32 s20, s26, 262144
  buffer_store_dwordx4 v[140:143], v144, s[4:7], s20 offen sc1
  s_waitcnt vmcnt(0)
  v_mov_b32 v11, s30
  buffer_store_dword v11, v10, s[4:7], s29 offen sc1
B_next:
  s_add_u32 s30, s30, 1
  s_add_u32 s26, s25, s52
  s_add_u32 s24, s24, 32768
  s_cmp_eq_u32 s24, 196608
  s_cselect_b32 s24, 65536, s24
  s_add_u32 s25, s25, 655360
  s_cmp_eq_u32 s25, 1769472
  s_cselect_b32 s25, 458752, s25
  s_cmp_lt_u32 s30, 64
  s_cbranch_scc1 B_loop
  s_cmp_lt_u32 s16, 2
  s_cbranch_scc1 B_end
  ds_read_b128 v[28:31], v13 offset:0
  ds_read_b128 v[32:35], v13 offset:1024
  ds_read_b128 v[36:39], v13 offset:2048
  ds_read_b128 v[40:43], v13 offset:3072
  ds_read_b128 v[44:47], v13 offset:4096
  s_waitcnt lgkmcnt(0)
  s_add_u32 s20, s27, 0
  buffer_store_dwordx4 v[28:31], v144, s[4:7], s20 offen sc1
  s_add_u32 s20, s27, 65536
  buffer_store_dwordx4 v[32:35], v144, s[4:7], s20 offen sc1
  s_add_u32 s20, s27, 131072
  buffer_store_dwordx4 v[36:39], v144, s[4:7], s20 offen sc1
  s_add_u32 s20, s27, 196608
  buffer_store_dwordx4 v[40:43], v144, s[4:7], s20 offen sc1
  s_add_u32 s20, s27, 262144
  buffer_store_dwordx4 v[44:47], v144, s[4:7], s20 offen sc1
  s_waitcnt vmcnt(0)
  v_mov_b32 v11, s30
  buffer_store_dword v11, v10, s[4:7], s29 offen sc1
B_end:
  s_endpgm
R_T1:
  s_lshr_b32 s20, s17, 5
  s_lshl_b32 s21, s20, 3
  s_add_u32 s21, s21, 16
  s_cmp_eq_u32 s20, 3
  s_cselect_b32 s21, 64, s21
  s_load_dwordx2 s[8:9], s[0:1], s21
  s_mov_b32 s10, 7864320
  s_cselect_b32 s10, 1966080, s10
  s_mov_b32 s11, 0x20000
  s_and_b32 s24, s17, 31
  s_mul_i32 s24, s24, 384
  s_load_dwordx2 s[12:13], s[0:1], 72
  s_mov_b32 s14, 3072
  s_mov_b32 s15, 0x20000
  v_mov_b32 v100, 0
  v_mov_b32 v101, 0
  v_mov_b32 v102, 0
  v_mov_b32 v103, 0
  v_mov_b32 v104, 0
  v_mov_b32 v105, 0
  v_mov_b32 v106, 0
  v_mov_b32 v107, 0
  v_mov_b32 v108, 0
  v_mov_b32 v109, 0
  v_mov_b32 v110, 0
  v_mov_b32 v111, 0
  s_waitcnt lgkmcnt(0)
  s_cmp_eq_u32 s20, 3
  s_cbranch_scc1 T1_ffn_w
  v_lshrrev_b32 v8, 3, v1
  s_lshl_b32 s20, s16, 3
  v_add_u32 v8, s20, v8
  v_mul_u32_u24 v8, 12288, v8
  v_and_b32 v9, 7, v1
  s_lshl_b32 s20, s16, 1
  v_xor_b32 v9, s20, v9
  v_lshl_add_u32 v2, v9, 4, v8
  v_lshrrev_b32 v8, 4, v1
  v_mul_u32_u24 v9, 3072, v8
  v_bfe_u32 v10, v1, 2, 2
  v_lshl_add_u32 v9, v10, 7, v9
  v_and_b32 v10, 3, v1
  v_lshl_add_u32 v9, v10, 3, v9
  s_mul_i32 s20, s16, 3
  s_add_u32 s20, s20, 0
  s_and_b32 s21, s20, 3
  s_lshr_b32 s20, s20, 2
  s_lshl_b32 s20, s20, 10
  v_xor_b32 v10, s21, v8
  v_lshl_add_u32 v10, v10, 5, v9
  v_add_u32 v3, s20, v10
  s_mul_i32 s20, s16, 3
  s_add_u32 s20, s20, 1
  s_and_b32 s21, s20, 3
  s_lshr_b32 s20, s20, 2
  s_lshl_b32 s20, s20, 10
  v_xor_b32 v10, s21, v8
  v_lshl_add_u32 v10, v10, 5, v9
  v_add_u32 v4, s20, v10
  s_mul_i32 s20, s16, 3
  s_add_u32 s20, s20, 2
  s_and_b32 s21, s20, 3
  s_lshr_b32 s20, s20, 2
  s_lshl_b32 s20, s20, 10
  v_xor_b32 v10, s21, v8
  v_lshl_add_u32 v10, v10, 5, v9
  v_add_u32 v5, s20, v10
  s_mul_i32 s27, s16, 3072
  s_add_u32 m0, s27, 0
  s_add_u32 s26, s24, 0
  buffer_load_dwordx4 v2, s[8:11], s26 offen lds
  s_add_u32 m0, s27, 1024
  s_add_u32 s26, s24, 128
  buffer_load_dwordx4 v2, s[8:11], s26 offen lds
  s_add_u32 m0, s27, 2048
  s_add_u32 s26, s24, 256
  buffer_load_dwordx4 v2, s[8:11], s26 offen lds
  s_add_u32 m0, s27, 12288
  s_add_u32 s26, s24, 393216
  buffer_load_dwordx4 v2, s[8:11], s26 offen lds
  s_add_u32 m0, s27, 13312
  s_add_u32 s26, s24, 393344
  buffer_load_dwordx4 v2, s[8:11], s26 offen lds
  s_add_u32 m0, s27, 14336
  s_add_u32 s26, s24, 393472
  buffer_load_dwordx4 v2, s[8:11], s26 offen lds
  s_add_u32 m0, s27, 24576
  s_add_u32 s26, s24, 786432
  buffer_load_dwordx4 v2, s[8:11], s26 offen lds
  s_add_u32 m0, s27, 25600
  s_add_u32 s26, s24, 786560
  buffer_load_dwordx4 v2, s[8:11], s26 offen lds
  s_add_u32 m0, s27, 26624
  s_add_u32 s26, s24, 786688
  buffer_load_dwordx4 v2, s[8:11], s26 offen lds
  s_add_u32 m0, s27, 36864
  s_add_u32 s26, s24, 1179648
  buffer_load_dwordx4 v2, s[8:11], s26 offen lds
  s_add_u32 m0, s27, 37888
  s_add_u32 s26, s24, 1179776
  buffer_load_dwordx4 v2, s[8:11], s26 offen lds
  s_add_u32 m0, s27, 38912
  s_add_u32 s26, s24, 1179904
  buffer_load_dwordx4 v2, s[8:11], s26 offen lds
  s_mul_i32 s27, s16, 3072
  s_add_u32 m0, s27, 49152
  s_add_u32 s26, s24, 1572864
  buffer_load_dwordx4 v2, s[8:11], s26 offen lds
  s_add_u32 m0, s27, 50176
  s_add_u32 s26, s24, 1572992
  buffer_load_dwordx4 v2, s[8:11], s26 offen lds
  s_add_u32 m0, s27, 51200
  s_add_u32 s26, s24, 1573120
  buffer_load_dwordx4 v2, s[8:11], s26 offen lds
  s_add_u32 m0, s27, 61440
  s_add_u32 s26, s24, 1966080
  buffer_load_dwordx4 v2, s[8:11], s26 offen lds
  s_add_u32 m0, s27, 62464
  s_add_u32 s26, s24, 1966208
  buffer_load_dwordx4 v2, s[8:11], s26 offen lds
  s_add_u32 m0, s27, 63488
  s_add_u32 s26, s24, 1966336
  buffer_load_dwordx4 v2, s[8:11], s26 offen lds
  s_add_u32 m0, s27, 73728
  s_add_u32 s26, s24, 2359296
  buffer_load_dwordx4 v2, s[8:11], s26 offen lds
  s_add_u32 m0, s27, 74752
  s_add_u32 s26, s24, 2359424
  buffer_load_dwordx4 v2, s[8:11], s26 offen lds
  s_add_u32 m0, s27, 75776
  s_add_u32 s26, s24, 2359552
  buffer_load_dwordx4 v2, s[8:11], s26 offen lds
  s_add_u32 m0, s27, 86016
  s_add_u32 s26, s24, 2752512
  buffer_load_dwordx4 v2, s[8:11], s26 offen lds
  s_add_u32 m0, s27, 87040
  s_add_u32 s26, s24, 2752640
  buffer_load_dwordx4 v2, s[8:11], s26 offen lds
  s_add_u32 m0, s27, 88064
  s_add_u32 s26, s24, 2752768
  buffer_load_dwordx4 v2, s[8:11], s26 offen lds
  s_mul_i32 s27, s16, 3072
  s_add_u32 m0, s27, 98304
  s_add_u32 s26, s24, 3145728
  buffer_load_dwordx4 v2, s[8:11], s26 offen lds
  s_add_u32 m0, s27, 99328
  s_add_u32 s26, s24, 3145856
  buffer_load_dwordx4 v2, s[8:11], s26 offen lds
  s_add_u32 m0, s27, 100352
  s_add_u32 s26, s24, 3145984
  buffer_load_dwordx4 v2, s[8:11], s26 offen lds
  s_add_u32 m0, s27, 110592
  s_add_u32 s26, s24, 3538944
  buffer_load_dwordx4 v2, s[8:11], s26 offen lds
  s_add_u32 m0, s27, 111616
  s_add_u32 s26, s24, 3539072
  buffer_load_dwordx4 v2, s[8:11], s26 offen lds
  s_add_u32 m0, s27, 112640
  s_add_u32 s26, s24, 3539200
  buffer_load_dwordx4 v2, s[8:11], s26 offen lds
  s_add_u32 m0, s27, 122880
  s_add_u32 s26, s24, 3932160
  buffer_load_dwordx4 v2, s[8:11], s26 offen lds
  s_add_u32 m0, s27, 123904
  s_add_u32 s26, s24, 3932288
  buffer_load_dwordx4 v2, s[8:11], s26 offen lds
  s_add_u32 m0, s27, 124928
  s_add_u32 s26, s24, 3932416
  buffer_load_dwordx4 v2, s[8:11], s26 offen lds
  s_add_u32 m0, s27, 135168
  s_add_u32 s26, s24, 4325376
  buffer_load_dwordx4 v2, s[8:11], s26 offen lds
  s_add_u32 m0, s27, 136192
  s_add_u32 s26, s24, 4325504
  buffer_load_dwordx4 v2, s[8:11], s26 offen lds
  s_add_u32 m0, s27, 137216
  s_add_u32 s26, s24, 4325632
  buffer_load_dwordx4 v2, s[8:11], s26 offen lds
  s_waitcnt vmcnt(24)
  s_barrier
  v_add_u32 v8, 0, v3
  v_add_u32 v9, 0, v4
  v_add_u32 v10, 0, v5
  ds_read_b64_tr_b16 a[0:1], v8 offset:0
  ds_read_b64_tr_b16 a[2:3], v8 offset:512
  ds_read_b64_tr_b16 a[4:5], v8 offset:12288
  ds_read_b64_tr_b16 a[6:7], v8 offset:12800
  ds_read_b64_tr_b16 a[8:9], v8 offset:24576
  ds_read_b64_tr_b16 a[10:11], v8 offset:25088
  ds_read_b64_tr_b16 a[12:13], v8 offset:36864
  ds_read_b64_tr_b16 a[14:15], v8 offset:37376
  ds_read_b64_tr_b16 a[80:81], v9 offset:0
  ds_read_b64_tr_b16 a[82:83], v9 offset:512
  ds_read_b64_tr_b16 a[84:85], v9 offset:12288
  ds_read_b64_tr_b16 a[86:87], v9 offset:12800
  ds_read_b64_tr_b16 a[88:89], v9 offset:24576
  ds_read_b64_tr_b16 a[90:91], v9 offset:25088
  ds_read_b64_tr_b16 a[92:93], v9 offset:36864
  ds_read_b64_tr_b16 a[94:95], v9 offset:37376
  ds_read_b64_tr_b16 a[160:161], v10 offset:0
  ds_read_b64_tr_b16 a[162:163], v10 offset:512
  ds_read_b64_tr_b16 a[164:165], v10 offset:12288
  ds_read_b64_tr_b16 a[166:167], v10 offset:12800
  ds_read_b64_tr_b16 a[168:169], v10 offset:24576
  ds_read_b64_tr_b16 a[170:171], v10 offset:25088
  ds_read_b64_tr_b16 a[172:173], v10 offset:36864
  ds_read_b64_tr_b16 a[174:175], v10 offset:37376
  s_waitcnt lgkmcnt(0)
  s_waitcnt vmcnt(12)
  s_barrier
  s_mul_i32 s27, s16, 3072
  s_add_u32 m0, s27, 0
  s_add_u32 s26, s24, 4718592
  buffer_load_dwordx4 v2, s[8:11], s26 offen lds
  s_add_u32 m0, s27, 1024
  s_add_u32 s26, s24, 4718720
  buffer_load_dwordx4 v2, s[8:11], s26 offen lds
  s_add_u32 m0, s27, 2048
  s_add_u32 s26, s24, 4718848
  buffer_load_dwordx4 v2, s[8:11], s26 offen lds
  s_add_u32 m0, s27, 12288
  s_add_u32 s26, s24, 5111808
  buffer_load_dwordx4 v2, s[8:11], s26 offen lds
  s_add_u32 m0, s27, 13312
  s_add_u32 s26, s24, 5111936
  buffer_load_dwordx4 v2, s[8:11], s26 offen lds
  s_add_u32 m0, s27, 14336
  s_add_u32 s26, s24, 5112064
  buffer_load_dwordx4 v2, s[8:11], s26 offen lds
  s_add_u32 m0, s27, 24576
  s_add_u32 s26, s24, 5505024
  buffer_load_dwordx4 v2, s[8:11], s26 offen lds
  s_add_u32 m0, s27, 25600
  s_add_u32 s26, s24, 5505152
  buffer_load_dwordx4 v2, s[8:11], s26 offen lds
  s_add_u32 m0, s27, 26624
  s_add_u32 s26, s24, 5505280
  buffer_load_dwordx4 v2, s[8:11], s26 offen lds
  s_add_u32 m0, s27, 36864
  s_add_u32 s26, s24, 5898240
  buffer_load_dwordx4 v2, s[8:11], s26 offen lds
  s_add_u32 m0, s27, 37888
  s_add_u32 s26, s24, 5898368
  buffer_load_dwordx4 v2, s[8:11], s26 offen lds
  s_add_u32 m0, s27, 38912
  s_add_u32 s26, s24, 5898496
  buffer_load_dwordx4 v2, s[8:11], s26 offen lds
  v_add_u32 v8, 49152, v3
  v_add_u32 v9, 49152, v4
  v_add_u32 v10, 49152, v5
  ds_read_b64_tr_b16 a[16:17], v8 offset:0
  ds_read_b64_tr_b16 a[18:19], v8 offset:512
  ds_read_b64_tr_b16 a[20:21], v8 offset:12288
  ds_read_b64_tr_b16 a[22:23], v8 offset:12800
  ds_read_b64_tr_b16 a[24:25], v8 offset:24576
  ds_read_b64_tr_b16 a[26:27], v8 offset:25088
  ds_read_b64_tr_b16 a[28:29], v8 offset:36864
  ds_read_b64_tr_b16 a[30:31], v8 offset:37376
  ds_read_b64_tr_b16 a[96:97], v9 offset:0
  ds_read_b64_tr_b16 a[98:99], v9 offset:512
  ds_read_b64_tr_b16 a[100:101], v9 offset:12288
  ds_read_b64_tr_b16 a[102:103], v9 offset:12800
  ds_read_b64_tr_b16 a[104:105], v9 offset:24576
  ds_read_b64_tr_b16 a[106:107], v9 offset:25088
  ds_read_b64_tr_b16 a[108:109], v9 offset:36864
  ds_read_b64_tr_b16 a[110:111], v9 offset:37376
  ds_read_b64_tr_b16 a[176:177], v10 offset:0
  ds_read_b64_tr_b16 a[178:179], v10 offset:512
  ds_read_b64_tr_b16 a[180:181], v10 offset:12288
  ds_read_b64_tr_b16 a[182:183], v10 offset:12800
  ds_read_b64_tr_b16 a[184:185], v10 offset:24576
  ds_read_b64_tr_b16 a[186:187], v10 offset:25088
  ds_read_b64_tr_b16 a[188:189], v10 offset:36864
  ds_read_b64_tr_b16 a[190:191], v10 offset:37376
  s_waitcnt lgkmcnt(0)
  s_waitcnt vmcnt(12)
  s_barrier
  s_mul_i32 s27, s16, 3072
  s_add_u32 m0, s27, 49152
  s_add_u32 s26, s24, 6291456
  buffer_load_dwordx4 v2, s[8:11], s26 offen lds
  s_add_u32 m0, s27, 50176
  s_add_u32 s26, s24, 6291584
  buffer_load_dwordx4 v2, s[8:11], s26 offen lds
  s_add_u32 m0, s27, 51200
  s_add_u32 s26, s24, 6291712
  buffer_load_dwordx4 v2, s[8:11], s26 offen lds
  s_add_u32 m0, s27, 61440
  s_add_u32 s26, s24, 6684672
  buffer_load_dwordx4 v2, s[8:11], s26 offen lds
  s_add_u32 m0, s27, 62464
  s_add_u32 s26, s24, 6684800
  buffer_load_dwordx4 v2, s[8:11], s26 offen lds
  s_add_u32 m0, s27, 63488
  s_add_u32 s26, s24, 6684928
  buffer_load_dwordx4 v2, s[8:11], s26 offen lds
  s_add_u32 m0, s27, 73728
  s_add_u32 s26, s24, 7077888
  buffer_load_dwordx4 v2, s[8:11], s26 offen lds
  s_add_u32 m0, s27, 74752
  s_add_u32 s26, s24, 7078016
  buffer_load_dwordx4 v2, s[8:11], s26 offen lds
  s_add_u32 m0, s27, 75776
  s_add_u32 s26, s24, 7078144
  buffer_load_dwordx4 v2, s[8:11], s26 offen lds
  s_add_u32 m0, s27, 86016
  s_add_u32 s26, s24, 7471104
  buffer_load_dwordx4 v2, s[8:11], s26 offen lds
  s_add_u32 m0, s27, 87040
  s_add_u32 s26, s24, 7471232
  buffer_load_dwordx4 v2, s[8:11], s26 offen lds
  s_add_u32 m0, s27, 88064
  s_add_u32 s26, s24, 7471360
  buffer_load_dwordx4 v2, s[8:11], s26 offen lds
  s_cmp_eq_u32 s16, 0
  s_cbranch_scc0 DI_63
  buffer_load_dwordx2 v[16:17], off, s[48:51], 0 offset:8 sc1
DI_63:
  v_add_u32 v8, 98304, v3
  v_add_u32 v9, 98304, v4
  v_add_u32 v10, 98304, v5
  ds_read_b64_tr_b16 a[32:33], v8 offset:0
  ds_read_b64_tr_b16 a[34:35], v8 offset:512
  ds_read_b64_tr_b16 a[36:37], v8 offset:12288
  ds_read_b64_tr_b16 a[38:39], v8 offset:12800
  ds_read_b64_tr_b16 a[40:41], v8 offset:24576
  ds_read_b64_tr_b16 a[42:43], v8 offset:25088
  ds_read_b64_tr_b16 a[44:45], v8 offset:36864
  ds_read_b64_tr_b16 a[46:47], v8 offset:37376
  ds_read_b64_tr_b16 a[112:113], v9 offset:0
  ds_read_b64_tr_b16 a[114:115], v9 offset:512
  ds_read_b64_tr_b16 a[116:117], v9 offset:12288
  ds_read_b64_tr_b16 a[118:119], v9 offset:12800
  ds_read_b64_tr_b16 a[120:121], v9 offset:24576
  ds_read_b64_tr_b16 a[122:123], v9 offset:25088
  ds_read_b64_tr_b16 a[124:125], v9 offset:36864
  ds_read_b64_tr_b16 a[126:127], v9 offset:37376
  ds_read_b64_tr_b16 a[192:193], v10 offset:0
  ds_read_b64_tr_b16 a[194:195], v10 offset:512
  ds_read_b64_tr_b16 a[196:197], v10 offset:12288
  ds_read_b64_tr_b16 a[198:199], v10 offset:12800
  ds_read_b64_tr_b16 a[200:201], v10 offset:24576
  ds_read_b64_tr_b16 a[202:203], v10 offset:25088
  ds_read_b64_tr_b16 a[204:205], v10 offset:36864
  ds_read_b64_tr_b16 a[206:207], v10 offset:37376
  s_waitcnt lgkmcnt(0)
  s_waitcnt vmcnt(12)
  s_barrier
  v_add_u32 v8, 0, v3
  v_add_u32 v9, 0, v4
  v_add_u32 v10, 0, v5
  ds_read_b64_tr_b16 a[48:49], v8 offset:0
  ds_read_b64_tr_b16 a[50:51], v8 offset:512
  ds_read_b64_tr_b16 a[52:53], v8 offset:12288
  ds_read_b64_tr_b16 a[54:55], v8 offset:12800
  ds_read_b64_tr_b16 a[56:57], v8 offset:24576
  ds_read_b64_tr_b16 a[58:59], v8 offset:25088
  ds_read_b64_tr_b16 a[60:61], v8 offset:36864
  ds_read_b64_tr_b16 a[62:63], v8 offset:37376
  ds_read_b64_tr_b16 a[128:129], v9 offset:0
  ds_read_b64_tr_b16 a[130:131], v9 offset:512
  ds_read_b64_tr_b16 a[132:133], v9 offset:12288
  ds_read_b64_tr_b16 a[134:135], v9 offset:12800
  ds_read_b64_tr_b16 a[136:137], v9 offset:24576
  ds_read_b64_tr_b16 a[138:139], v9 offset:25088
  ds_read_b64_tr_b16 a[140:141], v9 offset:36864
  ds_read_b64_tr_b16 a[142:143], v9 offset:37376
  ds_read_b64_tr_b16 a[208:209], v10 offset:0
  ds_read_b64_tr_b16 a[210:211], v10 offset:512
  ds_read_b64_tr_b16 a[212:213], v10 offset:12288
  ds_read_b64_tr_b16 a[214:215], v10 offset:12800
  ds_read_b64_tr_b16 a[216:217], v10 offset:24576
  ds_read_b64_tr_b16 a[218:219], v10 offset:25088
  ds_read_b64_tr_b16 a[220:221], v10 offset:36864
  ds_read_b64_tr_b16 a[222:223], v10 offset:37376
  s_waitcnt lgkmcnt(0)
  s_waitcnt vmcnt(0)
  s_barrier
  v_add_u32 v8, 49152, v3
  v_add_u32 v9, 49152, v4
  v_add_u32 v10, 49152, v5
  ds_read_b64_tr_b16 a[64:65], v8 offset:0
  ds_read_b64_tr_b16 a[66:67], v8 offset:512
  ds_read_b64_tr_b16 a[68:69], v8 offset:12288
  ds_read_b64_tr_b16 a[70:71], v8 offset:12800
  ds_read_b64_tr_b16 a[72:73], v8 offset:24576
  ds_read_b64_tr_b16 a[74:75], v8 offset:25088
  ds_read_b64_tr_b16 a[76:77], v8 offset:36864
  ds_read_b64_tr_b16 a[78:79], v8 offset:37376
  ds_read_b64_tr_b16 a[144:145], v9 offset:0
  ds_read_b64_tr_b16 a[146:147], v9 offset:512
  ds_read_b64_tr_b16 a[148:149], v9 offset:12288
  ds_read_b64_tr_b16 a[150:151], v9 offset:12800
  ds_read_b64_tr_b16 a[152:153], v9 offset:24576
  ds_read_b64_tr_b16 a[154:155], v9 offset:25088
  ds_read_b64_tr_b16 a[156:157], v9 offset:36864
  ds_read_b64_tr_b16 a[158:159], v9 offset:37376
  ds_read_b64_tr_b16 a[224:225], v10 offset:0
  ds_read_b64_tr_b16 a[226:227], v10 offset:512
  ds_read_b64_tr_b16 a[228:229], v10 offset:12288
  ds_read_b64_tr_b16 a[230:231], v10 offset:12800
  ds_read_b64_tr_b16 a[232:233], v10 offset:24576
  ds_read_b64_tr_b16 a[234:235], v10 offset:25088
  ds_read_b64_tr_b16 a[236:237], v10 offset:36864
  ds_read_b64_tr_b16 a[238:239], v10 offset:37376
  s_waitcnt lgkmcnt(0)
  s_cmp_eq_u32 s16, 0
  s_cbranch_scc0 DC_66
  s_mov_b32 s22, 0
DC_64:
  s_waitcnt vmcnt(0)
  v_readfirstlane_b32 s20, v16
  v_readfirstlane_b32 s21, v17
  s_cmp_lg_u32 s20, 0
  s_cbranch_scc1 DC_65
DC_67:
  s_add_u32 s22, s22, 1
  s_cmp_gt_u32 s22, 200000
  s_cbranch_scc1 DC_65
  s_sleep 16
  buffer_load_dwordx2 v[16:17], off, s[48:51], 0 offset:8 sc1
  s_branch DC_64
DC_65:
  s_and_b32 s21, s21, 8192
  v_mov_b32 v16, s21
  v_mov_b32 v17, 163824
  ds_write_b32 v17, v16
  s_waitcnt lgkmcnt(0)
DC_66:
  s_barrier
  v_mov_b32 v17, 163824
  ds_read_b32 v16, v17
  s_waitcnt lgkmcnt(0)
  v_readfirstlane_b32 s52, v16
  s_branch T1_main
T1_ffn_w:
  v_lshrrev_b32 v8, 4, v1
  v_lshlrev_b32 v8, 3, v8
  s_mul_i32 s21, s16, 96
  s_add_u32 s21, s21, s24
  buffer_load_dwordx2 v[10:11], v8, s[12:15], s21 offen offset:0
  buffer_load_dwordx2 v[12:13], v8, s[12:15], s21 offen offset:32
  buffer_load_dwordx2 v[14:15], v8, s[12:15], s21 offen offset:64
  s_waitcnt vmcnt(0)
  v_lshlrev_b32 v100, 16, v10
  v_and_b32 v101, 0xffff0000, v10
  v_lshlrev_b32 v102, 16, v11
  v_and_b32 v103, 0xffff0000, v11
  v_lshlrev_b32 v104, 16, v12
  v_and_b32 v105, 0xffff0000, v12
  v_lshlrev_b32 v106, 16, v13
  v_and_b32 v107, 0xffff0000, v13
  v_lshlrev_b32 v108, 16, v14
  v_and_b32 v109, 0xffff0000, v14
  v_lshlrev_b32 v110, 16, v15
  v_and_b32 v111, 0xffff0000, v15
  v_lshrrev_b32 v8, 3, v1
  s_lshl_b32 s20, s16, 3
  v_add_u32 v8, s20, v8
  v_mul_u32_u24 v8, 3072, v8
  v_and_b32 v9, 7, v1
  s_lshl_b32 s20, s16, 1
  v_xor_b32 v9, s20, v9
  v_lshl_add_u32 v2, v9, 4, v8
  v_lshrrev_b32 v8, 4, v1
  v_mul_u32_u24 v9, 3072, v8
  v_bfe_u32 v10, v1, 2, 2
  v_lshl_add_u32 v9, v10, 7, v9
  v_and_b32 v10, 3, v1
  v_lshl_add_u32 v9, v10, 3, v9
  s_mul_i32 s20, s16, 3
  s_add_u32 s20, s20, 0
  s_and_b32 s21, s20, 3
  s_lshr_b32 s20, s20, 2
  s_lshl_b32 s20, s20, 10
  v_xor_b32 v10, s21, v8
  v_lshl_add_u32 v10, v10, 5, v9
  v_add_u32 v3, s20, v10
  s_mul_i32 s20, s16, 3
  s_add_u32 s20, s20, 1
  s_and_b32 s21, s20, 3
  s_lshr_b32 s20, s20, 2
  s_lshl_b32 s20, s20, 10
  v_xor_b32 v10, s21, v8
  v_lshl_add_u32 v10, v10, 5, v9
  v_add_u32 v4, s20, v10
  s_mul_i32 s20, s16, 3
  s_add_u32 s20, s20, 2
  s_and_b32 s21, s20, 3
  s_lshr_b32 s20, s20, 2
  s_lshl_b32 s20, s20, 10
  v_xor_b32 v10, s21, v8
  v_lshl_add_u32 v10, v10, 5, v9
  v_add_u32 v5, s20, v10
  s_mul_i32 s27, s16, 3072
  s_add_u32 m0, s27, 0
  s_add_u32 s26, s24, 0
  buffer_load_dwordx4 v2, s[8:11], s26 offen lds
  s_add_u32 m0, s27, 1024
  s_add_u32 s26, s24, 128
  buffer_load_dwordx4 v2, s[8:11], s26 offen lds
  s_add_u32 m0, s27, 2048
  s_add_u32 s26, s24, 256
  buffer_load_dwordx4 v2, s[8:11], s26 offen lds
  s_add_u32 m0, s27, 12288
  s_add_u32 s26, s24, 98304
  buffer_load_dwordx4 v2, s[8:11], s26 offen lds
  s_add_u32 m0, s27, 13312
  s_add_u32 s26, s24, 98432
  buffer_load_dwordx4 v2, s[8:11], s26 offen lds
  s_add_u32 m0, s27, 14336
  s_add_u32 s26, s24, 98560
  buffer_load_dwordx4 v2, s[8:11], s26 offen lds
  s_add_u32 m0, s27, 24576
  s_add_u32 s26, s24, 196608
  buffer_load_dwordx4 v2, s[8:11], s26 offen lds
  s_add_u32 m0, s27, 25600
  s_add_u32 s26, s24, 196736
  buffer_load_dwordx4 v2, s[8:11], s26 offen lds
  s_add_u32 m0, s27, 26624
  s_add_u32 s26, s24, 196864
  buffer_load_dwordx4 v2, s[8:11], s26 offen lds
  s_add_u32 m0, s27, 36864
  s_add_u32 s26, s24, 294912
  buffer_load_dwordx4 v2, s[8:11], s26 offen lds
  s_add_u32 m0, s27, 37888
  s_add_u32 s26, s24, 295040
  buffer_load_dwordx4 v2, s[8:11], s26 offen lds
  s_add_u32 m0, s27, 38912
  s_add_u32 s26, s24, 295168
  buffer_load_dwordx4 v2, s[8:11], s26 offen lds
  s_mul_i32 s27, s16, 3072
  s_add_u32 m0, s27, 49152
  s_add_u32 s26, s24, 393216
  buffer_load_dwordx4 v2, s[8:11], s26 offen lds
  s_add_u32 m0, s27, 50176
  s_add_u32 s26, s24, 393344
  buffer_load_dwordx4 v2, s[8:11], s26 offen lds
  s_add_u32 m0, s27, 51200
  s_add_u32 s26, s24, 393472
  buffer_load_dwordx4 v2, s[8:11], s26 offen lds
  s_add_u32 m0, s27, 61440
  s_add_u32 s26, s24, 491520
  buffer_load_dwordx4 v2, s[8:11], s26 offen lds
  s_add_u32 m0, s27, 62464
  s_add_u32 s26, s24, 491648
  buffer_load_dwordx4 v2, s[8:11], s26 offen lds
  s_add_u32 m0, s27, 63488
  s_add_u32 s26, s24, 491776
  buffer_load_dwordx4 v2, s[8:11], s26 offen lds
  s_add_u32 m0, s27, 73728
  s_add_u32 s26, s24, 589824
  buffer_load_dwordx4 v2, s[8:11], s26 offen lds
  s_add_u32 m0, s27, 74752
  s_add_u32 s26, s24, 589952
  buffer_load_dwordx4 v2, s[8:11], s26 offen lds
  s_add_u32 m0, s27, 75776
  s_add_u32 s26, s24, 590080
  buffer_load_dwordx4 v2, s[8:11], s26 offen lds
  s_add_u32 m0, s27, 86016
  s_add_u32 s26, s24, 688128
  buffer_load_dwordx4 v2, s[8:11], s26 offen lds
  s_add_u32 m0, s27, 87040
  s_add_u32 s26, s24, 688256
  buffer_load_dwordx4 v2, s[8:11], s26 offen lds
  s_add_u32 m0, s27, 88064
  s_add_u32 s26, s24, 688384
  buffer_load_dwordx4 v2, s[8:11], s26 offen lds
  s_mul_i32 s27, s16, 3072
  s_add_u32 m0, s27, 98304
  s_add_u32 s26, s24, 786432
  buffer_load_dwordx4 v2, s[8:11], s26 offen lds
  s_add_u32 m0, s27, 99328
  s_add_u32 s26, s24, 786560
  buffer_load_dwordx4 v2, s[8:11], s26 offen lds
  s_add_u32 m0, s27, 100352
  s_add_u32 s26, s24, 786688
  buffer_load_dwordx4 v2, s[8:11], s26 offen lds
  s_add_u32 m0, s27, 110592
  s_add_u32 s26, s24, 884736
  buffer_load_dwordx4 v2, s[8:11], s26 offen lds
  s_add_u32 m0, s27, 111616
  s_add_u32 s26, s24, 884864
  buffer_load_dwordx4 v2, s[8:11], s26 offen lds
  s_add_u32 m0, s27, 112640
  s_add_u32 s26, s24, 884992
  buffer_load_dwordx4 v2, s[8:11], s26 offen lds
  s_add_u32 m0, s27, 122880
  s_add_u32 s26, s24, 983040
  buffer_load_dwordx4 v2, s[8:11], s26 offen lds
  s_add_u32 m0, s27, 123904
  s_add_u32 s26, s24, 983168
  buffer_load_dwordx4 v2, s[8:11], s26 offen lds
  s_add_u32 m0, s27, 124928
  s_add_u32 s26, s24, 983296
  buffer_load_dwordx4 v2, s[8:11], s26 offen lds
  s_add_u32 m0, s27, 135168
  s_add_u32 s26, s24, 1081344
  buffer_load_dwordx4 v2, s[8:11], s26 offen lds
  s_add_u32 m0, s27, 136192
  s_add_u32 s26, s24, 1081472
  buffer_load_dwordx4 v2, s[8:11], s26 offen lds
  s_add_u32 m0, s27, 137216
  s_add_u32 s26, s24, 1081600
  buffer_load_dwordx4 v2, s[8:11], s26 offen lds
  s_waitcnt vmcnt(24)
  s_barrier
  v_add_u32 v8, 0, v3
  v_add_u32 v9, 0, v4
  v_add_u32 v10, 0, v5
  ds_read_b64_tr_b16 a[0:1], v8 offset:0
  ds_read_b64_tr_b16 a[2:3], v8 offset:512
  ds_read_b64_tr_b16 a[4:5], v8 offset:12288
  ds_read_b64_tr_b16 a[6:7], v8 offset:12800
  ds_read_b64_tr_b16 a[8:9], v8 offset:24576
  ds_read_b64_tr_b16 a[10:11], v8 offset:25088
  ds_read_b64_tr_b16 a[12:13], v8 offset:36864
  ds_read_b64_tr_b16 a[14:15], v8 offset:37376
  ds_read_b64_tr_b16 a[80:81], v9 offset:0
  ds_read_b64_tr_b16 a[82:83], v9 offset:512
  ds_read_b64_tr_b16 a[84:85], v9 offset:12288
  ds_read_b64_tr_b16 a[86:87], v9 offset:12800
  ds_read_b64_tr_b16 a[88:89], v9 offset:24576
  ds_read_b64_tr_b16 a[90:91], v9 offset:25088
  ds_read_b64_tr_b16 a[92:93], v9 offset:36864
  ds_read_b64_tr_b16 a[94:95], v9 offset:37376
  ds_read_b64_tr_b16 a[160:161], v10 offset:0
  ds_read_b64_tr_b16 a[162:163], v10 offset:512
  ds_read_b64_tr_b16 a[164:165], v10 offset:12288
  ds_read_b64_tr_b16 a[166:167], v10 offset:12800
  ds_read_b64_tr_b16 a[168:169], v10 offset:24576
  ds_read_b64_tr_b16 a[170:171], v10 offset:25088
  ds_read_b64_tr_b16 a[172:173], v10 offset:36864
  ds_read_b64_tr_b16 a[174:175], v10 offset:37376
  s_waitcnt lgkmcnt(0)
  s_waitcnt vmcnt(12)
  s_barrier
  s_mul_i32 s27, s16, 3072
  s_add_u32 m0, s27, 0
  s_add_u32 s26, s24, 1179648
  buffer_load_dwordx4 v2, s[8:11], s26 offen lds
  s_add_u32 m0, s27, 1024
  s_add_u32 s26, s24, 1179776
  buffer_load_dwordx4 v2, s[8:11], s26 offen lds
  s_add_u32 m0, s27, 2048
  s_add_u32 s26, s24, 1179904
  buffer_load_dwordx4 v2, s[8:11], s26 offen lds
  s_add_u32 m0, s27, 12288
  s_add_u32 s26, s24, 1277952
  buffer_load_dwordx4 v2, s[8:11], s26 offen lds
  s_add_u32 m0, s27, 13312
  s_add_u32 s26, s24, 1278080
  buffer_load_dwordx4 v2, s[8:11], s26 offen lds
  s_add_u32 m0, s27, 14336
  s_add_u32 s26, s24, 1278208
  buffer_load_dwordx4 v2, s[8:11], s26 offen lds
  s_add_u32 m0, s27, 24576
  s_add_u32 s26, s24, 1376256
  buffer_load_dwordx4 v2, s[8:11], s26 offen lds
  s_add_u32 m0, s27, 25600
  s_add_u32 s26, s24, 1376384
  buffer_load_dwordx4 v2, s[8:11], s26 offen lds
  s_add_u32 m0, s27, 26624
  s_add_u32 s26, s24, 1376512
  buffer_load_dwordx4 v2, s[8:11], s26 offen lds
  s_add_u32 m0, s27, 36864
  s_add_u32 s26, s24, 1474560
  buffer_load_dwordx4 v2, s[8:11], s26 offen lds
  s_add_u32 m0, s27, 37888
  s_add_u32 s26, s24, 1474688
  buffer_load_dwordx4 v2, s[8:11], s26 offen lds
  s_add_u32 m0, s27, 38912
  s_add_u32 s26, s24, 1474816
  buffer_load_dwordx4 v2, s[8:11], s26 offen lds
  v_add_u32 v8, 49152, v3
  v_add_u32 v9, 49152, v4
  v_add_u32 v10, 49152, v5
  ds_read_b64_tr_b16 a[16:17], v8 offset:0
  ds_read_b64_tr_b16 a[18:19], v8 offset:512
  ds_read_b64_tr_b16 a[20:21], v8 offset:12288
  ds_read_b64_tr_b16 a[22:23], v8 offset:12800
  ds_read_b64_tr_b16 a[24:25], v8 offset:24576
  ds_read_b64_tr_b16 a[26:27], v8 offset:25088
  ds_read_b64_tr_b16 a[28:29], v8 offset:36864
  ds_read_b64_tr_b16 a[30:31], v8 offset:37376
  ds_read_b64_tr_b16 a[96:97], v9 offset:0
  ds_read_b64_tr_b16 a[98:99], v9 offset:512
  ds_read_b64_tr_b16 a[100:101], v9 offset:12288
  ds_read_b64_tr_b16 a[102:103], v9 offset:12800
  ds_read_b64_tr_b16 a[104:105], v9 offset:24576
  ds_read_b64_tr_b16 a[106:107], v9 offset:25088
  ds_read_b64_tr_b16 a[108:109], v9 offset:36864
  ds_read_b64_tr_b16 a[110:111], v9 offset:37376
  ds_read_b64_tr_b16 a[176:177], v10 offset:0
  ds_read_b64_tr_b16 a[178:179], v10 offset:512
  ds_read_b64_tr_b16 a[180:181], v10 offset:12288
  ds_read_b64_tr_b16 a[182:183], v10 offset:12800
  ds_read_b64_tr_b16 a[184:185], v10 offset:24576
  ds_read_b64_tr_b16 a[186:187], v10 offset:25088
  ds_read_b64_tr_b16 a[188:189], v10 offset:36864
  ds_read_b64_tr_b16 a[190:191], v10 offset:37376
  s_waitcnt lgkmcnt(0)
  s_waitcnt vmcnt(12)
  s_barrier
  s_mul_i32 s27, s16, 3072
  s_add_u32 m0, s27, 49152
  s_add_u32 s26, s24, 1572864
  buffer_load_dwordx4 v2, s[8:11], s26 offen lds
  s_add_u32 m0, s27, 50176
  s_add_u32 s26, s24, 1572992
  buffer_load_dwordx4 v2, s[8:11], s26 offen lds
  s_add_u32 m0, s27, 51200
  s_add_u32 s26, s24, 1573120
  buffer_load_dwordx4 v2, s[8:11], s26 offen lds
  s_add_u32 m0, s27, 61440
  s_add_u32 s26, s24, 1671168
  buffer_load_dwordx4 v2, s[8:11], s26 offen lds
  s_add_u32 m0, s27, 62464
  s_add_u32 s26, s24, 1671296
  buffer_load_dwordx4 v2, s[8:11], s26 offen lds
  s_add_u32 m0, s27, 63488
  s_add_u32 s26, s24, 1671424
  buffer_load_dwordx4 v2, s[8:11], s26 offen lds
  s_add_u32 m0, s27, 73728
  s_add_u32 s26, s24, 1769472
  buffer_load_dwordx4 v2, s[8:11], s26 offen lds
  s_add_u32 m0, s27, 74752
  s_add_u32 s26, s24, 1769600
  buffer_load_dwordx4 v2, s[8:11], s26 offen lds
  s_add_u32 m0, s27, 75776
  s_add_u32 s26, s24, 1769728
  buffer_load_dwordx4 v2, s[8:11], s26 offen lds
  s_add_u32 m0, s27, 86016
  s_add_u32 s26, s24, 1867776
  buffer_load_dwordx4 v2, s[8:11], s26 offen lds
  s_add_u32 m0, s27, 87040
  s_add_u32 s26, s24, 1867904
  buffer_load_dwordx4 v2, s[8:11], s26 offen lds
  s_add_u32 m0, s27, 88064
  s_add_u32 s26, s24, 1868032
  buffer_load_dwordx4 v2, s[8:11], s26 offen lds
  s_cmp_eq_u32 s16, 0
  s_cbranch_scc0 DI_68
  buffer_load_dwordx2 v[16:17], off, s[48:51], 0 offset:8 sc1
DI_68:
  v_add_u32 v8, 98304, v3
  v_add_u32 v9, 98304, v4
  v_add_u32 v10, 98304, v5
  ds_read_b64_tr_b16 a[32:33], v8 offset:0
  ds_read_b64_tr_b16 a[34:35], v8 offset:512
  ds_read_b64_tr_b16 a[36:37], v8 offset:12288
  ds_read_b64_tr_b16 a[38:39], v8 offset:12800
  ds_read_b64_tr_b16 a[40:41], v8 offset:24576
  ds_read_b64_tr_b16 a[42:43], v8 offset:25088
  ds_read_b64_tr_b16 a[44:45], v8 offset:36864
  ds_read_b64_tr_b16 a[46:47], v8 offset:37376
  ds_read_b64_tr_b16 a[112:113], v9 offset:0
  ds_read_b64_tr_b16 a[114:115], v9 offset:512
  ds_read_b64_tr_b16 a[116:117], v9 offset:12288
  ds_read_b64_tr_b16 a[118:119], v9 offset:12800
  ds_read_b64_tr_b16 a[120:121], v9 offset:24576
  ds_read_b64_tr_b16 a[122:123], v9 offset:25088
  ds_read_b64_tr_b16 a[124:125], v9 offset:36864
  ds_read_b64_tr_b16 a[126:127], v9 offset:37376
  ds_read_b64_tr_b16 a[192:193], v10 offset:0
  ds_read_b64_tr_b16 a[194:195], v10 offset:512
  ds_read_b64_tr_b16 a[196:197], v10 offset:12288
  ds_read_b64_tr_b16 a[198:199], v10 offset:12800
  ds_read_b64_tr_b16 a[200:201], v10 offset:24576
  ds_read_b64_tr_b16 a[202:203], v10 offset:25088
  ds_read_b64_tr_b16 a[204:205], v10 offset:36864
  ds_read_b64_tr_b16 a[206:207], v10 offset:37376
  s_waitcnt lgkmcnt(0)
  s_waitcnt vmcnt(12)
  s_barrier
  v_add_u32 v8, 0, v3
  v_add_u32 v9, 0, v4
  v_add_u32 v10, 0, v5
  ds_read_b64_tr_b16 a[48:49], v8 offset:0
  ds_read_b64_tr_b16 a[50:51], v8 offset:512
  ds_read_b64_tr_b16 a[52:53], v8 offset:12288
  ds_read_b64_tr_b16 a[54:55], v8 offset:12800
  ds_read_b64_tr_b16 a[56:57], v8 offset:24576
  ds_read_b64_tr_b16 a[58:59], v8 offset:25088
  ds_read_b64_tr_b16 a[60:61], v8 offset:36864
  ds_read_b64_tr_b16 a[62:63], v8 offset:37376
  ds_read_b64_tr_b16 a[128:129], v9 offset:0
  ds_read_b64_tr_b16 a[130:131], v9 offset:512
  ds_read_b64_tr_b16 a[132:133], v9 offset:12288
  ds_read_b64_tr_b16 a[134:135], v9 offset:12800
  ds_read_b64_tr_b16 a[136:137], v9 offset:24576
  ds_read_b64_tr_b16 a[138:139], v9 offset:25088
  ds_read_b64_tr_b16 a[140:141], v9 offset:36864
  ds_read_b64_tr_b16 a[142:143], v9 offset:37376
  ds_read_b64_tr_b16 a[208:209], v10 offset:0
  ds_read_b64_tr_b16 a[210:211], v10 offset:512
  ds_read_b64_tr_b16 a[212:213], v10 offset:12288
  ds_read_b64_tr_b16 a[214:215], v10 offset:12800
  ds_read_b64_tr_b16 a[216:217], v10 offset:24576
  ds_read_b64_tr_b16 a[218:219], v10 offset:25088
  ds_read_b64_tr_b16 a[220:221], v10 offset:36864
  ds_read_b64_tr_b16 a[222:223], v10 offset:37376
  s_waitcnt lgkmcnt(0)
  s_waitcnt vmcnt(0)
  s_barrier
  v_add_u32 v8, 49152, v3
  v_add_u32 v9, 49152, v4
  v_add_u32 v10, 49152, v5
  ds_read_b64_tr_b16 a[64:65], v8 offset:0
  ds_read_b64_tr_b16 a[66:67], v8 offset:512
  ds_read_b64_tr_b16 a[68:69], v8 offset:12288
  ds_read_b64_tr_b16 a[70:71], v8 offset:12800
  ds_read_b64_tr_b16 a[72:73], v8 offset:24576
  ds_read_b64_tr_b16 a[74:75], v8 offset:25088
  ds_read_b64_tr_b16 a[76:77], v8 offset:36864
  ds_read_b64_tr_b16 a[78:79], v8 offset:37376
  ds_read_b64_tr_b16 a[144:145], v9 offset:0
  ds_read_b64_tr_b16 a[146:147], v9 offset:512
  ds_read_b64_tr_b16 a[148:149], v9 offset:12288
  ds_read_b64_tr_b16 a[150:151], v9 offset:12800
  ds_read_b64_tr_b16 a[152:153], v9 offset:24576
  ds_read_b64_tr_b16 a[154:155], v9 offset:25088
  ds_read_b64_tr_b16 a[156:157], v9 offset:36864
  ds_read_b64_tr_b16 a[158:159], v9 offset:37376
  ds_read_b64_tr_b16 a[224:225], v10 offset:0
  ds_read_b64_tr_b16 a[226:227], v10 offset:512
  ds_read_b64_tr_b16 a[228:229], v10 offset:12288
  ds_read_b64_tr_b16 a[230:231], v10 offset:12800
  ds_read_b64_tr_b16 a[232:233], v10 offset:24576
  ds_read_b64_tr_b16 a[234:235], v10 offset:25088
  ds_read_b64_tr_b16 a[236:237], v10 offset:36864
  ds_read_b64_tr_b16 a[238:239], v10 offset:37376
  s_waitcnt lgkmcnt(0)
  s_cmp_eq_u32 s16, 0
  s_cbranch_scc0 DC_71
  s_mov_b32 s22, 0
DC_69:
  s_waitcnt vmcnt(0)
  v_readfirstlane_b32 s20, v16
  v_readfirstlane_b32 s21, v17
  s_cmp_lg_u32 s20, 0
  s_cbranch_scc1 DC_70
DC_72:
  s_add_u32 s22, s22, 1
  s_cmp_gt_u32 s22, 200000
  s_cbranch_scc1 DC_70
  s_sleep 16
  buffer_load_dwordx2 v[16:17], off, s[48:51], 0 offset:8 sc1
  s_branch DC_69
DC_70:
  s_and_b32 s21, s21, 8192
  v_mov_b32 v16, s21
  v_mov_b32 v17, 163824
  ds_write_b32 v17, v16
  s_waitcnt lgkmcnt(0)
DC_71:
  s_barrier
  v_mov_b32 v17, 163824
  ds_read_b32 v16, v17
  s_waitcnt lgkmcnt(0)
  v_readfirstlane_b32 s52, v16
T1_main:
  v_lshlrev_b32 v6, 4, v1
  s_mul_i32 s20, s16, 10240
  v_add_u32 v2, s20, v6
  v_lshrrev_b32 v7, 5, v1
  v_lshlrev_b32 v4, 8, v7
  v_and_b32 v7, 15, v1
  v_lshl_add_u32 v4, v7, 4, v4
  v_bfe_u32 v7, v1, 4, 1
  v_lshl_add_u32 v4, v7, 3, v4
  s_mul_i32 s21, s16, 1536
  v_add_u32 v4, s21, v4
  s_mov_b32 s25, s20
  s_mov_b32 s26, 3145728
  s_mov_b32 s27, 0
  s_mul_i32 s28, s17, 786432
  s_add_u32 s28, s28, 33554432
  s_lshl_b32 s29, s17, 7
  s_lshl_b32 s20, s16, 2
  s_add_u32 s29, s29, s20
  s_add_u32 s29, s29, 0
  s_mov_b32 s30, 0
  s_mov_b32 s31, 0
  v_mov_b32 v7, 0
  s_add_u32 s22, s27, s25
  s_add_u32 m0, s22, 0
  s_add_u32 s21, s26, 0
  buffer_load_dwordx4 v2, s[4:7], s21 offen offset:0 lds
  buffer_load_dwordx4 v2, s[4:7], s21 offen offset:1024 lds
  buffer_load_dwordx4 v2, s[4:7], s21 offen offset:2048 lds
  buffer_load_dwordx4 v2, s[4:7], s21 offen offset:3072 lds
  s_add_u32 m0, s22, 4096
  s_add_u32 s21, s26, 4096
  buffer_load_dwordx4 v2, s[4:7], s21 offen offset:0 lds
  buffer_load_dwordx4 v2, s[4:7], s21 offen offset:1024 lds
  buffer_load_dwordx4 v2, s[4:7], s21 offen offset:2048 lds
  buffer_load_dwordx4 v2, s[4:7], s21 offen offset:3072 lds
  s_add_u32 m0, s22, 8192
  s_add_u32 s21, s26, 8192
  buffer_load_dwordx4 v2, s[4:7], s21 offen offset:0 lds
  buffer_load_dwordx4 v2, s[4:7], s21 offen offset:1024 lds
  s_add_u32 s26, s26, 40960
  s_add_u32 s27, s27, 40960
  s_cmp_eq_u32 s27, 122880
  s_cselect_b32 s27, 0, s27
  s_add_u32 s22, s27, s25
  s_add_u32 m0, s22, 0
  s_add_u32 s21, s26, 0
  buffer_load_dwordx4 v2, s[4:7], s21 offen offset:0 lds
  buffer_load_dwordx4 v2, s[4:7], s21 offen offset:1024 lds
  buffer_load_dwordx4 v2, s[4:7], s21 offen offset:2048 lds
  buffer_load_dwordx4 v2, s[4:7], s21 offen offset:3072 lds
  s_add_u32 m0, s22, 4096
  s_add_u32 s21, s26, 4096
  buffer_load_dwordx4 v2, s[4:7], s21 offen offset:0 lds
  buffer_load_dwordx4 v2, s[4:7], s21 offen offset:1024 lds
  buffer_load_dwordx4 v2, s[4:7], s21 offen offset:2048 lds
  buffer_load_dwordx4 v2, s[4:7], s21 offen offset:3072 lds
  s_add_u32 m0, s22, 8192
  s_add_u32 s21, s26, 8192
  buffer_load_dwordx4 v2, s[4:7], s21 offen offset:0 lds
  buffer_load_dwordx4 v2, s[4:7], s21 offen offset:1024 lds
  s_add_u32 s26, s26, 40960
  s_add_u32 s27, s27, 40960
  s_cmp_eq_u32 s27, 122880
  s_cselect_b32 s27, 0, s27
  s_waitcnt vmcnt(10)
T1_loop:
  s_barrier
  v_add_u32 v3, s31, v6
  ds_read_b128 v[40:43], v3 offset:0
  ds_read_b128 v[44:47], v3 offset:20480
  ds_read_b128 v[48:51], v3 offset:1024
  ds_read_b128 v[52:55], v3 offset:21504
  s_add_u32 s22, s27, s25
  ds_read_b128 v[56:59], v3 offset:2048
  s_waitcnt lgkmcnt(4)
  v_mfma_f32_16x16x32_bf16 v[16:19], a[0:3], v[40:43], v[100:103]
  s_add_u32 m0, s22, 0
  s_add_u32 s21, s26, 0
  buffer_load_dwordx4 v2, s[4:7], s21 offen offset:0 lds
  v_mfma_f32_16x16x32_bf16 v[24:27], a[80:83], v[40:43], v[104:107]
  v_mfma_f32_16x16x32_bf16 v[32:35], a[160:163], v[40:43], v[108:111]
  ds_read_b128 v[60:63], v3 offset:22528
  s_waitcnt lgkmcnt(4)
  v_mfma_f32_16x16x32_bf16 v[20:23], a[0:3], v[44:47], v[100:103]
  v_mfma_f32_16x16x32_bf16 v[28:31], a[80:83], v[44:47], v[104:107]
  v_mfma_f32_16x16x32_bf16 v[36:39], a[160:163], v[44:47], v[108:111]
  ds_read_b128 v[40:43], v3 offset:3072
  s_waitcnt lgkmcnt(4)
  v_mfma_f32_16x16x32_bf16 v[16:19], a[4:7], v[48:51], v[16:19]
  buffer_load_dwordx4 v2, s[4:7], s21 offen offset:1024 lds
  v_mfma_f32_16x16x32_bf16 v[24:27], a[84:87], v[48:51], v[24:27]
  v_mfma_f32_16x16x32_bf16 v[32:35], a[164:167], v[48:51], v[32:35]
  ds_read_b128 v[44:47], v3 offset:23552
  s_waitcnt lgkmcnt(4)
  v_mfma_f32_16x16x32_bf16 v[20:23], a[4:7], v[52:55], v[20:23]
  v_mfma_f32_16x16x32_bf16 v[28:31], a[84:87], v[52:55], v[28:31]
  v_mfma_f32_16x16x32_bf16 v[36:39], a[164:167], v[52:55], v[36:39]
  ds_read_b128 v[48:51], v3 offset:4096
  s_waitcnt lgkmcnt(4)
  v_mfma_f32_16x16x32_bf16 v[16:19], a[8:11], v[56:59], v[16:19]
  buffer_load_dwordx4 v2, s[4:7], s21 offen offset:2048 lds
  v_mfma_f32_16x16x32_bf16 v[24:27], a[88:91], v[56:59], v[24:27]
  v_mfma_f32_16x16x32_bf16 v[32:35], a[168:171], v[56:59], v[32:35]
  ds_read_b128 v[52:55], v3 offset:24576
  s_waitcnt lgkmcnt(4)
  v_mfma_f32_16x16x32_bf16 v[20:23], a[8:11], v[60:63], v[20:23]
  v_mfma_f32_16x16x32_bf16 v[28:31], a[88:91], v[60:63], v[28:31]
  v_mfma_f32_16x16x32_bf16 v[36:39], a[168:171], v[60:63], v[36:39]
  ds_read_b128 v[56:59], v3 offset:5120
  s_waitcnt lgkmcnt(4)
  v_mfma_f32_16x16x32_bf16 v[16:19], a[12:15], v[40:43], v[16:19]
  buffer_load_dwordx4 v2, s[4:7], s21 offen offset:3072 lds
  v_mfma_f32_16x16x32_bf16 v[24:27], a[92:95], v[40:43], v[24:27]
  v_mfma_f32_16x16x32_bf16 v[32:35], a[172:175], v[40:43], v[32:35]
  ds_read_b128 v[60:63], v3 offset:25600
  s_waitcnt lgkmcnt(4)
  v_mfma_f32_16x16x32_bf16 v[20:23], a[12:15], v[44:47], v[20:23]
  v_mfma_f32_16x16x32_bf16 v[28:31], a[92:95], v[44:47], v[28:31]
  v_mfma_f32_16x16x32_bf16 v[36:39], a[172:175], v[44:47], v[36:39]
  ds_read_b128 v[40:43], v3 offset:6144
  s_waitcnt lgkmcnt(4)
  v_mfma_f32_16x16x32_bf16 v[16:19], a[16:19], v[48:51], v[16:19]
  s_add_u32 m0, s22, 4096
  s_add_u32 s21, s26, 4096
  buffer_load_dwordx4 v2, s[4:7], s21 offen offset:0 lds
  v_mfma_f32_16x16x32_bf16 v[24:27], a[96:99], v[48:51], v[24:27]
  v_mfma_f32_16x16x32_bf16 v[32:35], a[176:179], v[48:51], v[32:35]
  ds_read_b128 v[44:47], v3 offset:26624
  s_waitcnt lgkmcnt(4)
  v_mfma_f32_16x16x32_bf16 v[20:23], a[16:19], v[52:55], v[20:23]
  v_mfma_f32_16x16x32_bf16 v[28:31], a[96:99], v[52:55], v[28:31]
  v_mfma_f32_16x16x32_bf16 v[36:39], a[176:179], v[52:55], v[36:39]
  ds_read_b128 v[48:51], v3 offset:7168
  s_waitcnt lgkmcnt(4)
  v_mfma_f32_16x16x32_bf16 v[16:19], a[20:23], v[56:59], v[16:19]
  buffer_load_dwordx4 v2, s[4:7], s21 offen offset:1024 lds
  v_mfma_f32_16x16x32_bf16 v[24:27], a[100:103], v[56:59], v[24:27]
  v_mfma_f32_16x16x32_bf16 v[32:35], a[180:183], v[56:59], v[32:35]
  ds_read_b128 v[52:55], v3 offset:27648
  s_waitcnt lgkmcnt(4)
  v_mfma_f32_16x16x32_bf16 v[20:23], a[20:23], v[60:63], v[20:23]
  v_mfma_f32_16x16x32_bf16 v[28:31], a[100:103], v[60:63], v[28:31]
  v_mfma_f32_16x16x32_bf16 v[36:39], a[180:183], v[60:63], v[36:39]
  ds_read_b128 v[56:59], v3 offset:8192
  s_waitcnt lgkmcnt(4)
  v_mfma_f32_16x16x32_bf16 v[16:19], a[24:27], v[40:43], v[16:19]
  buffer_load_dwordx4 v2, s[4:7], s21 offen offset:2048 lds
  v_mfma_f32_16x16x32_bf16 v[24:27], a[104:107], v[40:43], v[24:27]
  v_mfma_f32_16x16x32_bf16 v[32:35], a[184:187], v[40:43], v[32:35]
  ds_read_b128 v[60:63], v3 offset:28672
  s_waitcnt lgkmcnt(4)
  v_mfma_f32_16x16x32_bf16 v[20:23], a[24:27], v[44:47], v[20:23]
  v_mfma_f32_16x16x32_bf16 v[28:31], a[104:107], v[44:47], v[28:31]
  v_mfma_f32_16x16x32_bf16 v[36:39], a[184:187], v[44:47], v[36:39]
  ds_read_b128 v[40:43], v3 offset:9216
  s_waitcnt lgkmcnt(4)
  v_mfma_f32_16x16x32_bf16 v[16:19], a[28:31], v[48:51], v[16:19]
  buffer_load_dwordx4 v2, s[4:7], s21 offen offset:3072 lds
  v_mfma_f32_16x16x32_bf16 v[24:27], a[108:111], v[48:51], v[24:27]
  v_mfma_f32_16x16x32_bf16 v[32:35], a[188:191], v[48:51], v[32:35]
  ds_read_b128 v[44:47], v3 offset:29696
  s_waitcnt lgkmcnt(4)
  v_mfma_f32_16x16x32_bf16 v[20:23], a[28:31], v[52:55], v[20:23]
  v_mfma_f32_16x16x32_bf16 v[28:31], a[108:111], v[52:55], v[28:31]
  v_mfma_f32_16x16x32_bf16 v[36:39], a[188:191], v[52:55], v[36:39]
  ds_read_b128 v[48:51], v3 offset:10240
  s_waitcnt lgkmcnt(4)
  v_mfma_f32_16x16x32_bf16 v[16:19], a[32:35], v[56:59], v[16:19]
  s_add_u32 m0, s22, 8192
  s_add_u32 s21, s26, 8192
  buffer_load_dwordx4 v2, s[4:7], s21 offen offset:0 lds
  v_mfma_f32_16x16x32_bf16 v[24:27], a[112:115], v[56:59], v[24:27]
  v_mfma_f32_16x16x32_bf16 v[32:35], a[192:195], v[56:59], v[32:35]
  ds_read_b128 v[52:55], v3 offset:30720
  s_waitcnt lgkmcnt(4)
  v_mfma_f32_16x16x32_bf16 v[20:23], a[32:35], v[60:63], v[20:23]
  v_mfma_f32_16x16x32_bf16 v[28:31], a[112:115], v[60:63], v[28:31]
  v_mfma_f32_16x16x32_bf16 v[36:39], a[192:195], v[60:63], v[36:39]
  ds_read_b128 v[56:59], v3 offset:11264
  s_waitcnt lgkmcnt(4)
  v_mfma_f32_16x16x32_bf16 v[16:19], a[36:39], v[40:43], v[16:19]
  buffer_load_dwordx4 v2, s[4:7], s21 offen offset:1024 lds
  v_mfma_f32_16x16x32_bf16 v[24:27], a[116:119], v[40:43], v[24:27]
  v_mfma_f32_16x16x32_bf16 v[32:35], a[196:199], v[40:43], v[32:35]
  ds_read_b128 v[60:63], v3 offset:31744
  s_waitcnt lgkmcnt(4)
  v_mfma_f32_16x16x32_bf16 v[20:23], a[36:39], v[44:47], v[20:23]
  v_mfma_f32_16x16x32_bf16 v[28:31], a[116:119], v[44:47], v[28:31]
  v_mfma_f32_16x16x32_bf16 v[36:39], a[196:199], v[44:47], v[36:39]
  ds_read_b128 v[40:43], v3 offset:12288
  s_waitcnt lgkmcnt(4)
  v_mfma_f32_16x16x32_bf16 v[16:19], a[40:43], v[48:51], v[16:19]
  v_mfma_f32_16x16x32_bf16 v[24:27], a[120:123], v[48:51], v[24:27]
  v_mfma_f32_16x16x32_bf16 v[32:35], a[200:203], v[48:51], v[32:35]
  ds_read_b128 v[44:47], v3 offset:32768
  s_waitcnt lgkmcnt(4)
  v_mfma_f32_16x16x32_bf16 v[20:23], a[40:43], v[52:55], v[20:23]
  v_mfma_f32_16x16x32_bf16 v[28:31], a[120:123], v[52:55], v[28:31]
  v_mfma_f32_16x16x32_bf16 v[36:39], a[200:203], v[52:55], v[36:39]
  ds_read_b128 v[48:51], v3 offset:13312
  s_waitcnt lgkmcnt(4)
  v_mfma_f32_16x16x32_bf16 v[16:19], a[44:47], v[56:59], v[16:19]
  v_mfma_f32_16x16x32_bf16 v[24:27], a[124:127], v[56:59], v[24:27]
  v_mfma_f32_16x16x32_bf16 v[32:35], a[204:207], v[56:59], v[32:35]
  ds_read_b128 v[52:55], v3 offset:33792
  s_waitcnt lgkmcnt(4)
  v_mfma_f32_16x16x32_bf16 v[20:23], a[44:47], v[60:63], v[20:23]
  v_mfma_f32_16x16x32_bf16 v[28:31], a[124:127], v[60:63], v[28:31]
  v_mfma_f32_16x16x32_bf16 v[36:39], a[204:207], v[60:63], v[36:39]
  ds_read_b128 v[56:59], v3 offset:14336
  s_waitcnt lgkmcnt(4)
  v_mfma_f32_16x16x32_bf16 v[16:19], a[48:51], v[40:43], v[16:19]
  v_mfma_f32_16x16x32_bf16 v[24:27], a[128:131], v[40:43], v[24:27]
  v_mfma_f32_16x16x32_bf16 v[32:35], a[208:211], v[40:43], v[32:35]
  ds_read_b128 v[60:63], v3 offset:34816
  s_waitcnt lgkmcnt(4)
  v_mfma_f32_16x16x32_bf16 v[20:23], a[48:51], v[44:47], v[20:23]
  v_mfma_f32_16x16x32_bf16 v[28:31], a[128:131], v[44:47], v[28:31]
  v_mfma_f32_16x16x32_bf16 v[36:39], a[208:211], v[44:47], v[36:39]
  ds_read_b128 v[40:43], v3 offset:15360
  s_waitcnt lgkmcnt(4)
  v_mfma_f32_16x16x32_bf16 v[16:19], a[52:55], v[48:51], v[16:19]
  v_mfma_f32_16x16x32_bf16 v[24:27], a[132:135], v[48:51], v[24:27]
  v_mfma_f32_16x16x32_bf16 v[32:35], a[212:215], v[48:51], v[32:35]
  s_add_u32 s26, s26, 40960
  s_add_u32 s27, s27, 40960
  s_cmp_eq_u32 s27, 122880
  s_cselect_b32 s27, 0, s27
  s_waitcnt vmcnt(10)
  v_mov_b32 v5, s30
  buffer_store_dword v5, v7, s[4:7], s29 offen sc1
  ds_read_b128 v[44:47], v3 offset:35840
  s_waitcnt lgkmcnt(4)
  v_mfma_f32_16x16x32_bf16 v[20:23], a[52:55], v[52:55], v[20:23]
  v_mfma_f32_16x16x32_bf16 v[28:31], a[132:135], v[52:55], v[28:31]
  v_mfma_f32_16x16x32_bf16 v[36:39], a[212:215], v[52:55], v[36:39]
  ds_read_b128 v[48:51], v3 offset:16384
  s_waitcnt lgkmcnt(4)
  v_mfma_f32_16x16x32_bf16 v[16:19], a[56:59], v[56:59], v[16:19]
  v_mfma_f32_16x16x32_bf16 v[24:27], a[136:139], v[56:59], v[24:27]
  v_mfma_f32_16x16x32_bf16 v[32:35], a[216:219], v[56:59], v[32:35]
  ds_read_b128 v[52:55], v3 offset:36864
  s_waitcnt lgkmcnt(4)
  v_mfma_f32_16x16x32_bf16 v[20:23], a[56:59], v[60:63], v[20:23]
  v_mfma_f32_16x16x32_bf16 v[28:31], a[136:139], v[60:63], v[28:31]
  v_mfma_f32_16x16x32_bf16 v[36:39], a[216:219], v[60:63], v[36:39]
  ds_read_b128 v[56:59], v3 offset:17408
  s_waitcnt lgkmcnt(4)
  v_mfma_f32_16x16x32_bf16 v[16:19], a[60:63], v[40:43], v[16:19]
  v_mfma_f32_16x16x32_bf16 v[24:27], a[140:143], v[40:43], v[24:27]
  v_mfma_f32_16x16x32_bf16 v[32:35], a[220:223], v[40:43], v[32:35]
  ds_read_b128 v[60:63], v3 offset:37888
  s_waitcnt lgkmcnt(4)
  v_mfma_f32_16x16x32_bf16 v[20:23], a[60:63], v[44:47], v[20:23]
  v_mfma_f32_16x16x32_bf16 v[28:31], a[140:143], v[44:47], v[28:31]
  v_mfma_f32_16x16x32_bf16 v[36:39], a[220:223], v[44:47], v[36:39]
  ds_read_b128 v[40:43], v3 offset:18432
  s_waitcnt lgkmcnt(4)
  v_mfma_f32_16x16x32_bf16 v[16:19], a[64:67], v[48:51], v[16:19]
  v_mfma_f32_16x16x32_bf16 v[24:27], a[144:147], v[48:51], v[24:27]
  v_mfma_f32_16x16x32_bf16 v[32:35], a[224:227], v[48:51], v[32:35]
  ds_read_b128 v[44:47], v3 offset:38912
  s_waitcnt lgkmcnt(4)
  v_mfma_f32_16x16x32_bf16 v[20:23], a[64:67], v[52:55], v[20:23]
  v_mfma_f32_16x16x32_bf16 v[28:31], a[144:147], v[52:55], v[28:31]
  v_mfma_f32_16x16x32_bf16 v[36:39], a[224:227], v[52:55], v[36:39]
  ds_read_b128 v[48:51], v3 offset:19456
  s_waitcnt lgkmcnt(4)
  v_mfma_f32_16x16x32_bf16 v[16:19], a[68:71], v[56:59], v[16:19]
  v_mfma_f32_16x16x32_bf16 v[24:27], a[148:151], v[56:59], v[24:27]
  v_mfma_f32_16x16x32_bf16 v[32:35], a[228:231], v[56:59], v[32:35]
  ds_read_b128 v[52:55], v3 offset:39936
  s_waitcnt lgkmcnt(4)
  v_mfma_f32_16x16x32_bf16 v[20:23], a[68:71], v[60:63], v[20:23]
  v_mfma_f32_16x16x32_bf16 v[28:31], a[148:151], v[60:63], v[28:31]
  v_mfma_f32_16x16x32_bf16 v[36:39], a[228:231], v[60:63], v[36:39]
  s_waitcnt lgkmcnt(3)
  v_mfma_f32_16x16x32_bf16 v[16:19], a[72:75], v[40:43], v[16:19]
  v_mfma_f32_16x16x32_bf16 v[24:27], a[152:155], v[40:43], v[24:27]
  v_mfma_f32_16x16x32_bf16 v[32:35], a[232:235], v[40:43], v[32:35]
  s_waitcnt lgkmcnt(2)
  v_mfma_f32_16x16x32_bf16 v[20:23], a[72:75], v[44:47], v[20:23]
  v_mfma_f32_16x16x32_bf16 v[28:31], a[152:155], v[44:47], v[28:31]
  v_mfma_f32_16x16x32_bf16 v[36:39], a[232:235], v[44:47], v[36:39]
  s_waitcnt lgkmcnt(1)
  v_mfma_f32_16x16x32_bf16 v[16:19], a[76:79], v[48:51], v[16:19]
  v_mfma_f32_16x16x32_bf16 v[24:27], a[156:159], v[48:51], v[24:27]
  v_mfma_f32_16x16x32_bf16 v[32:35], a[236:239], v[48:51], v[32:35]
  s_waitcnt lgkmcnt(0)
  v_mfma_f32_16x16x32_bf16 v[20:23], a[76:79], v[52:55], v[20:23]
  v_mfma_f32_16x16x32_bf16 v[28:31], a[156:159], v[52:55], v[28:31]
  v_mfma_f32_16x16x32_bf16 v[36:39], a[236:239], v[52:55], v[36:39]
  s_cmp_lt_u32 s17, 96
  s_nop 4
  s_cbranch_scc1 T1_st
  v_max_f32 v16, 0, v16
  v_max_f32 v17, 0, v17
  v_max_f32 v18, 0, v18
  v_max_f32 v19, 0, v19
  v_max_f32 v20, 0, v20
  v_max_f32 v21, 0, v21
  v_max_f32 v22, 0, v22
  v_max_f32 v23, 0, v23
  v_max_f32 v24, 0, v24
  v_max_f32 v25, 0, v25
  v_max_f32 v26, 0, v26
  v_max_f32 v27, 0, v27
  v_max_f32 v28, 0, v28
  v_max_f32 v29, 0, v29
  v_max_f32 v30, 0, v30
  v_max_f32 v31, 0, v31
  v_max_f32 v32, 0, v32
  v_max_f32 v33, 0, v33
  v_max_f32 v34, 0, v34
  v_max_f32 v35, 0, v35
  v_max_f32 v36, 0, v36
  v_max_f32 v37, 0, v37
  v_max_f32 v38, 0, v38
  v_max_f32 v39, 0, v39
  v_pk_mul_f32 v[16:17], v[16:17], v[16:17]
  v_pk_mul_f32 v[18:19], v[18:19], v[18:19]
  v_pk_mul_f32 v[20:21], v[20:21], v[20:21]
  v_pk_mul_f32 v[22:23], v[22:23], v[22:23]
  v_pk_mul_f32 v[24:25], v[24:25], v[24:25]
  v_pk_mul_f32 v[26:27], v[26:27], v[26:27]
  v_pk_mul_f32 v[28:29], v[28:29], v[28:29]
  v_pk_mul_f32 v[30:31], v[30:31], v[30:31]
  v_pk_mul_f32 v[32:33], v[32:33], v[32:33]
  v_pk_mul_f32 v[34:35], v[34:35], v[34:35]
  v_pk_mul_f32 v[36:37], v[36:37], v[36:37]
  v_pk_mul_f32 v[38:39], v[38:39], v[38:39]
T1_st:
  s_add_u32 s20, s28, 6144
  s_nop 1
  v_cvt_pk_bf16_f32 v64, v16, v17
  v_cvt_pk_bf16_f32 v65, v18, v19
  buffer_store_dwordx2 v[64:65], v4, s[4:7], s28 offen offset:0 sc1
  v_cvt_pk_bf16_f32 v68, v24, v25
  v_cvt_pk_bf16_f32 v69, v26, v27
  buffer_store_dwordx2 v[68:69], v4, s[4:7], s28 offen offset:512 sc1
  v_cvt_pk_bf16_f32 v72, v32, v33
  v_cvt_pk_bf16_f32 v73, v34, v35
  buffer_store_dwordx2 v[72:73], v4, s[4:7], s28 offen offset:1024 sc1
  v_cvt_pk_bf16_f32 v66, v20, v21
  v_cvt_pk_bf16_f32 v67, v22, v23
  buffer_store_dwordx2 v[66:67], v4, s[4:7], s20 offen offset:0 sc1
  v_cvt_pk_bf16_f32 v70, v28, v29
  v_cvt_pk_bf16_f32 v71, v30, v31
  buffer_store_dwordx2 v[70:71], v4, s[4:7], s20 offen offset:512 sc1
  v_cvt_pk_bf16_f32 v74, v36, v37
  v_cvt_pk_bf16_f32 v75, v38, v39
  buffer_store_dwordx2 v[74:75], v4, s[4:7], s20 offen offset:1024 sc1
  s_add_u32 s28, s28, 12288
  s_add_u32 s31, s31, 40960
  s_cmp_eq_u32 s31, 122880
  s_cselect_b32 s31, 0, s31
  s_add_u32 s30, s30, 1
  s_sub_u32 s20, s30, 3
  s_cmp_lt_u32 s20, 61
  s_cbranch_scc1 T1_loop
  s_waitcnt vmcnt(0)
  v_mov_b32 v5, s30
  buffer_store_dword v5, v7, s[4:7], s29 offen sc1
  s_cmp_lt_u32 s30, 64
  s_cbranch_scc1 T1_loop
  s_branch R_POSTW
R_T2:
  s_cmp_ge_u32 s17, 32
  s_cselect_b32 s21, 80, 40
  s_load_dwordx2 s[8:9], s[0:1], s21
  s_mov_b32 s10, 7864320
  s_cselect_b32 s10, 1966080, s10
  s_mov_b32 s11, 0x20000
  s_and_b32 s24, s17, 31
  s_mul_i32 s24, s24, 245760
  s_waitcnt lgkmcnt(0)
  v_lshrrev_b32 v8, 3, v1
  s_lshl_b32 s20, s16, 3
  v_add_u32 v8, s20, v8
  v_mul_u32_u24 v8, 1280, v8
  v_and_b32 v9, 7, v1
  s_lshl_b32 s20, s16, 1
  v_xor_b32 v9, s20, v9
  v_lshl_add_u32 v2, v9, 4, v8
  v_lshrrev_b32 v8, 4, v1
  v_mul_u32_u24 v9, 10240, v8
  v_bfe_u32 v10, v1, 2, 2
  v_lshl_add_u32 v9, v10, 7, v9
  v_and_b32 v10, 3, v1
  v_lshl_add_u32 v9, v10, 3, v9
  s_mul_i32 s20, s16, 10
  s_add_u32 s20, s20, 0
  s_and_b32 s21, s20, 3
  s_lshr_b32 s20, s20, 2
  s_lshl_b32 s20, s20, 10
  v_xor_b32 v10, s21, v8
  v_lshl_add_u32 v10, v10, 5, v9
  v_add_u32 v20, s20, v10
  s_mul_i32 s20, s16, 10
  s_add_u32 s20, s20, 1
  s_and_b32 s21, s20, 3
  s_lshr_b32 s20, s20, 2
  s_lshl_b32 s20, s20, 10
  v_xor_b32 v10, s21, v8
  v_lshl_add_u32 v10, v10, 5, v9
  v_add_u32 v21, s20, v10
  s_mul_i32 s20, s16, 10
  s_add_u32 s20, s20, 2
  s_and_b32 s21, s20, 3
  s_lshr_b32 s20, s20, 2
  s_lshl_b32 s20, s20, 10
  v_xor_b32 v10, s21, v8
  v_lshl_add_u32 v10, v10, 5, v9
  v_add_u32 v22, s20, v10
  s_mul_i32 s20, s16, 10
  s_add_u32 s20, s20, 3
  s_and_b32 s21, s20, 3
  s_lshr_b32 s20, s20, 2
  s_lshl_b32 s20, s20, 10
  v_xor_b32 v10, s21, v8
  v_lshl_add_u32 v10, v10, 5, v9
  v_add_u32 v23, s20, v10
  s_mul_i32 s20, s16, 10
  s_add_u32 s20, s20, 4
  s_and_b32 s21, s20, 3
  s_lshr_b32 s20, s20, 2
  s_lshl_b32 s20, s20, 10
  v_xor_b32 v10, s21, v8
  v_lshl_add_u32 v10, v10, 5, v9
  v_add_u32 v24, s20, v10
  s_mul_i32 s20, s16, 10
  s_add_u32 s20, s20, 5
  s_and_b32 s21, s20, 3
  s_lshr_b32 s20, s20, 2
  s_lshl_b32 s20, s20, 10
  v_xor_b32 v10, s21, v8
  v_lshl_add_u32 v10, v10, 5, v9
  v_add_u32 v25, s20, v10
  s_mul_i32 s20, s16, 10
  s_add_u32 s20, s20, 6
  s_and_b32 s21, s20, 3
  s_lshr_b32 s20, s20, 2
  s_lshl_b32 s20, s20, 10
  v_xor_b32 v10, s21, v8
  v_lshl_add_u32 v10, v10, 5, v9
  v_add_u32 v26, s20, v10
  s_mul_i32 s20, s16, 10
  s_add_u32 s20, s20, 7
  s_and_b32 s21, s20, 3
  s_lshr_b32 s20, s20, 2
  s_lshl_b32 s20, s20, 10
  v_xor_b32 v10, s21, v8
  v_lshl_add_u32 v10, v10, 5, v9
  v_add_u32 v27, s20, v10
  s_mul_i32 s20, s16, 10
  s_add_u32 s20, s20, 8
  s_and_b32 s21, s20, 3
  s_lshr_b32 s20, s20, 2
  s_lshl_b32 s20, s20, 10
  v_xor_b32 v10, s21, v8
  v_lshl_add_u32 v10, v10, 5, v9
  v_add_u32 v28, s20, v10
  s_mul_i32 s20, s16, 10
  s_add_u32 s20, s20, 9
  s_and_b32 s21, s20, 3
  s_lshr_b32 s20, s20, 2
  s_lshl_b32 s20, s20, 10
  v_xor_b32 v10, s21, v8
  v_lshl_add_u32 v10, v10, 5, v9
  v_add_u32 v29, s20, v10
  s_mul_i32 s27, s16, 10240
  s_add_u32 m0, s27, 0
  s_add_u32 s26, s24, 0
  buffer_load_dwordx4 v2, s[8:11], s26 offen lds
  s_add_u32 m0, s27, 1024
  s_add_u32 s26, s24, 128
  buffer_load_dwordx4 v2, s[8:11], s26 offen lds
  s_add_u32 m0, s27, 2048
  s_add_u32 s26, s24, 256
  buffer_load_dwordx4 v2, s[8:11], s26 offen lds
  s_add_u32 m0, s27, 3072
  s_add_u32 s26, s24, 384
  buffer_load_dwordx4 v2, s[8:11], s26 offen lds
  s_add_u32 m0, s27, 4096
  s_add_u32 s26, s24, 512
  buffer_load_dwordx4 v2, s[8:11], s26 offen lds
  s_add_u32 m0, s27, 5120
  s_add_u32 s26, s24, 640
  buffer_load_dwordx4 v2, s[8:11], s26 offen lds
  s_add_u32 m0, s27, 6144
  s_add_u32 s26, s24, 768
  buffer_load_dwordx4 v2, s[8:11], s26 offen lds
  s_add_u32 m0, s27, 7168
  s_add_u32 s26, s24, 896
  buffer_load_dwordx4 v2, s[8:11], s26 offen lds
  s_add_u32 m0, s27, 8192
  s_add_u32 s26, s24, 1024
  buffer_load_dwordx4 v2, s[8:11], s26 offen lds
  s_add_u32 m0, s27, 9216
  s_add_u32 s26, s24, 1152
  buffer_load_dwordx4 v2, s[8:11], s26 offen lds
  s_mul_i32 s27, s16, 10240
  s_add_u32 m0, s27, 40960
  s_add_u32 s26, s24, 40960
  buffer_load_dwordx4 v2, s[8:11], s26 offen lds
  s_add_u32 m0, s27, 41984
  s_add_u32 s26, s24, 41088
  buffer_load_dwordx4 v2, s[8:11], s26 offen lds
  s_add_u32 m0, s27, 43008
  s_add_u32 s26, s24, 41216
  buffer_load_dwordx4 v2, s[8:11], s26 offen lds
  s_add_u32 m0, s27, 44032
  s_add_u32 s26, s24, 41344
  buffer_load_dwordx4 v2, s[8:11], s26 offen lds
  s_add_u32 m0, s27, 45056
  s_add_u32 s26, s24, 41472
  buffer_load_dwordx4 v2, s[8:11], s26 offen lds
  s_add_u32 m0, s27, 46080
  s_add_u32 s26, s24, 41600
  buffer_load_dwordx4 v2, s[8:11], s26 offen lds
  s_add_u32 m0, s27, 47104
  s_add_u32 s26, s24, 41728
  buffer_load_dwordx4 v2, s[8:11], s26 offen lds
  s_add_u32 m0, s27, 48128
  s_add_u32 s26, s24, 41856
  buffer_load_dwordx4 v2, s[8:11], s26 offen lds
  s_add_u32 m0, s27, 49152
  s_add_u32 s26, s24, 41984
  buffer_load_dwordx4 v2, s[8:11], s26 offen lds
  s_add_u32 m0, s27, 50176
  s_add_u32 s26, s24, 42112
  buffer_load_dwordx4 v2, s[8:11], s26 offen lds
  s_mul_i32 s27, s16, 10240
  s_add_u32 m0, s27, 81920
  s_add_u32 s26, s24, 81920
  buffer_load_dwordx4 v2, s[8:11], s26 offen lds
  s_add_u32 m0, s27, 82944
  s_add_u32 s26, s24, 82048
  buffer_load_dwordx4 v2, s[8:11], s26 offen lds
  s_add_u32 m0, s27, 83968
  s_add_u32 s26, s24, 82176
  buffer_load_dwordx4 v2, s[8:11], s26 offen lds
  s_add_u32 m0, s27, 84992
  s_add_u32 s26, s24, 82304
  buffer_load_dwordx4 v2, s[8:11], s26 offen lds
  s_add_u32 m0, s27, 86016
  s_add_u32 s26, s24, 82432
  buffer_load_dwordx4 v2, s[8:11], s26 offen lds
  s_add_u32 m0, s27, 87040
  s_add_u32 s26, s24, 82560
  buffer_load_dwordx4 v2, s[8:11], s26 offen lds
  s_add_u32 m0, s27, 88064
  s_add_u32 s26, s24, 82688
  buffer_load_dwordx4 v2, s[8:11], s26 offen lds
  s_add_u32 m0, s27, 89088
  s_add_u32 s26, s24, 82816
  buffer_load_dwordx4 v2, s[8:11], s26 offen lds
  s_add_u32 m0, s27, 90112
  s_add_u32 s26, s24, 82944
  buffer_load_dwordx4 v2, s[8:11], s26 offen lds
  s_add_u32 m0, s27, 91136
  s_add_u32 s26, s24, 83072
  buffer_load_dwordx4 v2, s[8:11], s26 offen lds
  s_waitcnt vmcnt(20)
  s_barrier
  v_add_u32 v8, 0, v20
  v_add_u32 v9, 0, v21
  v_add_u32 v10, 0, v22
  v_add_u32 v11, 0, v23
  v_add_u32 v12, 0, v24
  v_add_u32 v13, 0, v25
  v_add_u32 v14, 0, v26
  v_add_u32 v15, 0, v27
  v_add_u32 v16, 0, v28
  v_add_u32 v17, 0, v29
  ds_read_b64_tr_b16 a[0:1], v8 offset:0
  ds_read_b64_tr_b16 a[2:3], v8 offset:512
  ds_read_b64_tr_b16 a[24:25], v9 offset:0
  ds_read_b64_tr_b16 a[26:27], v9 offset:512
  ds_read_b64_tr_b16 a[48:49], v10 offset:0
  ds_read_b64_tr_b16 a[50:51], v10 offset:512
  ds_read_b64_tr_b16 a[72:73], v11 offset:0
  ds_read_b64_tr_b16 a[74:75], v11 offset:512
  ds_read_b64_tr_b16 a[96:97], v12 offset:0
  ds_read_b64_tr_b16 a[98:99], v12 offset:512
  ds_read_b64_tr_b16 a[120:121], v13 offset:0
  ds_read_b64_tr_b16 a[122:123], v13 offset:512
  ds_read_b64_tr_b16 a[144:145], v14 offset:0
  ds_read_b64_tr_b16 a[146:147], v14 offset:512
  ds_read_b64_tr_b16 a[168:169], v15 offset:0
  ds_read_b64_tr_b16 a[170:171], v15 offset:512
  ds_read_b64_tr_b16 a[192:193], v16 offset:0
  ds_read_b64_tr_b16 a[194:195], v16 offset:512
  ds_read_b64_tr_b16 a[216:217], v17 offset:0
  ds_read_b64_tr_b16 a[218:219], v17 offset:512
  s_waitcnt lgkmcnt(0)
  s_waitcnt vmcnt(10)
  s_barrier
  s_mul_i32 s27, s16, 10240
  s_add_u32 m0, s27, 0
  s_add_u32 s26, s24, 122880
  buffer_load_dwordx4 v2, s[8:11], s26 offen lds
  s_add_u32 m0, s27, 1024
  s_add_u32 s26, s24, 123008
  buffer_load_dwordx4 v2, s[8:11], s26 offen lds
  s_add_u32 m0, s27, 2048
  s_add_u32 s26, s24, 123136
  buffer_load_dwordx4 v2, s[8:11], s26 offen lds
  s_add_u32 m0, s27, 3072
  s_add_u32 s26, s24, 123264
  buffer_load_dwordx4 v2, s[8:11], s26 offen lds
  s_add_u32 m0, s27, 4096
  s_add_u32 s26, s24, 123392
  buffer_load_dwordx4 v2, s[8:11], s26 offen lds
  s_add_u32 m0, s27, 5120
  s_add_u32 s26, s24, 123520
  buffer_load_dwordx4 v2, s[8:11], s26 offen lds
  s_add_u32 m0, s27, 6144
  s_add_u32 s26, s24, 123648
  buffer_load_dwordx4 v2, s[8:11], s26 offen lds
  s_add_u32 m0, s27, 7168
  s_add_u32 s26, s24, 123776
  buffer_load_dwordx4 v2, s[8:11], s26 offen lds
  s_add_u32 m0, s27, 8192
  s_add_u32 s26, s24, 123904
  buffer_load_dwordx4 v2, s[8:11], s26 offen lds
  s_add_u32 m0, s27, 9216
  s_add_u32 s26, s24, 124032
  buffer_load_dwordx4 v2, s[8:11], s26 offen lds
  v_add_u32 v8, 40960, v20
  v_add_u32 v9, 40960, v21
  v_add_u32 v10, 40960, v22
  v_add_u32 v11, 40960, v23
  v_add_u32 v12, 40960, v24
  v_add_u32 v13, 40960, v25
  v_add_u32 v14, 40960, v26
  v_add_u32 v15, 40960, v27
  v_add_u32 v16, 40960, v28
  v_add_u32 v17, 40960, v29
  ds_read_b64_tr_b16 a[4:5], v8 offset:0
  ds_read_b64_tr_b16 a[6:7], v8 offset:512
  ds_read_b64_tr_b16 a[28:29], v9 offset:0
  ds_read_b64_tr_b16 a[30:31], v9 offset:512
  ds_read_b64_tr_b16 a[52:53], v10 offset:0
  ds_read_b64_tr_b16 a[54:55], v10 offset:512
  ds_read_b64_tr_b16 a[76:77], v11 offset:0
  ds_read_b64_tr_b16 a[78:79], v11 offset:512
  ds_read_b64_tr_b16 a[100:101], v12 offset:0
  ds_read_b64_tr_b16 a[102:103], v12 offset:512
  ds_read_b64_tr_b16 a[124:125], v13 offset:0
  ds_read_b64_tr_b16 a[126:127], v13 offset:512
  ds_read_b64_tr_b16 a[148:149], v14 offset:0
  ds_read_b64_tr_b16 a[150:151], v14 offset:512
  ds_read_b64_tr_b16 a[172:173], v15 offset:0
  ds_read_b64_tr_b16 a[174:175], v15 offset:512
  ds_read_b64_tr_b16 a[196:197], v16 offset:0
  ds_read_b64_tr_b16 a[198:199], v16 offset:512
  ds_read_b64_tr_b16 a[220:221], v17 offset:0
  ds_read_b64_tr_b16 a[222:223], v17 offset:512
  s_waitcnt lgkmcnt(0)
  s_waitcnt vmcnt(10)
  s_barrier
  s_mul_i32 s27, s16, 10240
  s_add_u32 m0, s27, 40960
  s_add_u32 s26, s24, 163840
  buffer_load_dwordx4 v2, s[8:11], s26 offen lds
  s_add_u32 m0, s27, 41984
  s_add_u32 s26, s24, 163968
  buffer_load_dwordx4 v2, s[8:11], s26 offen lds
  s_add_u32 m0, s27, 43008
  s_add_u32 s26, s24, 164096
  buffer_load_dwordx4 v2, s[8:11], s26 offen lds
  s_add_u32 m0, s27, 44032
  s_add_u32 s26, s24, 164224
  buffer_load_dwordx4 v2, s[8:11], s26 offen lds
  s_add_u32 m0, s27, 45056
  s_add_u32 s26, s24, 164352
  buffer_load_dwordx4 v2, s[8:11], s26 offen lds
  s_add_u32 m0, s27, 46080
  s_add_u32 s26, s24, 164480
  buffer_load_dwordx4 v2, s[8:11], s26 offen lds
  s_add_u32 m0, s27, 47104
  s_add_u32 s26, s24, 164608
  buffer_load_dwordx4 v2, s[8:11], s26 offen lds
  s_add_u32 m0, s27, 48128
  s_add_u32 s26, s24, 164736
  buffer_load_dwordx4 v2, s[8:11], s26 offen lds
  s_add_u32 m0, s27, 49152
  s_add_u32 s26, s24, 164864
  buffer_load_dwordx4 v2, s[8:11], s26 offen lds
  s_add_u32 m0, s27, 50176
  s_add_u32 s26, s24, 164992
  buffer_load_dwordx4 v2, s[8:11], s26 offen lds
  v_add_u32 v8, 81920, v20
  v_add_u32 v9, 81920, v21
  v_add_u32 v10, 81920, v22
  v_add_u32 v11, 81920, v23
  v_add_u32 v12, 81920, v24
  v_add_u32 v13, 81920, v25
  v_add_u32 v14, 81920, v26
  v_add_u32 v15, 81920, v27
  v_add_u32 v16, 81920, v28
  v_add_u32 v17, 81920, v29
  ds_read_b64_tr_b16 a[8:9], v8 offset:0
  ds_read_b64_tr_b16 a[10:11], v8 offset:512
  ds_read_b64_tr_b16 a[32:33], v9 offset:0
  ds_read_b64_tr_b16 a[34:35], v9 offset:512
  ds_read_b64_tr_b16 a[56:57], v10 offset:0
  ds_read_b64_tr_b16 a[58:59], v10 offset:512
  ds_read_b64_tr_b16 a[80:81], v11 offset:0
  ds_read_b64_tr_b16 a[82:83], v11 offset:512
  ds_read_b64_tr_b16 a[104:105], v12 offset:0
  ds_read_b64_tr_b16 a[106:107], v12 offset:512
  ds_read_b64_tr_b16 a[128:129], v13 offset:0
  ds_read_b64_tr_b16 a[130:131], v13 offset:512
  ds_read_b64_tr_b16 a[152:153], v14 offset:0
  ds_read_b64_tr_b16 a[154:155], v14 offset:512
  ds_read_b64_tr_b16 a[176:177], v15 offset:0
  ds_read_b64_tr_b16 a[178:179], v15 offset:512
  ds_read_b64_tr_b16 a[200:201], v16 offset:0
  ds_read_b64_tr_b16 a[202:203], v16 offset:512
  ds_read_b64_tr_b16 a[224:225], v17 offset:0
  ds_read_b64_tr_b16 a[226:227], v17 offset:512
  s_waitcnt lgkmcnt(0)
  s_waitcnt vmcnt(10)
  s_barrier
  s_mul_i32 s27, s16, 10240
  s_add_u32 m0, s27, 81920
  s_add_u32 s26, s24, 204800
  buffer_load_dwordx4 v2, s[8:11], s26 offen lds
  s_add_u32 m0, s27, 82944
  s_add_u32 s26, s24, 204928
  buffer_load_dwordx4 v2, s[8:11], s26 offen lds
  s_add_u32 m0, s27, 83968
  s_add_u32 s26, s24, 205056
  buffer_load_dwordx4 v2, s[8:11], s26 offen lds
  s_add_u32 m0, s27, 84992
  s_add_u32 s26, s24, 205184
  buffer_load_dwordx4 v2, s[8:11], s26 offen lds
  s_add_u32 m0, s27, 86016
  s_add_u32 s26, s24, 205312
  buffer_load_dwordx4 v2, s[8:11], s26 offen lds
  s_add_u32 m0, s27, 87040
  s_add_u32 s26, s24, 205440
  buffer_load_dwordx4 v2, s[8:11], s26 offen lds
  s_add_u32 m0, s27, 88064
  s_add_u32 s26, s24, 205568
  buffer_load_dwordx4 v2, s[8:11], s26 offen lds
  s_add_u32 m0, s27, 89088
  s_add_u32 s26, s24, 205696
  buffer_load_dwordx4 v2, s[8:11], s26 offen lds
  s_add_u32 m0, s27, 90112
  s_add_u32 s26, s24, 205824
  buffer_load_dwordx4 v2, s[8:11], s26 offen lds
  s_add_u32 m0, s27, 91136
  s_add_u32 s26, s24, 205952
  buffer_load_dwordx4 v2, s[8:11], s26 offen lds
  s_cmp_eq_u32 s16, 0
  s_cbranch_scc0 DI_73
  buffer_load_dwordx2 v[32:33], off, s[48:51], 0 offset:8 sc1
DI_73:
  v_add_u32 v8, 0, v20
  v_add_u32 v9, 0, v21
  v_add_u32 v10, 0, v22
  v_add_u32 v11, 0, v23
  v_add_u32 v12, 0, v24
  v_add_u32 v13, 0, v25
  v_add_u32 v14, 0, v26
  v_add_u32 v15, 0, v27
  v_add_u32 v16, 0, v28
  v_add_u32 v17, 0, v29
  ds_read_b64_tr_b16 a[12:13], v8 offset:0
  ds_read_b64_tr_b16 a[14:15], v8 offset:512
  ds_read_b64_tr_b16 a[36:37], v9 offset:0
  ds_read_b64_tr_b16 a[38:39], v9 offset:512
  ds_read_b64_tr_b16 a[60:61], v10 offset:0
  ds_read_b64_tr_b16 a[62:63], v10 offset:512
  ds_read_b64_tr_b16 a[84:85], v11 offset:0
  ds_read_b64_tr_b16 a[86:87], v11 offset:512
  ds_read_b64_tr_b16 a[108:109], v12 offset:0
  ds_read_b64_tr_b16 a[110:111], v12 offset:512
  ds_read_b64_tr_b16 a[132:133], v13 offset:0
  ds_read_b64_tr_b16 a[134:135], v13 offset:512
  ds_read_b64_tr_b16 a[156:157], v14 offset:0
  ds_read_b64_tr_b16 a[158:159], v14 offset:512
  ds_read_b64_tr_b16 a[180:181], v15 offset:0
  ds_read_b64_tr_b16 a[182:183], v15 offset:512
  ds_read_b64_tr_b16 a[204:205], v16 offset:0
  ds_read_b64_tr_b16 a[206:207], v16 offset:512
  ds_read_b64_tr_b16 a[228:229], v17 offset:0
  ds_read_b64_tr_b16 a[230:231], v17 offset:512
  s_waitcnt lgkmcnt(0)
  s_waitcnt vmcnt(10)
  s_barrier
  v_add_u32 v8, 40960, v20
  v_add_u32 v9, 40960, v21
  v_add_u32 v10, 40960, v22
  v_add_u32 v11, 40960, v23
  v_add_u32 v12, 40960, v24
  v_add_u32 v13, 40960, v25
  v_add_u32 v14, 40960, v26
  v_add_u32 v15, 40960, v27
  v_add_u32 v16, 40960, v28
  v_add_u32 v17, 40960, v29
  ds_read_b64_tr_b16 a[16:17], v8 offset:0
  ds_read_b64_tr_b16 a[18:19], v8 offset:512
  ds_read_b64_tr_b16 a[40:41], v9 offset:0
  ds_read_b64_tr_b16 a[42:43], v9 offset:512
  ds_read_b64_tr_b16 a[64:65], v10 offset:0
  ds_read_b64_tr_b16 a[66:67], v10 offset:512
  ds_read_b64_tr_b16 a[88:89], v11 offset:0
  ds_read_b64_tr_b16 a[90:91], v11 offset:512
  ds_read_b64_tr_b16 a[112:113], v12 offset:0
  ds_read_b64_tr_b16 a[114:115], v12 offset:512
  ds_read_b64_tr_b16 a[136:137], v13 offset:0
  ds_read_b64_tr_b16 a[138:139], v13 offset:512
  ds_read_b64_tr_b16 a[160:161], v14 offset:0
  ds_read_b64_tr_b16 a[162:163], v14 offset:512
  ds_read_b64_tr_b16 a[184:185], v15 offset:0
  ds_read_b64_tr_b16 a[186:187], v15 offset:512
  ds_read_b64_tr_b16 a[208:209], v16 offset:0
  ds_read_b64_tr_b16 a[210:211], v16 offset:512
  ds_read_b64_tr_b16 a[232:233], v17 offset:0
  ds_read_b64_tr_b16 a[234:235], v17 offset:512
  s_waitcnt lgkmcnt(0)
  s_waitcnt vmcnt(0)
  s_barrier
  v_add_u32 v8, 81920, v20
  v_add_u32 v9, 81920, v21
  v_add_u32 v10, 81920, v22
  v_add_u32 v11, 81920, v23
  v_add_u32 v12, 81920, v24
  v_add_u32 v13, 81920, v25
  v_add_u32 v14, 81920, v26
  v_add_u32 v15, 81920, v27
  v_add_u32 v16, 81920, v28
  v_add_u32 v17, 81920, v29
  ds_read_b64_tr_b16 a[20:21], v8 offset:0
  ds_read_b64_tr_b16 a[22:23], v8 offset:512
  ds_read_b64_tr_b16 a[44:45], v9 offset:0
  ds_read_b64_tr_b16 a[46:47], v9 offset:512
  ds_read_b64_tr_b16 a[68:69], v10 offset:0
  ds_read_b64_tr_b16 a[70:71], v10 offset:512
  ds_read_b64_tr_b16 a[92:93], v11 offset:0
  ds_read_b64_tr_b16 a[94:95], v11 offset:512
  ds_read_b64_tr_b16 a[116:117], v12 offset:0
  ds_read_b64_tr_b16 a[118:119], v12 offset:512
  ds_read_b64_tr_b16 a[140:141], v13 offset:0
  ds_read_b64_tr_b16 a[142:143], v13 offset:512
  ds_read_b64_tr_b16 a[164:165], v14 offset:0
  ds_read_b64_tr_b16 a[166:167], v14 offset:512
  ds_read_b64_tr_b16 a[188:189], v15 offset:0
  ds_read_b64_tr_b16 a[190:191], v15 offset:512
  ds_read_b64_tr_b16 a[212:213], v16 offset:0
  ds_read_b64_tr_b16 a[214:215], v16 offset:512
  ds_read_b64_tr_b16 a[236:237], v17 offset:0
  ds_read_b64_tr_b16 a[238:239], v17 offset:512
  s_waitcnt lgkmcnt(0)
  s_cmp_eq_u32 s16, 0
  s_cbranch_scc0 DC_76
  s_mov_b32 s22, 0
DC_74:
  s_waitcnt vmcnt(0)
  v_readfirstlane_b32 s20, v32
  v_readfirstlane_b32 s21, v33
  s_cmp_lg_u32 s20, 0
  s_cbranch_scc1 DC_75
DC_77:
  s_add_u32 s22, s22, 1
  s_cmp_gt_u32 s22, 200000
  s_cbranch_scc1 DC_75
  s_sleep 16
  buffer_load_dwordx2 v[32:33], off, s[48:51], 0 offset:8 sc1
  s_branch DC_74
DC_75:
  s_and_b32 s21, s21, 8192
  v_mov_b32 v32, s21
  v_mov_b32 v33, 163824
  ds_write_b32 v33, v32
  s_waitcnt lgkmcnt(0)
DC_76:
  s_barrier
  v_mov_b32 v33, 163824
  ds_read_b32 v32, v33
  s_waitcnt lgkmcnt(0)
  v_readfirstlane_b32 s52, v32
  v_lshlrev_b32 v2, 4, v1
  v_and_b32 v4, 15, v1
  v_lshlrev_b32 v4, 6, v4
  v_lshrrev_b32 v5, 4, v1
  v_lshl_add_u32 v4, v5, 4, v4
  s_mul_i32 s20, s16, 409600
  v_add_u32 v4, s20, v4
  v_mov_b32 v7, 0
  s_add_u32 s20, s17, 64
  s_mul_i32 s26, s20, 786432
  s_add_u32 s26, s26, 33554432
  s_lshl_b32 s27, s20, 7
  s_add_u32 s27, s27, 0
  s_lshl_b32 s28, s17, 10
  s_add_u32 s28, s28, 117440512
  s_lshl_b32 s29, s17, 7
  s_lshl_b32 s20, s16, 2
  s_add_u32 s29, s29, s20
  s_add_u32 s29, s29, 13312
  s_mov_b32 s30, 0
  s_mov_b32 s32, 0
T2sp_78:
  buffer_load_dwordx4 v[8:11], v7, s[4:7], s27 offen sc1
  s_waitcnt vmcnt(0)
  v_min_u32 v8, v8, v9
  v_min3_u32 v8, v8, v10, v11
  s_nop 0
  v_readfirstlane_b32 s22, v8
  s_cmp_gt_u32 s22, s30
  s_cbranch_scc1 T2sx_79
  s_sleep 5
  s_add_u32 s32, s32, 1
  s_cmp_gt_u32 s32, 200000
  s_cbranch_scc1 T2sx_79
  s_branch T2sp_78
T2sx_79:
  buffer_load_dwordx4 v[32:35], v2, s[4:7], s26 offen offset:0 sc1
  s_add_u32 s20, s26, 4096
  s_add_u32 s21, s26, 8192
  buffer_load_dwordx4 v[36:39], v2, s[4:7], s26 offen offset:1024 sc1
  buffer_load_dwordx4 v[40:43], v2, s[4:7], s26 offen offset:2048 sc1
  buffer_load_dwordx4 v[44:47], v2, s[4:7], s26 offen offset:3072 sc1
  buffer_load_dwordx4 v[48:51], v2, s[4:7], s20 offen offset:0 sc1
  buffer_load_dwordx4 v[52:55], v2, s[4:7], s20 offen offset:1024 sc1
  buffer_load_dwordx4 v[56:59], v2, s[4:7], s20 offen offset:2048 sc1
  buffer_load_dwordx4 v[60:63], v2, s[4:7], s20 offen offset:3072 sc1
  buffer_load_dwordx4 v[64:67], v2, s[4:7], s21 offen offset:0 sc1
  buffer_load_dwordx4 v[68:71], v2, s[4:7], s21 offen offset:1024 sc1
  buffer_load_dwordx4 v[72:75], v2, s[4:7], s21 offen offset:2048 sc1
  buffer_load_dwordx4 v[76:79], v2, s[4:7], s21 offen offset:3072 sc1
  s_add_u32 s26, s26, 12288
  s_waitcnt vmcnt(0)
T2_loop:
  s_waitcnt vmcnt(6)
  buffer_load_dwordx4 v[8:11], v7, s[4:7], s27 offen sc1
  v_mfma_f32_16x16x32_bf16 v[128:131], v[32:35], a[0:3], 0
  v_mfma_f32_16x16x32_bf16 v[132:135], v[56:59], a[0:3], 0
  v_mfma_f32_16x16x32_bf16 v[136:139], v[32:35], a[24:27], 0
  v_mfma_f32_16x16x32_bf16 v[140:143], v[56:59], a[24:27], 0
  v_mfma_f32_16x16x32_bf16 v[128:131], v[36:39], a[4:7], v[128:131]
  v_mfma_f32_16x16x32_bf16 v[132:135], v[60:63], a[4:7], v[132:135]
  v_mfma_f32_16x16x32_bf16 v[136:139], v[36:39], a[28:31], v[136:139]
  v_mfma_f32_16x16x32_bf16 v[140:143], v[60:63], a[28:31], v[140:143]
  v_mfma_f32_16x16x32_bf16 v[128:131], v[40:43], a[8:11], v[128:131]
  v_mfma_f32_16x16x32_bf16 v[132:135], v[64:67], a[8:11], v[132:135]
  v_mfma_f32_16x16x32_bf16 v[136:139], v[40:43], a[32:35], v[136:139]
  v_mfma_f32_16x16x32_bf16 v[140:143], v[64:67], a[32:35], v[140:143]
  v_mfma_f32_16x16x32_bf16 v[128:131], v[44:47], a[12:15], v[128:131]
  v_mfma_f32_16x16x32_bf16 v[132:135], v[68:71], a[12:15], v[132:135]
  v_mfma_f32_16x16x32_bf16 v[136:139], v[44:47], a[36:39], v[136:139]
  v_mfma_f32_16x16x32_bf16 v[140:143], v[68:71], a[36:39], v[140:143]
  v_mfma_f32_16x16x32_bf16 v[128:131], v[48:51], a[16:19], v[128:131]
  v_mfma_f32_16x16x32_bf16 v[132:135], v[72:75], a[16:19], v[132:135]
  v_mfma_f32_16x16x32_bf16 v[136:139], v[48:51], a[40:43], v[136:139]
  v_mfma_f32_16x16x32_bf16 v[140:143], v[72:75], a[40:43], v[140:143]
  v_mfma_f32_16x16x32_bf16 v[128:131], v[52:55], a[20:23], v[128:131]
  v_mfma_f32_16x16x32_bf16 v[132:135], v[76:79], a[20:23], v[132:135]
  v_mfma_f32_16x16x32_bf16 v[136:139], v[52:55], a[44:47], v[136:139]
  v_mfma_f32_16x16x32_bf16 v[140:143], v[76:79], a[44:47], v[140:143]
  v_mfma_f32_16x16x32_bf16 v[144:147], v[32:35], a[48:51], 0
  v_mfma_f32_16x16x32_bf16 v[148:151], v[56:59], a[48:51], 0
  v_mfma_f32_16x16x32_bf16 v[152:155], v[32:35], a[72:75], 0
  v_mfma_f32_16x16x32_bf16 v[156:159], v[56:59], a[72:75], 0
  v_mfma_f32_16x16x32_bf16 v[144:147], v[36:39], a[52:55], v[144:147]
  v_mfma_f32_16x16x32_bf16 v[148:151], v[60:63], a[52:55], v[148:151]
  v_mfma_f32_16x16x32_bf16 v[152:155], v[36:39], a[76:79], v[152:155]
  v_mfma_f32_16x16x32_bf16 v[156:159], v[60:63], a[76:79], v[156:159]
  v_mfma_f32_16x16x32_bf16 v[144:147], v[40:43], a[56:59], v[144:147]
  v_mfma_f32_16x16x32_bf16 v[148:151], v[64:67], a[56:59], v[148:151]
  v_mfma_f32_16x16x32_bf16 v[152:155], v[40:43], a[80:83], v[152:155]
  v_mfma_f32_16x16x32_bf16 v[156:159], v[64:67], a[80:83], v[156:159]
  v_cvt_pk_bf16_f32 v160, v128, v129
  v_cvt_pk_bf16_f32 v161, v130, v131
  v_cvt_pk_bf16_f32 v162, v132, v133
  v_cvt_pk_bf16_f32 v163, v134, v135
  s_add_u32 s20, s28, 0
  buffer_store_dwordx4 v[160:163], v4, s[4:7], s20 offen sc1
  v_cvt_pk_bf16_f32 v164, v136, v137
  v_cvt_pk_bf16_f32 v165, v138, v139
  v_cvt_pk_bf16_f32 v166, v140, v141
  v_cvt_pk_bf16_f32 v167, v142, v143
  s_add_u32 s20, s28, 40960
  buffer_store_dwordx4 v[164:167], v4, s[4:7], s20 offen sc1
  v_mfma_f32_16x16x32_bf16 v[144:147], v[44:47], a[60:63], v[144:147]
  v_mfma_f32_16x16x32_bf16 v[148:151], v[68:71], a[60:63], v[148:151]
  v_mfma_f32_16x16x32_bf16 v[152:155], v[44:47], a[84:87], v[152:155]
  v_mfma_f32_16x16x32_bf16 v[156:159], v[68:71], a[84:87], v[156:159]
  v_mfma_f32_16x16x32_bf16 v[144:147], v[48:51], a[64:67], v[144:147]
  v_mfma_f32_16x16x32_bf16 v[148:151], v[72:75], a[64:67], v[148:151]
  v_mfma_f32_16x16x32_bf16 v[152:155], v[48:51], a[88:91], v[152:155]
  v_mfma_f32_16x16x32_bf16 v[156:159], v[72:75], a[88:91], v[156:159]
  v_mfma_f32_16x16x32_bf16 v[144:147], v[52:55], a[68:71], v[144:147]
  v_mfma_f32_16x16x32_bf16 v[148:151], v[76:79], a[68:71], v[148:151]
  v_mfma_f32_16x16x32_bf16 v[152:155], v[52:55], a[92:95], v[152:155]
  v_mfma_f32_16x16x32_bf16 v[156:159], v[76:79], a[92:95], v[156:159]
  v_mfma_f32_16x16x32_bf16 v[128:131], v[32:35], a[96:99], 0
  v_mfma_f32_16x16x32_bf16 v[132:135], v[56:59], a[96:99], 0
  v_mfma_f32_16x16x32_bf16 v[136:139], v[32:35], a[120:123], 0
  v_mfma_f32_16x16x32_bf16 v[140:143], v[56:59], a[120:123], 0
  v_mfma_f32_16x16x32_bf16 v[128:131], v[36:39], a[100:103], v[128:131]
  v_mfma_f32_16x16x32_bf16 v[132:135], v[60:63], a[100:103], v[132:135]
  v_mfma_f32_16x16x32_bf16 v[136:139], v[36:39], a[124:127], v[136:139]
  v_mfma_f32_16x16x32_bf16 v[140:143], v[60:63], a[124:127], v[140:143]
  v_mfma_f32_16x16x32_bf16 v[128:131], v[40:43], a[104:107], v[128:131]
  v_mfma_f32_16x16x32_bf16 v[132:135], v[64:67], a[104:107], v[132:135]
  v_mfma_f32_16x16x32_bf16 v[136:139], v[40:43], a[128:131], v[136:139]
  v_mfma_f32_16x16x32_bf16 v[140:143], v[64:67], a[128:131], v[140:143]
  v_cvt_pk_bf16_f32 v168, v144, v145
  v_cvt_pk_bf16_f32 v169, v146, v147
  v_cvt_pk_bf16_f32 v170, v148, v149
  v_cvt_pk_bf16_f32 v171, v150, v151
  s_add_u32 s20, s28, 81920
  buffer_store_dwordx4 v[168:171], v4, s[4:7], s20 offen sc1
  v_cvt_pk_bf16_f32 v172, v152, v153
  v_cvt_pk_bf16_f32 v173, v154, v155
  v_cvt_pk_bf16_f32 v174, v156, v157
  v_cvt_pk_bf16_f32 v175, v158, v159
  s_add_u32 s20, s28, 122880
  buffer_store_dwordx4 v[172:175], v4, s[4:7], s20 offen sc1
  v_mfma_f32_16x16x32_bf16 v[128:131], v[44:47], a[108:111], v[128:131]
  v_mfma_f32_16x16x32_bf16 v[132:135], v[68:71], a[108:111], v[132:135]
  v_mfma_f32_16x16x32_bf16 v[136:139], v[44:47], a[132:135], v[136:139]
  v_mfma_f32_16x16x32_bf16 v[140:143], v[68:71], a[132:135], v[140:143]
  v_mfma_f32_16x16x32_bf16 v[128:131], v[48:51], a[112:115], v[128:131]
  v_mfma_f32_16x16x32_bf16 v[132:135], v[72:75], a[112:115], v[132:135]
  v_mfma_f32_16x16x32_bf16 v[136:139], v[48:51], a[136:139], v[136:139]
  v_mfma_f32_16x16x32_bf16 v[140:143], v[72:75], a[136:139], v[140:143]
  v_mfma_f32_16x16x32_bf16 v[128:131], v[52:55], a[116:119], v[128:131]
  v_mfma_f32_16x16x32_bf16 v[132:135], v[76:79], a[116:119], v[132:135]
  v_mfma_f32_16x16x32_bf16 v[136:139], v[52:55], a[140:143], v[136:139]
  v_mfma_f32_16x16x32_bf16 v[140:143], v[76:79], a[140:143], v[140:143]
  s_waitcnt vmcnt(4)
  v_mov_b32 v5, s30
  buffer_store_dword v5, v7, s[4:7], s29 offen sc1
  v_min_u32 v8, v8, v9
  v_min3_u32 v8, v8, v10, v11
  s_nop 0
  v_readfirstlane_b32 s22, v8
  s_add_u32 s23, s30, 1
  s_cmp_gt_u32 s22, s23
  s_cselect_b32 s31, 1, 0
  s_cbranch_scc0 T2np_80
  buffer_load_dwordx4 v[80:83], v2, s[4:7], s26 offen offset:0 sc1
  s_add_u32 s20, s26, 4096
  s_add_u32 s21, s26, 8192
  buffer_load_dwordx4 v[84:87], v2, s[4:7], s26 offen offset:1024 sc1
  buffer_load_dwordx4 v[88:91], v2, s[4:7], s26 offen offset:2048 sc1
  buffer_load_dwordx4 v[92:95], v2, s[4:7], s26 offen offset:3072 sc1
  buffer_load_dwordx4 v[96:99], v2, s[4:7], s20 offen offset:0 sc1
  buffer_load_dwordx4 v[100:103], v2, s[4:7], s20 offen offset:1024 sc1
  buffer_load_dwordx4 v[104:107], v2, s[4:7], s20 offen offset:2048 sc1
  buffer_load_dwordx4 v[108:111], v2, s[4:7], s20 offen offset:3072 sc1
  buffer_load_dwordx4 v[112:115], v2, s[4:7], s21 offen offset:0 sc1
  buffer_load_dwordx4 v[116:119], v2, s[4:7], s21 offen offset:1024 sc1
  buffer_load_dwordx4 v[120:123], v2, s[4:7], s21 offen offset:2048 sc1
  buffer_load_dwordx4 v[124:127], v2, s[4:7], s21 offen offset:3072 sc1
  s_add_u32 s26, s26, 12288
T2np_80:
  v_mfma_f32_16x16x32_bf16 v[144:147], v[32:35], a[144:147], 0
  v_mfma_f32_16x16x32_bf16 v[148:151], v[56:59], a[144:147], 0
  v_mfma_f32_16x16x32_bf16 v[152:155], v[32:35], a[168:171], 0
  v_mfma_f32_16x16x32_bf16 v[156:159], v[56:59], a[168:171], 0
  v_mfma_f32_16x16x32_bf16 v[144:147], v[36:39], a[148:151], v[144:147]
  v_mfma_f32_16x16x32_bf16 v[148:151], v[60:63], a[148:151], v[148:151]
  v_mfma_f32_16x16x32_bf16 v[152:155], v[36:39], a[172:175], v[152:155]
  v_mfma_f32_16x16x32_bf16 v[156:159], v[60:63], a[172:175], v[156:159]
  v_mfma_f32_16x16x32_bf16 v[144:147], v[40:43], a[152:155], v[144:147]
  v_mfma_f32_16x16x32_bf16 v[148:151], v[64:67], a[152:155], v[148:151]
  v_mfma_f32_16x16x32_bf16 v[152:155], v[40:43], a[176:179], v[152:155]
  v_mfma_f32_16x16x32_bf16 v[156:159], v[64:67], a[176:179], v[156:159]
  v_cvt_pk_bf16_f32 v160, v128, v129
  v_cvt_pk_bf16_f32 v161, v130, v131
  v_cvt_pk_bf16_f32 v162, v132, v133
  v_cvt_pk_bf16_f32 v163, v134, v135
  s_add_u32 s20, s28, 163840
  buffer_store_dwordx4 v[160:163], v4, s[4:7], s20 offen sc1
  v_cvt_pk_bf16_f32 v164, v136, v137
  v_cvt_pk_bf16_f32 v165, v138, v139
  v_cvt_pk_bf16_f32 v166, v140, v141
  v_cvt_pk_bf16_f32 v167, v142, v143
  s_add_u32 s20, s28, 204800
  buffer_store_dwordx4 v[164:167], v4, s[4:7], s20 offen sc1
  v_mfma_f32_16x16x32_bf16 v[144:147], v[44:47], a[156:159], v[144:147]
  v_mfma_f32_16x16x32_bf16 v[148:151], v[68:71], a[156:159], v[148:151]
  v_mfma_f32_16x16x32_bf16 v[152:155], v[44:47], a[180:183], v[152:155]
  v_mfma_f32_16x16x32_bf16 v[156:159], v[68:71], a[180:183], v[156:159]
  v_mfma_f32_16x16x32_bf16 v[144:147], v[48:51], a[160:163], v[144:147]
  v_mfma_f32_16x16x32_bf16 v[148:151], v[72:75], a[160:163], v[148:151]
  v_mfma_f32_16x16x32_bf16 v[152:155], v[48:51], a[184:187], v[152:155]
  v_mfma_f32_16x16x32_bf16 v[156:159], v[72:75], a[184:187], v[156:159]
  v_mfma_f32_16x16x32_bf16 v[144:147], v[52:55], a[164:167], v[144:147]
  v_mfma_f32_16x16x32_bf16 v[148:151], v[76:79], a[164:167], v[148:151]
  v_mfma_f32_16x16x32_bf16 v[152:155], v[52:55], a[188:191], v[152:155]
  v_mfma_f32_16x16x32_bf16 v[156:159], v[76:79], a[188:191], v[156:159]
  v_mfma_f32_16x16x32_bf16 v[128:131], v[32:35], a[192:195], 0
  v_mfma_f32_16x16x32_bf16 v[132:135], v[56:59], a[192:195], 0
  v_mfma_f32_16x16x32_bf16 v[136:139], v[32:35], a[216:219], 0
  v_mfma_f32_16x16x32_bf16 v[140:143], v[56:59], a[216:219], 0
  v_mfma_f32_16x16x32_bf16 v[128:131], v[36:39], a[196:199], v[128:131]
  v_mfma_f32_16x16x32_bf16 v[132:135], v[60:63], a[196:199], v[132:135]
  v_mfma_f32_16x16x32_bf16 v[136:139], v[36:39], a[220:223], v[136:139]
  v_mfma_f32_16x16x32_bf16 v[140:143], v[60:63], a[220:223], v[140:143]
  v_mfma_f32_16x16x32_bf16 v[128:131], v[40:43], a[200:203], v[128:131]
  v_mfma_f32_16x16x32_bf16 v[132:135], v[64:67], a[200:203], v[132:135]
  v_mfma_f32_16x16x32_bf16 v[136:139], v[40:43], a[224:227], v[136:139]
  v_mfma_f32_16x16x32_bf16 v[140:143], v[64:67], a[224:227], v[140:143]
  v_cvt_pk_bf16_f32 v168, v144, v145
  v_cvt_pk_bf16_f32 v169, v146, v147
  v_cvt_pk_bf16_f32 v170, v148, v149
  v_cvt_pk_bf16_f32 v171, v150, v151
  s_add_u32 s20, s28, 245760
  buffer_store_dwordx4 v[168:171], v4, s[4:7], s20 offen sc1
  v_cvt_pk_bf16_f32 v172, v152, v153
  v_cvt_pk_bf16_f32 v173, v154, v155
  v_cvt_pk_bf16_f32 v174, v156, v157
  v_cvt_pk_bf16_f32 v175, v158, v159
  s_add_u32 s20, s28, 286720
  buffer_store_dwordx4 v[172:175], v4, s[4:7], s20 offen sc1
  v_mfma_f32_16x16x32_bf16 v[128:131], v[44:47], a[204:207], v[128:131]
  v_mfma_f32_16x16x32_bf16 v[132:135], v[68:71], a[204:207], v[132:135]
  v_mfma_f32_16x16x32_bf16 v[136:139], v[44:47], a[228:231], v[136:139]
  v_mfma_f32_16x16x32_bf16 v[140:143], v[68:71], a[228:231], v[140:143]
  v_mfma_f32_16x16x32_bf16 v[128:131], v[48:51], a[208:211], v[128:131]
  v_mfma_f32_16x16x32_bf16 v[132:135], v[72:75], a[208:211], v[132:135]
  v_mfma_f32_16x16x32_bf16 v[136:139], v[48:51], a[232:235], v[136:139]
  v_mfma_f32_16x16x32_bf16 v[140:143], v[72:75], a[232:235], v[140:143]
  v_mfma_f32_16x16x32_bf16 v[128:131], v[52:55], a[212:215], v[128:131]
  v_mfma_f32_16x16x32_bf16 v[132:135], v[76:79], a[212:215], v[132:135]
  v_mfma_f32_16x16x32_bf16 v[136:139], v[52:55], a[236:239], v[136:139]
  v_mfma_f32_16x16x32_bf16 v[140:143], v[76:79], a[236:239], v[140:143]
  s_nop 7
  v_cvt_pk_bf16_f32 v160, v128, v129
  v_cvt_pk_bf16_f32 v161, v130, v131
  v_cvt_pk_bf16_f32 v162, v132, v133
  v_cvt_pk_bf16_f32 v163, v134, v135
  s_add_u32 s20, s28, 327680
  buffer_store_dwordx4 v[160:163], v4, s[4:7], s20 offen sc1
  v_cvt_pk_bf16_f32 v164, v136, v137
  v_cvt_pk_bf16_f32 v165, v138, v139
  v_cvt_pk_bf16_f32 v166, v140, v141
  v_cvt_pk_bf16_f32 v167, v142, v143
  s_add_u32 s20, s28, 368640
  buffer_store_dwordx4 v[164:167], v4, s[4:7], s20 offen sc1
  s_add_u32 s28, s28, 1638400
  s_add_u32 s30, s30, 1
  s_cmp_eq_u32 s30, 64
  s_cbranch_scc1 T2_done
  s_cmp_lt_u32 s30, 3
  s_cselect_b32 s20, 0, s31
  s_cmp_eq_u32 s20, 1
  s_cbranch_scc1 T2f_81
  s_waitcnt vmcnt(0)
  v_mov_b32 v5, s30
  buffer_store_dword v5, v7, s[4:7], s29 offen sc1
  s_cmp_eq_u32 s31, 1
  s_cbranch_scc1 T2f_81
T2sp_82:
  buffer_load_dwordx4 v[8:11], v7, s[4:7], s27 offen sc1
  s_waitcnt vmcnt(0)
  v_min_u32 v8, v8, v9
  v_min3_u32 v8, v8, v10, v11
  s_nop 0
  v_readfirstlane_b32 s22, v8
  s_cmp_gt_u32 s22, s30
  s_cbranch_scc1 T2sx_83
  s_sleep 5
  s_add_u32 s32, s32, 1
  s_cmp_gt_u32 s32, 200000
  s_cbranch_scc1 T2sx_83
  s_branch T2sp_82
T2sx_83:
  buffer_load_dwordx4 v[80:83], v2, s[4:7], s26 offen offset:0 sc1
  s_add_u32 s20, s26, 4096
  s_add_u32 s21, s26, 8192
  buffer_load_dwordx4 v[84:87], v2, s[4:7], s26 offen offset:1024 sc1
  buffer_load_dwordx4 v[88:91], v2, s[4:7], s26 offen offset:2048 sc1
  buffer_load_dwordx4 v[92:95], v2, s[4:7], s26 offen offset:3072 sc1
  buffer_load_dwordx4 v[96:99], v2, s[4:7], s20 offen offset:0 sc1
  buffer_load_dwordx4 v[100:103], v2, s[4:7], s20 offen offset:1024 sc1
  buffer_load_dwordx4 v[104:107], v2, s[4:7], s20 offen offset:2048 sc1
  buffer_load_dwordx4 v[108:111], v2, s[4:7], s20 offen offset:3072 sc1
  buffer_load_dwordx4 v[112:115], v2, s[4:7], s21 offen offset:0 sc1
  buffer_load_dwordx4 v[116:119], v2, s[4:7], s21 offen offset:1024 sc1
  buffer_load_dwordx4 v[120:123], v2, s[4:7], s21 offen offset:2048 sc1
  buffer_load_dwordx4 v[124:127], v2, s[4:7], s21 offen offset:3072 sc1
  s_add_u32 s26, s26, 12288
  s_waitcnt vmcnt(0)
T2f_81:
  s_waitcnt vmcnt(6)
  buffer_load_dwordx4 v[8:11], v7, s[4:7], s27 offen sc1
  v_mfma_f32_16x16x32_bf16 v[128:131], v[80:83], a[0:3], 0
  v_mfma_f32_16x16x32_bf16 v[132:135], v[104:107], a[0:3], 0
  v_mfma_f32_16x16x32_bf16 v[136:139], v[80:83], a[24:27], 0
  v_mfma_f32_16x16x32_bf16 v[140:143], v[104:107], a[24:27], 0
  v_mfma_f32_16x16x32_bf16 v[128:131], v[84:87], a[4:7], v[128:131]
  v_mfma_f32_16x16x32_bf16 v[132:135], v[108:111], a[4:7], v[132:135]
  v_mfma_f32_16x16x32_bf16 v[136:139], v[84:87], a[28:31], v[136:139]
  v_mfma_f32_16x16x32_bf16 v[140:143], v[108:111], a[28:31], v[140:143]
  v_mfma_f32_16x16x32_bf16 v[128:131], v[88:91], a[8:11], v[128:131]
  v_mfma_f32_16x16x32_bf16 v[132:135], v[112:115], a[8:11], v[132:135]
  v_mfma_f32_16x16x32_bf16 v[136:139], v[88:91], a[32:35], v[136:139]
  v_mfma_f32_16x16x32_bf16 v[140:143], v[112:115], a[32:35], v[140:143]
  v_mfma_f32_16x16x32_bf16 v[128:131], v[92:95], a[12:15], v[128:131]
  v_mfma_f32_16x16x32_bf16 v[132:135], v[116:119], a[12:15], v[132:135]
  v_mfma_f32_16x16x32_bf16 v[136:139], v[92:95], a[36:39], v[136:139]
  v_mfma_f32_16x16x32_bf16 v[140:143], v[116:119], a[36:39], v[140:143]
  v_mfma_f32_16x16x32_bf16 v[128:131], v[96:99], a[16:19], v[128:131]
  v_mfma_f32_16x16x32_bf16 v[132:135], v[120:123], a[16:19], v[132:135]
  v_mfma_f32_16x16x32_bf16 v[136:139], v[96:99], a[40:43], v[136:139]
  v_mfma_f32_16x16x32_bf16 v[140:143], v[120:123], a[40:43], v[140:143]
  v_mfma_f32_16x16x32_bf16 v[128:131], v[100:103], a[20:23], v[128:131]
  v_mfma_f32_16x16x32_bf16 v[132:135], v[124:127], a[20:23], v[132:135]
  v_mfma_f32_16x16x32_bf16 v[136:139], v[100:103], a[44:47], v[136:139]
  v_mfma_f32_16x16x32_bf16 v[140:143], v[124:127], a[44:47], v[140:143]
  v_mfma_f32_16x16x32_bf16 v[144:147], v[80:83], a[48:51], 0
  v_mfma_f32_16x16x32_bf16 v[148:151], v[104:107], a[48:51], 0
  v_mfma_f32_16x16x32_bf16 v[152:155], v[80:83], a[72:75], 0
  v_mfma_f32_16x16x32_bf16 v[156:159], v[104:107], a[72:75], 0
  v_mfma_f32_16x16x32_bf16 v[144:147], v[84:87], a[52:55], v[144:147]
  v_mfma_f32_16x16x32_bf16 v[148:151], v[108:111], a[52:55], v[148:151]
  v_mfma_f32_16x16x32_bf16 v[152:155], v[84:87], a[76:79], v[152:155]
  v_mfma_f32_16x16x32_bf16 v[156:159], v[108:111], a[76:79], v[156:159]
  v_mfma_f32_16x16x32_bf16 v[144:147], v[88:91], a[56:59], v[144:147]
  v_mfma_f32_16x16x32_bf16 v[148:151], v[112:115], a[56:59], v[148:151]
  v_mfma_f32_16x16x32_bf16 v[152:155], v[88:91], a[80:83], v[152:155]
  v_mfma_f32_16x16x32_bf16 v[156:159], v[112:115], a[80:83], v[156:159]
  v_cvt_pk_bf16_f32 v160, v128, v129
  v_cvt_pk_bf16_f32 v161, v130, v131
  v_cvt_pk_bf16_f32 v162, v132, v133
  v_cvt_pk_bf16_f32 v163, v134, v135
  s_add_u32 s20, s28, 0
  buffer_store_dwordx4 v[160:163], v4, s[4:7], s20 offen sc1
  v_cvt_pk_bf16_f32 v164, v136, v137
  v_cvt_pk_bf16_f32 v165, v138, v139
  v_cvt_pk_bf16_f32 v166, v140, v141
  v_cvt_pk_bf16_f32 v167, v142, v143
  s_add_u32 s20, s28, 40960
  buffer_store_dwordx4 v[164:167], v4, s[4:7], s20 offen sc1
  v_mfma_f32_16x16x32_bf16 v[144:147], v[92:95], a[60:63], v[144:147]
  v_mfma_f32_16x16x32_bf16 v[148:151], v[116:119], a[60:63], v[148:151]
  v_mfma_f32_16x16x32_bf16 v[152:155], v[92:95], a[84:87], v[152:155]
  v_mfma_f32_16x16x32_bf16 v[156:159], v[116:119], a[84:87], v[156:159]
  v_mfma_f32_16x16x32_bf16 v[144:147], v[96:99], a[64:67], v[144:147]
  v_mfma_f32_16x16x32_bf16 v[148:151], v[120:123], a[64:67], v[148:151]
  v_mfma_f32_16x16x32_bf16 v[152:155], v[96:99], a[88:91], v[152:155]
  v_mfma_f32_16x16x32_bf16 v[156:159], v[120:123], a[88:91], v[156:159]
  v_mfma_f32_16x16x32_bf16 v[144:147], v[100:103], a[68:71], v[144:147]
  v_mfma_f32_16x16x32_bf16 v[148:151], v[124:127], a[68:71], v[148:151]
  v_mfma_f32_16x16x32_bf16 v[152:155], v[100:103], a[92:95], v[152:155]
  v_mfma_f32_16x16x32_bf16 v[156:159], v[124:127], a[92:95], v[156:159]
  v_mfma_f32_16x16x32_bf16 v[128:131], v[80:83], a[96:99], 0
  v_mfma_f32_16x16x32_bf16 v[132:135], v[104:107], a[96:99], 0
  v_mfma_f32_16x16x32_bf16 v[136:139], v[80:83], a[120:123], 0
  v_mfma_f32_16x16x32_bf16 v[140:143], v[104:107], a[120:123], 0
  v_mfma_f32_16x16x32_bf16 v[128:131], v[84:87], a[100:103], v[128:131]
  v_mfma_f32_16x16x32_bf16 v[132:135], v[108:111], a[100:103], v[132:135]
  v_mfma_f32_16x16x32_bf16 v[136:139], v[84:87], a[124:127], v[136:139]
  v_mfma_f32_16x16x32_bf16 v[140:143], v[108:111], a[124:127], v[140:143]
  v_mfma_f32_16x16x32_bf16 v[128:131], v[88:91], a[104:107], v[128:131]
  v_mfma_f32_16x16x32_bf16 v[132:135], v[112:115], a[104:107], v[132:135]
  v_mfma_f32_16x16x32_bf16 v[136:139], v[88:91], a[128:131], v[136:139]
  v_mfma_f32_16x16x32_bf16 v[140:143], v[112:115], a[128:131], v[140:143]
  v_cvt_pk_bf16_f32 v168, v144, v145
  v_cvt_pk_bf16_f32 v169, v146, v147
  v_cvt_pk_bf16_f32 v170, v148, v149
  v_cvt_pk_bf16_f32 v171, v150, v151
  s_add_u32 s20, s28, 81920
  buffer_store_dwordx4 v[168:171], v4, s[4:7], s20 offen sc1
  v_cvt_pk_bf16_f32 v172, v152, v153
  v_cvt_pk_bf16_f32 v173, v154, v155
  v_cvt_pk_bf16_f32 v174, v156, v157
  v_cvt_pk_bf16_f32 v175, v158, v159
  s_add_u32 s20, s28, 122880
  buffer_store_dwordx4 v[172:175], v4, s[4:7], s20 offen sc1
  v_mfma_f32_16x16x32_bf16 v[128:131], v[92:95], a[108:111], v[128:131]
  v_mfma_f32_16x16x32_bf16 v[132:135], v[116:119], a[108:111], v[132:135]
  v_mfma_f32_16x16x32_bf16 v[136:139], v[92:95], a[132:135], v[136:139]
  v_mfma_f32_16x16x32_bf16 v[140:143], v[116:119], a[132:135], v[140:143]
  v_mfma_f32_16x16x32_bf16 v[128:131], v[96:99], a[112:115], v[128:131]
  v_mfma_f32_16x16x32_bf16 v[132:135], v[120:123], a[112:115], v[132:135]
  v_mfma_f32_16x16x32_bf16 v[136:139], v[96:99], a[136:139], v[136:139]
  v_mfma_f32_16x16x32_bf16 v[140:143], v[120:123], a[136:139], v[140:143]
  v_mfma_f32_16x16x32_bf16 v[128:131], v[100:103], a[116:119], v[128:131]
  v_mfma_f32_16x16x32_bf16 v[132:135], v[124:127], a[116:119], v[132:135]
  v_mfma_f32_16x16x32_bf16 v[136:139], v[100:103], a[140:143], v[136:139]
  v_mfma_f32_16x16x32_bf16 v[140:143], v[124:127], a[140:143], v[140:143]
  s_waitcnt vmcnt(4)
  v_mov_b32 v5, s30
  buffer_store_dword v5, v7, s[4:7], s29 offen sc1
  v_min_u32 v8, v8, v9
  v_min3_u32 v8, v8, v10, v11
  s_nop 0
  v_readfirstlane_b32 s22, v8
  s_add_u32 s23, s30, 1
  s_cmp_gt_u32 s22, s23
  s_cselect_b32 s31, 1, 0
  s_cbranch_scc0 T2np_84
  buffer_load_dwordx4 v[32:35], v2, s[4:7], s26 offen offset:0 sc1
  s_add_u32 s20, s26, 4096
  s_add_u32 s21, s26, 8192
  buffer_load_dwordx4 v[36:39], v2, s[4:7], s26 offen offset:1024 sc1
  buffer_load_dwordx4 v[40:43], v2, s[4:7], s26 offen offset:2048 sc1
  buffer_load_dwordx4 v[44:47], v2, s[4:7], s26 offen offset:3072 sc1
  buffer_load_dwordx4 v[48:51], v2, s[4:7], s20 offen offset:0 sc1
  buffer_load_dwordx4 v[52:55], v2, s[4:7], s20 offen offset:1024 sc1
  buffer_load_dwordx4 v[56:59], v2, s[4:7], s20 offen offset:2048 sc1
  buffer_load_dwordx4 v[60:63], v2, s[4:7], s20 offen offset:3072 sc1
  buffer_load_dwordx4 v[64:67], v2, s[4:7], s21 offen offset:0 sc1
  buffer_load_dwordx4 v[68:71], v2, s[4:7], s21 offen offset:1024 sc1
  buffer_load_dwordx4 v[72:75], v2, s[4:7], s21 offen offset:2048 sc1
  buffer_load_dwordx4 v[76:79], v2, s[4:7], s21 offen offset:3072 sc1
  s_add_u32 s26, s26, 12288
T2np_84:
  v_mfma_f32_16x16x32_bf16 v[144:147], v[80:83], a[144:147], 0
  v_mfma_f32_16x16x32_bf16 v[148:151], v[104:107], a[144:147], 0
  v_mfma_f32_16x16x32_bf16 v[152:155], v[80:83], a[168:171], 0
  v_mfma_f32_16x16x32_bf16 v[156:159], v[104:107], a[168:171], 0
  v_mfma_f32_16x16x32_bf16 v[144:147], v[84:87], a[148:151], v[144:147]
  v_mfma_f32_16x16x32_bf16 v[148:151], v[108:111], a[148:151], v[148:151]
  v_mfma_f32_16x16x32_bf16 v[152:155], v[84:87], a[172:175], v[152:155]
  v_mfma_f32_16x16x32_bf16 v[156:159], v[108:111], a[172:175], v[156:159]
  v_mfma_f32_16x16x32_bf16 v[144:147], v[88:91], a[152:155], v[144:147]
  v_mfma_f32_16x16x32_bf16 v[148:151], v[112:115], a[152:155], v[148:151]
  v_mfma_f32_16x16x32_bf16 v[152:155], v[88:91], a[176:179], v[152:155]
  v_mfma_f32_16x16x32_bf16 v[156:159], v[112:115], a[176:179], v[156:159]
  v_cvt_pk_bf16_f32 v160, v128, v129
  v_cvt_pk_bf16_f32 v161, v130, v131
  v_cvt_pk_bf16_f32 v162, v132, v133
  v_cvt_pk_bf16_f32 v163, v134, v135
  s_add_u32 s20, s28, 163840
  buffer_store_dwordx4 v[160:163], v4, s[4:7], s20 offen sc1
  v_cvt_pk_bf16_f32 v164, v136, v137
  v_cvt_pk_bf16_f32 v165, v138, v139
  v_cvt_pk_bf16_f32 v166, v140, v141
  v_cvt_pk_bf16_f32 v167, v142, v143
  s_add_u32 s20, s28, 204800
  buffer_store_dwordx4 v[164:167], v4, s[4:7], s20 offen sc1
  v_mfma_f32_16x16x32_bf16 v[144:147], v[92:95], a[156:159], v[144:147]
  v_mfma_f32_16x16x32_bf16 v[148:151], v[116:119], a[156:159], v[148:151]
  v_mfma_f32_16x16x32_bf16 v[152:155], v[92:95], a[180:183], v[152:155]
  v_mfma_f32_16x16x32_bf16 v[156:159], v[116:119], a[180:183], v[156:159]
  v_mfma_f32_16x16x32_bf16 v[144:147], v[96:99], a[160:163], v[144:147]
  v_mfma_f32_16x16x32_bf16 v[148:151], v[120:123], a[160:163], v[148:151]
  v_mfma_f32_16x16x32_bf16 v[152:155], v[96:99], a[184:187], v[152:155]
  v_mfma_f32_16x16x32_bf16 v[156:159], v[120:123], a[184:187], v[156:159]
  v_mfma_f32_16x16x32_bf16 v[144:147], v[100:103], a[164:167], v[144:147]
  v_mfma_f32_16x16x32_bf16 v[148:151], v[124:127], a[164:167], v[148:151]
  v_mfma_f32_16x16x32_bf16 v[152:155], v[100:103], a[188:191], v[152:155]
  v_mfma_f32_16x16x32_bf16 v[156:159], v[124:127], a[188:191], v[156:159]
  v_mfma_f32_16x16x32_bf16 v[128:131], v[80:83], a[192:195], 0
  v_mfma_f32_16x16x32_bf16 v[132:135], v[104:107], a[192:195], 0
  v_mfma_f32_16x16x32_bf16 v[136:139], v[80:83], a[216:219], 0
  v_mfma_f32_16x16x32_bf16 v[140:143], v[104:107], a[216:219], 0
  v_mfma_f32_16x16x32_bf16 v[128:131], v[84:87], a[196:199], v[128:131]
  v_mfma_f32_16x16x32_bf16 v[132:135], v[108:111], a[196:199], v[132:135]
  v_mfma_f32_16x16x32_bf16 v[136:139], v[84:87], a[220:223], v[136:139]
  v_mfma_f32_16x16x32_bf16 v[140:143], v[108:111], a[220:223], v[140:143]
  v_mfma_f32_16x16x32_bf16 v[128:131], v[88:91], a[200:203], v[128:131]
  v_mfma_f32_16x16x32_bf16 v[132:135], v[112:115], a[200:203], v[132:135]
  v_mfma_f32_16x16x32_bf16 v[136:139], v[88:91], a[224:227], v[136:139]
  v_mfma_f32_16x16x32_bf16 v[140:143], v[112:115], a[224:227], v[140:143]
  v_cvt_pk_bf16_f32 v168, v144, v145
  v_cvt_pk_bf16_f32 v169, v146, v147
  v_cvt_pk_bf16_f32 v170, v148, v149
  v_cvt_pk_bf16_f32 v171, v150, v151
  s_add_u32 s20, s28, 245760
  buffer_store_dwordx4 v[168:171], v4, s[4:7], s20 offen sc1
  v_cvt_pk_bf16_f32 v172, v152, v153
  v_cvt_pk_bf16_f32 v173, v154, v155
  v_cvt_pk_bf16_f32 v174, v156, v157
  v_cvt_pk_bf16_f32 v175, v158, v159
  s_add_u32 s20, s28, 286720
  buffer_store_dwordx4 v[172:175], v4, s[4:7], s20 offen sc1
  v_mfma_f32_16x16x32_bf16 v[128:131], v[92:95], a[204:207], v[128:131]
  v_mfma_f32_16x16x32_bf16 v[132:135], v[116:119], a[204:207], v[132:135]
  v_mfma_f32_16x16x32_bf16 v[136:139], v[92:95], a[228:231], v[136:139]
  v_mfma_f32_16x16x32_bf16 v[140:143], v[116:119], a[228:231], v[140:143]
  v_mfma_f32_16x16x32_bf16 v[128:131], v[96:99], a[208:211], v[128:131]
  v_mfma_f32_16x16x32_bf16 v[132:135], v[120:123], a[208:211], v[132:135]
  v_mfma_f32_16x16x32_bf16 v[136:139], v[96:99], a[232:235], v[136:139]
  v_mfma_f32_16x16x32_bf16 v[140:143], v[120:123], a[232:235], v[140:143]
  v_mfma_f32_16x16x32_bf16 v[128:131], v[100:103], a[212:215], v[128:131]
  v_mfma_f32_16x16x32_bf16 v[132:135], v[124:127], a[212:215], v[132:135]
  v_mfma_f32_16x16x32_bf16 v[136:139], v[100:103], a[236:239], v[136:139]
  v_mfma_f32_16x16x32_bf16 v[140:143], v[124:127], a[236:239], v[140:143]
  s_nop 7
  v_cvt_pk_bf16_f32 v160, v128, v129
  v_cvt_pk_bf16_f32 v161, v130, v131
  v_cvt_pk_bf16_f32 v162, v132, v133
  v_cvt_pk_bf16_f32 v163, v134, v135
  s_add_u32 s20, s28, 327680
  buffer_store_dwordx4 v[160:163], v4, s[4:7], s20 offen sc1
  v_cvt_pk_bf16_f32 v164, v136, v137
  v_cvt_pk_bf16_f32 v165, v138, v139
  v_cvt_pk_bf16_f32 v166, v140, v141
  v_cvt_pk_bf16_f32 v167, v142, v143
  s_add_u32 s20, s28, 368640
  buffer_store_dwordx4 v[164:167], v4, s[4:7], s20 offen sc1
  s_add_u32 s28, s28, 1638400
  s_add_u32 s30, s30, 1
  s_cmp_eq_u32 s30, 64
  s_cbranch_scc1 T2_done
  s_cmp_lt_u32 s30, 3
  s_cselect_b32 s20, 0, s31
  s_cmp_eq_u32 s20, 1
  s_cbranch_scc1 T2f_85
  s_waitcnt vmcnt(0)
  v_mov_b32 v5, s30
  buffer_store_dword v5, v7, s[4:7], s29 offen sc1
  s_cmp_eq_u32 s31, 1
  s_cbranch_scc1 T2f_85
T2sp_86:
  buffer_load_dwordx4 v[8:11], v7, s[4:7], s27 offen sc1
  s_waitcnt vmcnt(0)
  v_min_u32 v8, v8, v9
  v_min3_u32 v8, v8, v10, v11
  s_nop 0
  v_readfirstlane_b32 s22, v8
  s_cmp_gt_u32 s22, s30
  s_cbranch_scc1 T2sx_87
  s_sleep 5
  s_add_u32 s32, s32, 1
  s_cmp_gt_u32 s32, 200000
  s_cbranch_scc1 T2sx_87
  s_branch T2sp_86
T2sx_87:
  buffer_load_dwordx4 v[32:35], v2, s[4:7], s26 offen offset:0 sc1
  s_add_u32 s20, s26, 4096
  s_add_u32 s21, s26, 8192
  buffer_load_dwordx4 v[36:39], v2, s[4:7], s26 offen offset:1024 sc1
  buffer_load_dwordx4 v[40:43], v2, s[4:7], s26 offen offset:2048 sc1
  buffer_load_dwordx4 v[44:47], v2, s[4:7], s26 offen offset:3072 sc1
  buffer_load_dwordx4 v[48:51], v2, s[4:7], s20 offen offset:0 sc1
  buffer_load_dwordx4 v[52:55], v2, s[4:7], s20 offen offset:1024 sc1
  buffer_load_dwordx4 v[56:59], v2, s[4:7], s20 offen offset:2048 sc1
  buffer_load_dwordx4 v[60:63], v2, s[4:7], s20 offen offset:3072 sc1
  buffer_load_dwordx4 v[64:67], v2, s[4:7], s21 offen offset:0 sc1
  buffer_load_dwordx4 v[68:71], v2, s[4:7], s21 offen offset:1024 sc1
  buffer_load_dwordx4 v[72:75], v2, s[4:7], s21 offen offset:2048 sc1
  buffer_load_dwordx4 v[76:79], v2, s[4:7], s21 offen offset:3072 sc1
  s_add_u32 s26, s26, 12288
  s_waitcnt vmcnt(0)
T2f_85:
  s_branch T2_loop
T2_done:
  s_waitcnt vmcnt(0)
  v_mov_b32 v5, s30
  buffer_store_dword v5, v7, s[4:7], s29 offen sc1
  s_branch R_POSTW
R_POSTW:
  s_getreg_b32 s20, hwreg(HW_REG_XCC_ID)
  s_and_b32 s20, s20, 7
  s_cmp_ge_u32 s20, 4
  s_cbranch_scc0 P_end
  s_sub_u32 s20, s2, 168
  s_cmp_lt_u32 s20, 40
  s_cbranch_scc1 P_end
  s_cmp_lt_u32 s2, 208
  s_cbranch_scc0 P_end
  s_barrier
R_POST:
  s_load_dwordx2 s[8:9], s[0:1], 0
  s_mov_b32 s10, 2621440
  s_mov_b32 s11, 0x20000
  s_load_dwordx2 s[12:13], s[0:1], 96
  s_mov_b32 s14, 2621440
  s_mov_b32 s15, 0x20000
  s_load_dwordx2 s[40:41], s[0:1], 88
  s_mov_b32 s42, 1280
  s_mov_b32 s43, 0x20000
  v_lshlrev_b32 v2, 4, v1
  v_mov_b32 v3, 0
  v_lshrrev_b32 v56, 4, v1
  v_and_b32 v57, 15, v1
  v_lshrrev_b32 v59, 2, v57
  v_min_u32 v5, 39, v1
  v_lshlrev_b32 v5, 4, v5
  v_lshlrev_b32 v6, 3, v1
  v_lshlrev_b32 v7, 2, v1
  v_mov_b32 v8, 0
  v_and_b32 v60, 1, v59
  v_lshlrev_b32 v60, 3, v60
  v_and_b32 v61, 3, v57
  v_add_u32 v60, v60, v61
  v_lshrrev_b32 v62, 1, v59
  v_mul_u32_u24 v9, 40960, v62
  v_lshl_add_u32 v9, v60, 6, v9
  v_lshl_add_u32 v9, v56, 4, v9
  v_add_u32 v10, 256, v9
  v_lshlrev_b32 v11, 14, v62
  v_lshl_add_u32 v11, v60, 4, v11
  v_lshl_add_u32 v11, v56, 8, v11
  v_add_u32 v12, 64, v11
  v_lshl_add_u32 v58, v59, 3, v61
  v_mul_u32_u24 v13, 1280, v58
  v_lshl_add_u32 v13, v56, 4, v13
  s_and_b32 s20, s16, 1
  s_mul_i32 s20, s20, 5120
  s_lshr_b32 s21, s16, 1
  s_lshl_b32 s21, s21, 3
  s_add_u32 s20, s20, s21
  v_add_u32 v13, s20, v13
  v_lshlrev_b32 v15, 4, v56
  v_add_u32 v15, s21, v15
  v_and_b32 v58, 1, v57
  v_cmp_eq_u32 vcc, 1, v58
  v_mov_b32 v62, 0x3f80
  v_mov_b32 v63, 0x3f800000
  v_cndmask_b32 v62, v62, v63, vcc
  v_cmp_eq_u32 vcc, v56, v59
  v_cndmask_b32 v62, v3, v62, vcc
  v_bfe_u32 v58, v57, 1, 1
  v_cmp_eq_u32 vcc, 0, v58
  v_cndmask_b32 v16, v3, v62, vcc
  v_cndmask_b32 v17, v62, v3, vcc
  v_mov_b32 v18, 0
  v_mov_b32 v19, 0
  v_mov_b32 v20, 0
  v_mov_b32 v21, 0
  v_mov_b32 v22, v16
  v_mov_b32 v23, v17
  s_mov_b32 s32, 0
  s_movk_i32 s33, 26624
  s_waitcnt lgkmcnt(0)
  s_mov_b32 s34, 0
  s_mov_b32 s36, 0
  s_movk_i32 s35, 26880
  s_cmp_eq_u32 s2, 248
  s_cbranch_scc0 P_start
  s_cmp_eq_u32 s16, 0
  s_cbranch_scc0 P_end
  v_min_u32 v5, 39, v1
  v_lshlrev_b32 v5, 7, v5
  v_and_b32 v6, 31, v1
  v_lshlrev_b32 v6, 7, v6
  s_movk_i32 s20, 13312
  s_movk_i32 s21, 22528
  s_movk_i32 s22, 18432
P_mon:
  buffer_load_dwordx4 v[56:59], v5, s[4:7], s20 offen sc1
  buffer_load_dwordx2 v[60:61], v6, s[4:7], s21 offen sc1
  buffer_load_dwordx2 v[62:63], v6, s[4:7], s22 offen sc1
  s_waitcnt vmcnt(0)
  v_min3_u32 v7, v56, v57, v58
  v_min_u32 v7, v7, v59
  v_min3_u32 v8, v7, v60, v61
  v_min3_u32 v8, v8, v62, v63
  s_add_u32 s23, s34, s36
P_mon2a:
  v_cmp_lt_u32 vcc, s34, v8
  s_cmp_eq_u64 vcc, exec
  s_cbranch_scc0 P_mon3a
  s_add_u32 s34, s34, 1
  s_branch P_mon2a
P_mon3a:
P_mon2b:
  v_cmp_lt_u32 vcc, s36, v7
  s_cmp_eq_u64 vcc, exec
  s_cbranch_scc0 P_mon3b
  s_add_u32 s36, s36, 1
  s_branch P_mon2b
P_mon3b:
  s_add_u32 s24, s34, s36
  s_cmp_eq_u32 s23, s24
  s_cbranch_scc1 P_mon4
  v_mov_b32 v56, s34
  v_mov_b32 v57, s36
  buffer_store_dwordx2 v[56:57], v3, s[4:7], s35 offen sc1
  s_cmp_ge_u32 s34, 64
  s_cbranch_scc1 P_end
P_mon4:
  s_sleep 3
  s_add_u32 s32, s32, 1
  s_cmp_gt_u32 s32, 200000
  s_cbranch_scc1 P_end
  s_branch P_mon
P_start:
  s_lshl_b32 s20, s16, 13
  v_add_u32 v14, s20, v2
  s_lshl_b32 s20, s16, 10
  v_add_u32 v5, s20, v2
  v_mov_b32 v6, 65536
  s_cmp_eq_u32 s16, 0
  s_cselect_b64 s[38:39], 1, 0
  s_lshl_b32 s44, s16, 13
  s_lshl_b32 s45, s16, 11
  s_mov_b64 exec, s[38:39]
  v_mov_b32 v4, 1
  buffer_atomic_add v4, v3, s[4:7], s33 offen sc0 sc1
  s_mov_b64 exec, -1
  s_waitcnt vmcnt(0)
  s_mov_b64 exec, s[38:39]
  ds_write_b32 v6, v4
  s_mov_b64 exec, -1
  s_waitcnt lgkmcnt(0)
  s_barrier
  ds_read_b32 v7, v6
P_loop:
  s_waitcnt lgkmcnt(0)
  v_readfirstlane_b32 s30, v7
  v_xor_b32 v6, 4, v6
  v_xor_b32 v14, 32768, v14
  v_xor_b32 v5, 32768, v5
  s_cmp_ge_u32 s30, 1280
  s_cbranch_scc1 P_end
  s_mul_i32 s31, s30, 3277
  s_lshr_b32 s31, s31, 16
  s_mul_i32 s20, s31, 20
  s_sub_u32 s30, s30, s20
P_flt:
  s_cmp_lt_u32 s31, s36
  s_cbranch_scc1 P_got
  s_add_u32 s32, s32, 1
  s_cmp_gt_u32 s32, 200000
  s_cbranch_scc1 P_got
  s_add_u32 s20, s36, 1
  s_cmp_le_u32 s31, s20
  s_cbranch_scc1 P_neart
  s_sleep 60
P_neart:
  s_sleep 4
  buffer_load_dwordx2 v[56:57], v3, s[4:7], s35 offen sc1
  s_waitcnt vmcnt(0)
  v_readfirstlane_b32 s34, v56
  v_readfirstlane_b32 s36, v57
  s_branch P_flt
P_got:
  s_mov_b64 exec, s[38:39]
  v_mov_b32 v4, 1
  buffer_atomic_add v4, v3, s[4:7], s33 offen sc0 sc1
  s_mov_b64 exec, -1
  s_mul_i32 s24, s31, 1638400
  s_mul_i32 s20, s30, 81920
  s_add_u32 s24, s24, s20
  s_add_u32 s24, s24, 117440512
  s_add_u32 s23, s24, s45
  s_add_u32 s24, s24, s44
  s_lshl_b32 s25, s31, 16
  s_add_u32 s25, s25, 5767168
  s_lshl_b32 s20, s44, 1
  s_add_u32 s25, s25, s20
  s_lshr_b32 s26, s31, 1
  s_mul_i32 s26, s26, 655360
  s_lshl_b32 s20, s30, 15
  s_add_u32 s26, s26, s20
  s_and_b32 s20, s31, 1
  s_lshl_b32 s20, s20, 13
  s_add_u32 s26, s26, s20
  s_add_u32 s26, s26, 11796480
  s_add_u32 s26, s26, s45
  s_lshl_b32 s27, s31, 14
  s_add_u32 s27, s27, 9961472
  s_lshl_b32 s20, s45, 1
  s_add_u32 s27, s27, s20
  s_mul_i32 s28, s31, 40960
  s_lshl_b32 s29, s30, 6
  s_add_u32 s28, s28, s29
  buffer_load_dwordx2 v[60:61], v13, s[8:11], s28 offen
  buffer_load_dwordx2 v[62:63], v15, s[40:43], s29 offen
  s_add_u32 s20, s23, 32768
  buffer_load_dwordx4 v[64:67], v9, s[4:7], s20 offen sc1 nt
  buffer_load_dwordx4 v[68:71], v10, s[4:7], s20 offen sc1 nt
  s_add_u32 s20, s23, 33792
  buffer_load_dwordx4 v[80:83], v9, s[4:7], s20 offen sc1 nt
  buffer_load_dwordx4 v[84:87], v10, s[4:7], s20 offen sc1 nt
  s_add_u32 s20, s24, 0
  buffer_load_dwordx4 v[96:99], v9, s[4:7], s20 offen sc1 nt
  buffer_load_dwordx4 v[100:103], v10, s[4:7], s20 offen sc1 nt
  s_add_u32 s20, s24, 1024
  buffer_load_dwordx4 v[112:115], v9, s[4:7], s20 offen sc1 nt
  buffer_load_dwordx4 v[116:119], v10, s[4:7], s20 offen sc1 nt
  s_add_u32 s20, s24, 2048
  buffer_load_dwordx4 v[128:131], v9, s[4:7], s20 offen sc1 nt
  buffer_load_dwordx4 v[132:135], v10, s[4:7], s20 offen sc1 nt
  s_add_u32 s20, s24, 3072
  buffer_load_dwordx4 v[144:147], v9, s[4:7], s20 offen sc1 nt
  buffer_load_dwordx4 v[148:151], v10, s[4:7], s20 offen sc1 nt
  s_add_u32 s20, s24, 4096
  buffer_load_dwordx4 v[160:163], v9, s[4:7], s20 offen sc1 nt
  buffer_load_dwordx4 v[164:167], v10, s[4:7], s20 offen sc1 nt
  s_add_u32 s20, s24, 5120
  buffer_load_dwordx4 v[176:179], v9, s[4:7], s20 offen sc1 nt
  buffer_load_dwordx4 v[180:183], v10, s[4:7], s20 offen sc1 nt
  s_add_u32 s20, s24, 6144
  buffer_load_dwordx4 v[192:195], v9, s[4:7], s20 offen sc1 nt
  buffer_load_dwordx4 v[196:199], v10, s[4:7], s20 offen sc1 nt
  s_add_u32 s20, s24, 7168
  buffer_load_dwordx4 v[208:211], v9, s[4:7], s20 offen sc1 nt
  buffer_load_dwordx4 v[212:215], v10, s[4:7], s20 offen sc1 nt
P_fla:
  s_cmp_lt_u32 s31, s34
  s_cbranch_scc1 P_goa
  s_add_u32 s32, s32, 1
  s_cmp_gt_u32 s32, 200000
  s_cbranch_scc1 P_goa
  s_add_u32 s20, s34, 1
  s_cmp_le_u32 s31, s20
  s_cbranch_scc1 P_neara
  s_sleep 60
P_neara:
  s_sleep 4
  buffer_load_dwordx2 v[56:57], v3, s[4:7], s35 offen sc1
  s_waitcnt vmcnt(0)
  v_readfirstlane_b32 s34, v56
  v_readfirstlane_b32 s36, v57
  s_branch P_fla
P_goa:
  s_add_u32 s21, s25, 0
  buffer_load_dwordx4 v[104:107], v2, s[4:7], s21 offen offset:0 sc1
  buffer_load_dwordx4 v[108:111], v2, s[4:7], s21 offen offset:1024 sc1
  s_add_u32 s21, s25, 2048
  buffer_load_dwordx4 v[120:123], v2, s[4:7], s21 offen offset:0 sc1
  buffer_load_dwordx4 v[124:127], v2, s[4:7], s21 offen offset:1024 sc1
  s_add_u32 s21, s25, 4096
  buffer_load_dwordx4 v[136:139], v2, s[4:7], s21 offen offset:0 sc1
  buffer_load_dwordx4 v[140:143], v2, s[4:7], s21 offen offset:1024 sc1
  s_add_u32 s21, s25, 6144
  buffer_load_dwordx4 v[152:155], v2, s[4:7], s21 offen offset:0 sc1
  buffer_load_dwordx4 v[156:159], v2, s[4:7], s21 offen offset:1024 sc1
  s_add_u32 s21, s25, 8192
  buffer_load_dwordx4 v[168:171], v2, s[4:7], s21 offen offset:0 sc1
  buffer_load_dwordx4 v[172:175], v2, s[4:7], s21 offen offset:1024 sc1
  s_add_u32 s21, s25, 10240
  buffer_load_dwordx4 v[184:187], v2, s[4:7], s21 offen offset:0 sc1
  buffer_load_dwordx4 v[188:191], v2, s[4:7], s21 offen offset:1024 sc1
  s_add_u32 s21, s25, 12288
  buffer_load_dwordx4 v[200:203], v2, s[4:7], s21 offen offset:0 sc1
  buffer_load_dwordx4 v[204:207], v2, s[4:7], s21 offen offset:1024 sc1
  s_add_u32 s21, s25, 14336
  buffer_load_dwordx4 v[216:219], v2, s[4:7], s21 offen offset:0 sc1
  buffer_load_dwordx4 v[220:223], v2, s[4:7], s21 offen offset:1024 sc1
  s_add_u32 s20, s26, 0
  buffer_load_dwordx4 v[224:227], v11, s[4:7], s20 offen sc1 nt
  buffer_load_dwordx4 v[228:231], v12, s[4:7], s20 offen sc1 nt
  s_add_u32 s21, s27, 0
  buffer_load_dwordx4 v[232:235], v2, s[4:7], s21 offen offset:0 sc1
  buffer_load_dwordx4 v[236:239], v2, s[4:7], s21 offen offset:1024 sc1
  s_add_u32 s20, s26, 1024
  buffer_load_dwordx4 v[240:243], v11, s[4:7], s20 offen sc1 nt
  buffer_load_dwordx4 v[244:247], v12, s[4:7], s20 offen sc1 nt
  s_add_u32 s21, s27, 2048
  buffer_load_dwordx4 v[248:251], v2, s[4:7], s21 offen offset:0 sc1
  buffer_load_dwordx4 v[252:255], v2, s[4:7], s21 offen offset:1024 sc1
  s_waitcnt vmcnt(24)
  v_mfma_f32_16x16x32_bf16 v[40:43], v[64:67], v[16:19], 0
  v_mfma_f32_16x16x32_bf16 v[44:47], v[64:67], v[20:23], 0
  v_mfma_f32_16x16x32_bf16 v[48:51], v[68:71], v[16:19], 0
  v_mfma_f32_16x16x32_bf16 v[52:55], v[68:71], v[20:23], 0
  v_mfma_f32_16x16x32_bf16 v[40:43], v[80:83], v[16:19], v[40:43]
  v_mfma_f32_16x16x32_bf16 v[44:47], v[80:83], v[20:23], v[44:47]
  v_mfma_f32_16x16x32_bf16 v[48:51], v[84:87], v[16:19], v[48:51]
  v_mfma_f32_16x16x32_bf16 v[52:55], v[84:87], v[20:23], v[52:55]
  s_waitcnt vmcnt(22)
  v_mfma_f32_16x16x32_bf16 v[24:27], v[96:99], v[104:107], 0
  v_mfma_f32_16x16x32_bf16 v[28:31], v[96:99], v[108:111], 0
  v_mfma_f32_16x16x32_bf16 v[32:35], v[100:103], v[104:107], 0
  v_mfma_f32_16x16x32_bf16 v[36:39], v[100:103], v[108:111], 0
  s_waitcnt vmcnt(20)
  v_mfma_f32_16x16x32_bf16 v[24:27], v[112:115], v[120:123], v[24:27]
  v_mfma_f32_16x16x32_bf16 v[28:31], v[112:115], v[124:127], v[28:31]
  v_mfma_f32_16x16x32_bf16 v[32:35], v[116:119], v[120:123], v[32:35]
  v_mfma_f32_16x16x32_bf16 v[36:39], v[116:119], v[124:127], v[36:39]
  s_mov_b64 exec, s[38:39]
  ds_write_b32 v6, v4
  s_mov_b64 exec, -1
  ds_write_b128 v14, v[40:43] offset:4096
  ds_write_b128 v14, v[44:47] offset:5120
  ds_write_b128 v14, v[48:51] offset:6144
  ds_write_b128 v14, v[52:55] offset:7168
  s_waitcnt vmcnt(18)
  v_mfma_f32_16x16x32_bf16 v[24:27], v[128:131], v[136:139], v[24:27]
  v_mfma_f32_16x16x32_bf16 v[28:31], v[128:131], v[140:143], v[28:31]
  v_mfma_f32_16x16x32_bf16 v[32:35], v[132:135], v[136:139], v[32:35]
  v_mfma_f32_16x16x32_bf16 v[36:39], v[132:135], v[140:143], v[36:39]
  s_waitcnt vmcnt(16)
  v_mfma_f32_16x16x32_bf16 v[24:27], v[144:147], v[152:155], v[24:27]
  v_mfma_f32_16x16x32_bf16 v[28:31], v[144:147], v[156:159], v[28:31]
  v_mfma_f32_16x16x32_bf16 v[32:35], v[148:151], v[152:155], v[32:35]
  v_mfma_f32_16x16x32_bf16 v[36:39], v[148:151], v[156:159], v[36:39]
  s_waitcnt vmcnt(14)
  v_mfma_f32_16x16x32_bf16 v[24:27], v[160:163], v[168:171], v[24:27]
  v_mfma_f32_16x16x32_bf16 v[28:31], v[160:163], v[172:175], v[28:31]
  v_mfma_f32_16x16x32_bf16 v[32:35], v[164:167], v[168:171], v[32:35]
  v_mfma_f32_16x16x32_bf16 v[36:39], v[164:167], v[172:175], v[36:39]
  s_waitcnt vmcnt(12)
  v_mfma_f32_16x16x32_bf16 v[24:27], v[176:179], v[184:187], v[24:27]
  v_mfma_f32_16x16x32_bf16 v[28:31], v[176:179], v[188:191], v[28:31]
  v_mfma_f32_16x16x32_bf16 v[32:35], v[180:183], v[184:187], v[32:35]
  v_mfma_f32_16x16x32_bf16 v[36:39], v[180:183], v[188:191], v[36:39]
  s_waitcnt vmcnt(10)
  v_mfma_f32_16x16x32_bf16 v[24:27], v[192:195], v[200:203], v[24:27]
  v_mfma_f32_16x16x32_bf16 v[28:31], v[192:195], v[204:207], v[28:31]
  v_mfma_f32_16x16x32_bf16 v[32:35], v[196:199], v[200:203], v[32:35]
  v_mfma_f32_16x16x32_bf16 v[36:39], v[196:199], v[204:207], v[36:39]
  s_waitcnt vmcnt(8)
  v_mfma_f32_16x16x32_bf16 v[24:27], v[208:211], v[216:219], v[24:27]
  v_mfma_f32_16x16x32_bf16 v[28:31], v[208:211], v[220:223], v[28:31]
  v_mfma_f32_16x16x32_bf16 v[32:35], v[212:215], v[216:219], v[32:35]
  v_mfma_f32_16x16x32_bf16 v[36:39], v[212:215], v[220:223], v[36:39]
  s_waitcnt vmcnt(4)
  v_mfma_f32_16x16x32_bf16 v[24:27], v[224:227], v[232:235], v[24:27]
  v_mfma_f32_16x16x32_bf16 v[28:31], v[224:227], v[236:239], v[28:31]
  v_mfma_f32_16x16x32_bf16 v[32:35], v[228:231], v[232:235], v[32:35]
  v_mfma_f32_16x16x32_bf16 v[36:39], v[228:231], v[236:239], v[36:39]
  s_waitcnt vmcnt(0)
  v_mfma_f32_16x16x32_bf16 v[24:27], v[240:243], v[248:251], v[24:27]
  v_mfma_f32_16x16x32_bf16 v[28:31], v[240:243], v[252:255], v[28:31]
  v_mfma_f32_16x16x32_bf16 v[32:35], v[244:247], v[248:251], v[32:35]
  v_mfma_f32_16x16x32_bf16 v[36:39], v[244:247], v[252:255], v[36:39]
  s_nop 7
  ds_write_b128 v14, v[24:27] offset:0
  ds_write_b128 v14, v[28:31] offset:1024
  ds_write_b128 v14, v[32:35] offset:2048
  ds_write_b128 v14, v[36:39] offset:3072
  s_waitcnt lgkmcnt(0)
  s_barrier
  ds_read_b128 v[64:67], v5 offset:4096
  ds_read_b128 v[68:71], v5 offset:12288
  ds_read_b128 v[72:75], v5 offset:20480
  ds_read_b128 v[76:79], v5 offset:28672
  ds_read_b128 v[80:83], v5 offset:0
  ds_read_b128 v[84:87], v5 offset:8192
  ds_read_b128 v[88:91], v5 offset:16384
  ds_read_b128 v[92:95], v5 offset:24576
  ds_read_b32 v7, v6
  v_lshlrev_b32 v96, 16, v62
  v_and_b32 v97, 0xffff0000, v62
  v_lshlrev_b32 v98, 16, v63
  v_and_b32 v99, 0xffff0000, v63
  s_waitcnt lgkmcnt(5)
  v_pk_add_f32 v[64:65], v[64:65], v[68:69]
  v_pk_add_f32 v[66:67], v[66:67], v[70:71]
  v_pk_add_f32 v[64:65], v[64:65], v[72:73]
  v_pk_add_f32 v[66:67], v[66:67], v[74:75]
  v_pk_add_f32 v[64:65], v[64:65], v[76:77]
  v_pk_add_f32 v[66:67], v[66:67], v[78:79]
  v_cvt_pk_bf16_f32 v65, v64, v65
  v_lshlrev_b32 v64, 16, v65
  v_and_b32 v65, 0xffff0000, v65
  v_cvt_pk_bf16_f32 v67, v66, v67
  v_lshlrev_b32 v66, 16, v67
  v_and_b32 v67, 0xffff0000, v67
  v_add_f32 v64, v64, v96
  v_add_f32 v65, v65, v97
  v_add_f32 v66, v66, v98
  v_add_f32 v67, v67, v99
  v_cvt_pk_bf16_f32 v65, v64, v65
  v_lshlrev_b32 v64, 16, v65
  v_and_b32 v65, 0xffff0000, v65
  v_cvt_pk_bf16_f32 v67, v66, v67
  v_lshlrev_b32 v66, 16, v67
  v_and_b32 v67, 0xffff0000, v67
  v_mul_f32 v100, 0xbfb8aa3b, v64
  v_mul_f32 v101, 0xbfb8aa3b, v65
  v_mul_f32 v102, 0xbfb8aa3b, v66
  v_mul_f32 v103, 0xbfb8aa3b, v67
  v_exp_f32 v100, v100
  v_exp_f32 v101, v101
  v_exp_f32 v102, v102
  v_exp_f32 v103, v103
  s_waitcnt lgkmcnt(1)
  v_pk_add_f32 v[80:81], v[80:81], v[84:85]
  v_pk_add_f32 v[82:83], v[82:83], v[86:87]
  v_pk_add_f32 v[80:81], v[80:81], v[88:89]
  v_pk_add_f32 v[82:83], v[82:83], v[90:91]
  v_pk_add_f32 v[80:81], v[80:81], v[92:93]
  v_pk_add_f32 v[82:83], v[82:83], v[94:95]
  v_add_f32 v100, 1.0, v100
  v_add_f32 v101, 1.0, v101
  v_add_f32 v102, 1.0, v102
  v_add_f32 v103, 1.0, v103
  v_rcp_f32 v100, v100
  v_rcp_f32 v101, v101
  v_rcp_f32 v102, v102
  v_rcp_f32 v103, v103
  v_cvt_pk_bf16_f32 v81, v80, v81
  v_lshlrev_b32 v80, 16, v81
  v_and_b32 v81, 0xffff0000, v81
  v_cvt_pk_bf16_f32 v83, v82, v83
  v_lshlrev_b32 v82, 16, v83
  v_and_b32 v83, 0xffff0000, v83
  v_mul_f32 v64, v64, v100
  v_mul_f32 v65, v65, v101
  v_mul_f32 v66, v66, v102
  v_mul_f32 v67, v67, v103
  v_cvt_pk_bf16_f32 v65, v64, v65
  v_lshlrev_b32 v64, 16, v65
  v_and_b32 v65, 0xffff0000, v65
  v_cvt_pk_bf16_f32 v67, v66, v67
  v_lshlrev_b32 v66, 16, v67
  v_and_b32 v67, 0xffff0000, v67
  v_mul_f32 v80, v80, v64
  v_mul_f32 v81, v81, v65
  v_mul_f32 v82, v82, v66
  v_mul_f32 v83, v83, v67
  v_cvt_pk_bf16_f32 v81, v80, v81
  v_lshlrev_b32 v80, 16, v81
  v_and_b32 v81, 0xffff0000, v81
  v_cvt_pk_bf16_f32 v83, v82, v83
  v_lshlrev_b32 v82, 16, v83
  v_and_b32 v83, 0xffff0000, v83
  v_lshlrev_b32 v100, 16, v60
  v_and_b32 v101, 0xffff0000, v60
  v_add_f32 v100, v100, v80
  v_add_f32 v101, v101, v81
  v_cvt_pk_bf16_f32 v102, v100, v101
  v_lshlrev_b32 v100, 16, v61
  v_and_b32 v101, 0xffff0000, v61
  v_add_f32 v100, v100, v82
  v_add_f32 v101, v101, v83
  v_cvt_pk_bf16_f32 v103, v100, v101
  buffer_store_dwordx2 v[102:103], v13, s[12:15], s28 offen
  s_branch P_loop
P_end:
  s_endpgm
.section .rodata,"a"
.p2align 6
.amdhsa_kernel recurrent_scan__memory_aug_recurrent_mem_tr__dense_activation_squared_relu__prompt_kernel
  .amdhsa_next_free_vgpr 512
  .amdhsa_next_free_sgpr 102
  .amdhsa_accum_offset 256
  .amdhsa_group_segment_fixed_size 0
  .amdhsa_kernarg_size 120
  .amdhsa_user_sgpr_count 2
  .amdhsa_user_sgpr_kernarg_segment_ptr 1
  .amdhsa_system_sgpr_workgroup_id_x 1
.end_amdhsa_kernel
```
